```python
import torch

def _softmax(x, axis=-1):
    return torch.softmax(x, dim=axis)

def _gelu(x):
    return torch.nn.functional.gelu(x, approximate='tanh')

def _silu(x):
    return torch.nn.functional.silu(x)

def _sigmoid(x):
    return torch.sigmoid(x)

def _layernorm(x, axis=-1, eps=1e-05):
    m = x.mean(dim=axis, keepdim=True)
    v = x.var(dim=axis, keepdim=True, unbiased=False)
    return (x - m) / torch.sqrt(v + eps)

def _scatter_add(tgt, idx, src, axis=0):
    return tgt.clone().index_add_(axis, idx, src)

def _segment_sum(src, seg, n):
    out = torch.zeros((n,) + src.shape[1:], dtype=src.dtype)
    return out.index_add_(0, seg, src)

def _pad(x, pw):
    flat = tuple((v for pair in reversed(pw) for v in pair))
    return torch.nn.functional.pad(x, flat)
kernel_name = 'adaLN_cond__ssm_conv_h3__dense_activation_silu__prompt'

def setup_inputs():

    _w = lambda a: (lambda t: t.to(torch.bfloat16) if t.is_floating_point() else t)(torch.as_tensor(a))

    def _A_setup():
        B, S, D = (1, 2048, 1024)
        ks = 4
        return {'q': _w((lambda *s: torch.randn(*s, dtype=torch.bfloat16) * 0.05)(B, S, D)), 'k': _w((lambda *s: torch.randn(*s, dtype=torch.bfloat16) * 0.8)(B, S, D)), 'v': _w((lambda *s: torch.randn(*s, dtype=torch.bfloat16) * 0.8)(B, S, D)), 'shift_k': _w((lambda *s: torch.randn(*s, dtype=torch.bfloat16) * 0.8)(D, ks) * 0.5), 'ssm_k': _w((lambda *s: torch.randn(*s, dtype=torch.bfloat16) * 0.8)(D, S) * (1.0 / S ** 0.5)), 'ssm_D': _w((lambda *s: torch.randn(*s, dtype=torch.bfloat16) * 0.8)(D))}
    _A_in = _A_setup()

    def _B_setup():
        B, S, D, F = (1, 2048, 1024, 3584)
        return {'x': _w((lambda *s: torch.randn(*s, dtype=torch.bfloat16) * 0.05)(B, S, D)), 'w1': _w((lambda *s: torch.randn(*s, dtype=torch.bfloat16) * 3.2)(D, F) * D ** (-0.5)), 'w2': _w((lambda *s: torch.randn(*s, dtype=torch.bfloat16) * 1.6)(F, D) * F ** (-0.5))}
    _B_in = _B_setup()
    return {'A_q': _A_in['q'], 'A_k': _A_in['k'], 'A_v': _A_in['v'], 'A_shift_k': _A_in['shift_k'], 'A_ssm_k': _A_in['ssm_k'], 'A_ssm_D': _A_in['ssm_D'], 'B_x': _B_in['x'], 'B_w1': _B_in['w1'], 'B_w2': _B_in['w2'], 'c': _w((lambda *s: torch.randn(*s, dtype=torch.bfloat16) * 0.1)(1, 1024) * 8.0), 'w_mod': _w((lambda *s: torch.randn(*s, dtype=torch.bfloat16) * 0.1)(1024, 6 * 1024) * 1024 ** (-0.5) * 8.0)}

def reference(A_q, A_k, A_v, A_shift_k, A_ssm_k, A_ssm_D, B_x, B_w1, B_w2, c, w_mod):

    def _A_ref(q, k, v, shift_k, ssm_k, ssm_D):
        B, S, D = q.shape
        ks = shift_k.shape[-1]
        k_pad = _pad(k, ((0, 0), (ks - 1, 0), (0, 0)))
        k_shift = torch.zeros_like(k)
        for t in range(ks):
            k_shift = k_shift + k_pad[:, t:t + S, :] * shift_k[:, ks - 1 - t][None, None, :]
        kv = k_shift * v
        L = 2 * S
        kv_pad = _pad(kv, ((0, 0), (0, S), (0, 0)))
        kf_pad = _pad(ssm_k, ((0, 0), (0, S)))
        kv_f = (lambda x, axes=(-2, -1): torch.fft.rfft2(x.float(), dim=axes))(kv_pad[:, None, :, :], axes=(1, 2))
        kf_f = (lambda x, axes=(-2, -1): torch.fft.rfft2(x.float(), dim=axes))(kf_pad[:, None, :], axes=(1, 2))
        kf_f = (lambda x, *d: x.permute(*d))(kf_f, 1, 2, 0)
        y_f = kv_f * kf_f[None, :, :, :]
        y = (lambda x, s, axes=(-2, -1): torch.fft.irfft2(x, s=s, dim=axes).to(torch.bfloat16))(y_f, (1, L), axes=(1, 2))[:, 0, :S, :]
        y = y + kv * ssm_D[None, None, :]
        return q * y

    def _B_ref(x, w1, w2):
        h = torch.einsum('bsd,df->bsf', x, w1)
        h = _silu(h)
        out = torch.einsum('bsf,fd->bsd', h, w2)
        return out
    x = A_q
    mod = (_silu(c) @ w_mod).reshape(c.shape[0], 6, 1, -1)
    sa, ca, ga, sb, cb, gb = (mod[:, 0].clone(), mod[:, 1].clone(), mod[:, 2].clone(), mod[:, 3].clone(), mod[:, 4].clone(), mod[:, 5].clone())
    h = _layernorm(x, axis=-1) * (1 + ca) + sa
    x = x + ga * _A_ref(h, A_k, A_v, A_shift_k, A_ssm_k, A_ssm_D)
    h = _layernorm(x, axis=-1) * (1 + cb) + sb
    x = x + gb * _B_ref(h, B_w1, B_w2)
    return x
```

```asm
; @launch kernel=conv_kernel grid=(256,1,1) block=(256,1,1) lds=121856
; @launch kernel=mlp_kernel grid=(256,1,1) block=(256,1,1) lds=163840
.amdgcn_target "amdgcn-amd-amdhsa--gfx950"
.text
.globl conv_kernel
.p2align 8
.type conv_kernel,@function
conv_kernel:
s_cmp_ge_u32 s2, 256
s_cbranch_scc1 conv_kernel_end
s_load_dwordx8 s[4:11], s[0:1], 8
s_load_dwordx2 s[22:23], s[0:1], 104
s_getpc_b64 s[92:93]
conv_kernel_pc0:
s_lshr_b32 s91, s2, 3
s_and_b32 s93, s93, 0xffff
s_mov_b32 s94, conv_kernel_end-conv_kernel_pc0
s_mov_b32 s95, 0x00020000
s_and_b32 s91, s91, 31
s_lshl_b32 s91, s91, 15
v_lshlrev_b32 v2, 7, v0
buffer_load_dword v255, v2, s[92:95], s91 offen
v_lshrrev_b32 v9, 6, v0
v_and_b32 v1, 63, v0
v_readfirstlane_b32 s3, v9
s_and_b32 s88, s2, 7
s_lshr_b32 s89, s2, 4
s_bitcmp1_b32 s2, 3
s_cbranch_scc1 conv_kernel_aux
s_load_dwordx2 s[12:13], s[0:1], 40
s_load_dwordx4 s[16:19], s[0:1], 56
s_lshl_b32 s90, s88, 7
s_lshl_b32 s93, s89, 3
s_add_u32 s90, s90, s93
s_lshl_b32 s87, s90, 1
v_lshlrev_b32 v12, 4, v1
v_lshlrev_b32 v2, 12, v1
v_sub_u32 v3, 2, v1
v_lshlrev_b32 v3, 11, v3
v_mov_b32 v11, 1073741824
v_cmp_gt_u32 vcc, 3, v1
s_lshl_b32 s96, s3, 18
s_add_u32 s96, s96, s87
v_cndmask_b32 v3, v11, v3, vcc
s_lshl_b32 s93, s3, 1
s_add_u32 s93, s93, s90
s_lshl_b32 s95, s93, 12
s_mov_b32 s26, 4194304
s_mov_b32 s27, 0x00020000
s_mov_b32 s30, 4194304
s_mov_b32 s31, 0x00020000
s_mov_b32 s34, 4194304
s_mov_b32 s35, 0x00020000
s_waitcnt lgkmcnt(0)
s_mov_b32 s32, s10
s_and_b32 s33, s11, 0xffff
buffer_load_dwordx4 v[64:67], v12, s[32:35], s95 offen offset:0
buffer_load_dwordx4 v[68:71], v12, s[32:35], s95 offen offset:1024
buffer_load_dwordx4 v[72:75], v12, s[32:35], s95 offen offset:2048
buffer_load_dwordx4 v[76:79], v12, s[32:35], s95 offen offset:3072
s_add_u32 s95, s95, 4096
buffer_load_dwordx4 v[80:83], v12, s[32:35], s95 offen offset:0
buffer_load_dwordx4 v[84:87], v12, s[32:35], s95 offen offset:1024
buffer_load_dwordx4 v[88:91], v12, s[32:35], s95 offen offset:2048
buffer_load_dwordx4 v[92:95], v12, s[32:35], s95 offen offset:3072
s_mov_b32 s24, s4
s_and_b32 s25, s5, 0xffff
s_mov_b32 s28, s6
s_and_b32 s29, s7, 0xffff
s_add_u32 s97, s96, 0
s_sub_u32 s98, s97, 6144
buffer_load_dwordx4 v[32:35], v3, s[24:27], s98 offen
buffer_load_dwordx4 v[16:19], v2, s[24:27], s97 offen
buffer_load_dwordx4 v[20:23], v2, s[24:27], s97 offen offset:2048
buffer_load_dwordx4 v[24:27], v2, s[28:31], s97 offen
buffer_load_dwordx4 v[28:31], v2, s[28:31], s97 offen offset:2048
s_lshl_b32 s94, s90, 3
s_add_u32 s8, s8, s94
s_addc_u32 s9, s9, 0
s_load_dwordx16 s[36:51], s[8:9], 0
s_lshl_b32 s94, s93, 1
s_add_u32 s12, s12, s94
s_addc_u32 s13, s13, 0
s_load_dword s84, s[12:13], 0
v_and_b32 v10, 15, v1
v_lshrrev_b32 v11, 4, v1
s_mul_i32 s94, s3, 9216
s_add_u32 s94, s94, 66560
v_lshlrev_b32 v13, 5, v10
v_lshlrev_b32 v14, 4, v11
v_sub_u32 v5, v14, v13
v_add_u32 v5, 480, v5
v_add_u32 v5, s94, v5
v_sub_u32 v12, 1008, v12
v_add_u32 v12, s94, v12
v_lshlrev_b32 v9, 3, v1
v_add_u32 v9, s94, v9
s_mul_i32 s95, s3, 16640
v_lshlrev_b32 v14, 3, v11
v_add_u32 v8, v13, v14
v_add_u32 v8, 32, v8
v_add_u32 v8, s95, v8
v_lshrrev_b32 v13, 1, v11
v_lshl_add_u32 v13, v10, 1, v13
v_mul_u32_u24 v7, 144, v13
v_and_b32 v13, 1, v11
v_lshl_add_u32 v7, v13, 3, v7
s_lshl_b32 s98, s3, 5
s_add_u32 s98, s98, 103424
v_add_u32 v7, s98, v7
v_add_u32 v13, 1, v10
v_and_b32 v14, 1, v13
v_and_b32 v13, -2, v13
v_lshl_add_u32 v13, v11, 3, v13
v_mul_u32_u24 v14, 4160, v14
v_lshl_add_u32 v6, v13, 1, v14
v_add_u32 v6, s95, v6
v_lshlrev_b32 v4, 2, v1
s_lshl_b32 s98, s3, 8
s_add_u32 s98, s98, 30
v_add_u32 v4, s98, v4
v_mov_b32 v14, 0
v_mov_b32 v15, 0
v_lshrrev_b32 v13, 2, v1
v_mul_u32_u24 v13, 4160, v13
v_and_b32 v10, 3, v1
v_lshl_add_u32 v13, v10, 3, v13
v_add_u32 v10, 0x1000, v9
s_cmp_eq_u32 s3, 0
s_cselect_b64 vcc, -1, 0
v_cndmask_b32 v13, v10, v13, vcc
ds_write_b64 v9, v[14:15] offset:4096
ds_write_b64 v9, v[14:15] offset:8704
ds_write_b64 v13, v[14:15]
v_add_u32 v9, 8320, v6
s_lshl_b32 s99, s90, 4
s_lshl_b32 s98, s3, 18
s_add_u32 s99, s99, s98
s_waitcnt lgkmcnt(0)
s_lshl_b32 s52, s36, 16
s_and_b32 s53, s36, 0xffff0000
s_lshl_b32 s54, s37, 16
s_and_b32 s55, s37, 0xffff0000
s_lshl_b32 s56, s38, 16
s_and_b32 s57, s38, 0xffff0000
s_lshl_b32 s58, s39, 16
s_and_b32 s59, s39, 0xffff0000
s_lshl_b32 s60, s40, 16
s_and_b32 s61, s40, 0xffff0000
s_lshl_b32 s62, s41, 16
s_and_b32 s63, s41, 0xffff0000
s_lshl_b32 s64, s42, 16
s_and_b32 s65, s42, 0xffff0000
s_lshl_b32 s66, s43, 16
s_and_b32 s67, s43, 0xffff0000
s_lshl_b32 s68, s44, 16
s_and_b32 s69, s44, 0xffff0000
s_lshl_b32 s70, s45, 16
s_and_b32 s71, s45, 0xffff0000
s_lshl_b32 s72, s46, 16
s_and_b32 s73, s46, 0xffff0000
s_lshl_b32 s74, s47, 16
s_and_b32 s75, s47, 0xffff0000
s_lshl_b32 s76, s48, 16
s_and_b32 s77, s48, 0xffff0000
s_lshl_b32 s78, s49, 16
s_and_b32 s79, s49, 0xffff0000
s_lshl_b32 s80, s50, 16
s_and_b32 s81, s50, 0xffff0000
s_lshl_b32 s82, s51, 16
s_and_b32 s83, s51, 0xffff0000
s_lshl_b32 s85, s84, 16
s_and_b32 s86, s84, 0xffff0000
s_mov_b32 s87, 0xffff
s_add_u32 s36, s22, 262144
s_addc_u32 s37, s23, 0
s_and_b32 s37, s37, 0xffff
s_mov_b32 s38, 131072
s_mov_b32 s39, 0x00020000
s_add_u32 s40, s22, 1048576
s_addc_u32 s41, s23, 0
s_and_b32 s41, s41, 0xffff
s_mov_b32 s42, 4194304
s_mov_b32 s43, 0x00020000
s_mov_b32 s44, s16
s_and_b32 s45, s17, 0xffff
s_mov_b32 s46, 7340032
s_mov_b32 s47, 0x00020000
s_mov_b32 s48, s18
s_and_b32 s49, s19, 0xffff
s_mov_b32 s50, 7340032
s_mov_b32 s51, 0x00020000
s_lshl_b32 s91, s88, 4
s_add_u32 s91, s91, s89
s_lshl_b32 s91, s91, 2
s_add_u32 s91, s91, s3
s_mul_i32 s91, s91, 14336
s_add_u32 s92, s91, 7168
v_min_u32 v13, 55, v1
v_lshlrev_b32 v13, 7, v13
s_waitcnt vmcnt(9)
v_lshlrev_b32 v252, 16, v64
v_add_f32 v252, s85, v252
v_cvt_pk_bf16_f32 v252, v252, v252
v_cmp_eq_u32 vcc, 0, v1
v_bfi_b32 v252, s87, v252, v64
s_nop 0
v_cndmask_b32 v64, v64, v252, vcc
v_alignbit_b32 v236, v67, v67, 16
v_alignbit_b32 v237, v66, v66, 16
v_alignbit_b32 v238, v65, v65, 16
v_alignbit_b32 v239, v64, v64, 16
ds_write_b128 v12, v[236:239] offset:3072
v_alignbit_b32 v240, v71, v71, 16
v_alignbit_b32 v241, v70, v70, 16
v_alignbit_b32 v242, v69, v69, 16
v_alignbit_b32 v243, v68, v68, 16
ds_write_b128 v12, v[240:243] offset:2048
v_alignbit_b32 v244, v75, v75, 16
v_alignbit_b32 v245, v74, v74, 16
v_alignbit_b32 v246, v73, v73, 16
v_alignbit_b32 v247, v72, v72, 16
ds_write_b128 v12, v[244:247] offset:1024
v_alignbit_b32 v248, v79, v79, 16
v_alignbit_b32 v249, v78, v78, 16
v_alignbit_b32 v250, v77, v77, 16
v_alignbit_b32 v251, v76, v76, 16
ds_write_b128 v12, v[248:251] offset:0
s_waitcnt vmcnt(5)
v_lshlrev_b32 v252, 16, v80
v_add_f32 v252, s86, v252
v_cvt_pk_bf16_f32 v252, v252, v252
v_cmp_eq_u32 vcc, 0, v1
v_bfi_b32 v252, s87, v252, v80
s_nop 0
v_cndmask_b32 v80, v80, v252, vcc
v_alignbit_b32 v236, v83, v83, 16
v_alignbit_b32 v237, v82, v82, 16
v_alignbit_b32 v238, v81, v81, 16
v_alignbit_b32 v239, v80, v80, 16
ds_write_b128 v12, v[236:239] offset:7680
v_alignbit_b32 v240, v87, v87, 16
v_alignbit_b32 v241, v86, v86, 16
v_alignbit_b32 v242, v85, v85, 16
v_alignbit_b32 v243, v84, v84, 16
ds_write_b128 v12, v[240:243] offset:6656
v_alignbit_b32 v244, v91, v91, 16
v_alignbit_b32 v245, v90, v90, 16
v_alignbit_b32 v246, v89, v89, 16
v_alignbit_b32 v247, v88, v88, 16
ds_write_b128 v12, v[244:247] offset:5632
v_alignbit_b32 v248, v95, v95, 16
v_alignbit_b32 v249, v94, v94, 16
v_alignbit_b32 v250, v93, v93, 16
v_alignbit_b32 v251, v92, v92, 16
ds_write_b128 v12, v[248:251] offset:4608
s_add_u32 s97, s96, 1048576
s_sub_u32 s98, s97, 6144
buffer_load_dwordx4 v[52:55], v3, s[24:27], s98 offen
buffer_load_dwordx4 v[36:39], v2, s[24:27], s97 offen
buffer_load_dwordx4 v[40:43], v2, s[24:27], s97 offen offset:2048
buffer_load_dwordx4 v[44:47], v2, s[28:31], s97 offen
buffer_load_dwordx4 v[48:51], v2, s[28:31], s97 offen offset:2048
v_lshrrev_b32 v11, 3, v1
v_and_b32 v10, 7, v1
v_lshlrev_b32 v12, 14, v11
v_lshl_add_u32 v12, v10, 4, v12
v_mul_u32_u24 v11, 144, v11
v_lshl_add_u32 v11, v10, 4, v11
s_mul_i32 s98, s3, 2304
s_add_u32 s98, s98, 103424
v_add_u32 v11, s98, v11
s_waitcnt lgkmcnt(0)
ds_read_b128 a[0:3], v5 offset:3584
ds_read_b128 a[4:7], v5 offset:3648
ds_read_b128 a[8:11], v5 offset:3712
ds_read_b128 a[12:15], v5 offset:3776
ds_read_b128 a[16:19], v5 offset:3840
ds_read_b128 a[20:23], v5 offset:3904
ds_read_b128 a[24:27], v5 offset:3968
ds_read_b128 a[28:31], v5 offset:4032
ds_read_b128 a[32:35], v5 offset:3072
ds_read_b128 a[36:39], v5 offset:3136
ds_read_b128 a[40:43], v5 offset:3200
ds_read_b128 a[44:47], v5 offset:3264
ds_read_b128 a[48:51], v5 offset:3328
ds_read_b128 a[52:55], v5 offset:3392
ds_read_b128 a[56:59], v5 offset:3456
ds_read_b128 a[60:63], v5 offset:3520
ds_read_b128 a[64:67], v5 offset:2560
ds_read_b128 a[68:71], v5 offset:2624
ds_read_b128 a[72:75], v5 offset:2688
ds_read_b128 a[76:79], v5 offset:2752
ds_read_b128 a[80:83], v5 offset:2816
ds_read_b128 a[84:87], v5 offset:2880
ds_read_b128 a[88:91], v5 offset:2944
ds_read_b128 a[92:95], v5 offset:3008
ds_read_b128 a[96:99], v5 offset:8192
ds_read_b128 a[100:103], v5 offset:8256
ds_read_b128 a[104:107], v5 offset:8320
ds_read_b128 a[108:111], v5 offset:8384
ds_read_b128 a[112:115], v5 offset:8448
ds_read_b128 a[116:119], v5 offset:8512
ds_read_b128 a[120:123], v5 offset:8576
ds_read_b128 a[124:127], v5 offset:8640
ds_read_b128 a[128:131], v5 offset:7680
ds_read_b128 a[132:135], v5 offset:7744
ds_read_b128 a[136:139], v5 offset:7808
ds_read_b128 a[140:143], v5 offset:7872
ds_read_b128 a[144:147], v5 offset:7936
ds_read_b128 a[148:151], v5 offset:8000
ds_read_b128 a[152:155], v5 offset:8064
ds_read_b128 a[156:159], v5 offset:8128
ds_read_b128 a[160:163], v5 offset:7168
ds_read_b128 a[164:167], v5 offset:7232
ds_read_b128 a[168:171], v5 offset:7296
ds_read_b128 a[172:175], v5 offset:7360
ds_read_b128 a[176:179], v5 offset:7424
ds_read_b128 a[180:183], v5 offset:7488
ds_read_b128 a[184:187], v5 offset:7552
ds_read_b128 a[188:191], v5 offset:7616
s_waitcnt vmcnt(5)
v_mov_b32_dpp v56, v32 row_shl:1 row_mask:0xf bank_mask:0xf
v_mov_b32_dpp v57, v33 row_shl:1 row_mask:0xf bank_mask:0xf
v_mov_b32_dpp v58, v34 row_shl:1 row_mask:0xf bank_mask:0xf
v_mov_b32_dpp v59, v35 row_shl:1 row_mask:0xf bank_mask:0xf
v_mov_b32_dpp v60, v32 row_shl:2 row_mask:0xf bank_mask:0xf
v_mov_b32_dpp v61, v33 row_shl:2 row_mask:0xf bank_mask:0xf
v_mov_b32_dpp v62, v34 row_shl:2 row_mask:0xf bank_mask:0xf
v_mov_b32_dpp v63, v35 row_shl:2 row_mask:0xf bank_mask:0xf
v_mov_b32_dpp v32, v20 wave_shr:1 row_mask:0xf bank_mask:0xf
v_mov_b32_dpp v33, v21 wave_shr:1 row_mask:0xf bank_mask:0xf
v_mov_b32_dpp v34, v22 wave_shr:1 row_mask:0xf bank_mask:0xf
v_mov_b32_dpp v35, v23 wave_shr:1 row_mask:0xf bank_mask:0xf
v_mov_b32_dpp v56, v16 wave_shr:1 row_mask:0xf bank_mask:0xf
v_mov_b32_dpp v57, v17 wave_shr:1 row_mask:0xf bank_mask:0xf
v_mov_b32_dpp v58, v18 wave_shr:1 row_mask:0xf bank_mask:0xf
v_mov_b32_dpp v59, v19 wave_shr:1 row_mask:0xf bank_mask:0xf
v_mov_b32_dpp v60, v32 wave_shr:1 row_mask:0xf bank_mask:0xf
v_mov_b32_dpp v61, v33 wave_shr:1 row_mask:0xf bank_mask:0xf
v_mov_b32_dpp v62, v34 wave_shr:1 row_mask:0xf bank_mask:0xf
v_mov_b32_dpp v63, v35 wave_shr:1 row_mask:0xf bank_mask:0xf
v_lshlrev_b32 v224, 16, v20
v_lshlrev_b32 v225, 16, v16
v_lshlrev_b32 v226, 16, v32
v_lshlrev_b32 v227, 16, v56
v_lshlrev_b32 v228, 16, v60
v_lshlrev_b32 v229, 16, v24
v_lshlrev_b32 v230, 16, v28
v_mul_f32 v231, s55, v228
v_mul_f32 v232, s55, v227
v_fmac_f32 v231, s54, v227
v_fmac_f32 v232, s54, v226
v_fmac_f32 v231, s53, v226
v_fmac_f32 v232, s53, v225
v_fmac_f32 v231, s52, v225
v_fmac_f32 v232, s52, v224
v_mul_f32 v231, v231, v229
v_mul_f32 v232, v232, v230
v_cvt_pk_bf16_f32 v233, v231, v232
ds_write_b32 v4, v233 offset:2
ds_write_b16 v4, v233 offset:4160
ds_write_b16_d16_hi v4, v233 offset:4162
v_and_b32 v234, 0xffff0000, v20
v_and_b32 v235, 0xffff0000, v16
v_and_b32 v236, 0xffff0000, v32
v_and_b32 v237, 0xffff0000, v56
v_and_b32 v238, 0xffff0000, v60
v_and_b32 v239, 0xffff0000, v24
v_and_b32 v240, 0xffff0000, v28
v_mul_f32 v241, s59, v238
v_mul_f32 v242, s59, v237
v_fmac_f32 v241, s58, v237
v_fmac_f32 v242, s58, v236
v_fmac_f32 v241, s57, v236
v_fmac_f32 v242, s57, v235
v_fmac_f32 v241, s56, v235
v_fmac_f32 v242, s56, v234
v_mul_f32 v241, v241, v239
v_mul_f32 v242, v242, v240
v_cvt_pk_bf16_f32 v243, v241, v242
ds_write_b32 v4, v243 offset:8322
ds_write_b16 v4, v243 offset:12480
ds_write_b16_d16_hi v4, v243 offset:12482
v_lshlrev_b32 v224, 16, v21
v_lshlrev_b32 v225, 16, v17
v_lshlrev_b32 v226, 16, v33
v_lshlrev_b32 v227, 16, v57
v_lshlrev_b32 v228, 16, v61
v_lshlrev_b32 v229, 16, v25
v_lshlrev_b32 v230, 16, v29
v_mul_f32 v231, s63, v228
v_mul_f32 v232, s63, v227
v_fmac_f32 v231, s62, v227
v_fmac_f32 v232, s62, v226
v_fmac_f32 v231, s61, v226
v_fmac_f32 v232, s61, v225
v_fmac_f32 v231, s60, v225
v_fmac_f32 v232, s60, v224
v_mul_f32 v231, v231, v229
v_mul_f32 v232, v232, v230
v_cvt_pk_bf16_f32 v233, v231, v232
ds_write_b32 v4, v233 offset:16642
ds_write_b16 v4, v233 offset:20800
ds_write_b16_d16_hi v4, v233 offset:20802
v_and_b32 v234, 0xffff0000, v21
v_and_b32 v235, 0xffff0000, v17
v_and_b32 v236, 0xffff0000, v33
v_and_b32 v237, 0xffff0000, v57
v_and_b32 v238, 0xffff0000, v61
v_and_b32 v239, 0xffff0000, v25
v_and_b32 v240, 0xffff0000, v29
v_mul_f32 v241, s67, v238
v_mul_f32 v242, s67, v237
v_fmac_f32 v241, s66, v237
v_fmac_f32 v242, s66, v236
v_fmac_f32 v241, s65, v236
v_fmac_f32 v242, s65, v235
v_fmac_f32 v241, s64, v235
v_fmac_f32 v242, s64, v234
v_mul_f32 v241, v241, v239
v_mul_f32 v242, v242, v240
v_cvt_pk_bf16_f32 v243, v241, v242
ds_write_b32 v4, v243 offset:24962
ds_write_b16 v4, v243 offset:29120
ds_write_b16_d16_hi v4, v243 offset:29122
v_lshlrev_b32 v224, 16, v22
v_lshlrev_b32 v225, 16, v18
v_lshlrev_b32 v226, 16, v34
v_lshlrev_b32 v227, 16, v58
v_lshlrev_b32 v228, 16, v62
v_lshlrev_b32 v229, 16, v26
v_lshlrev_b32 v230, 16, v30
v_mul_f32 v231, s71, v228
v_mul_f32 v232, s71, v227
v_fmac_f32 v231, s70, v227
v_fmac_f32 v232, s70, v226
v_fmac_f32 v231, s69, v226
v_fmac_f32 v232, s69, v225
v_fmac_f32 v231, s68, v225
v_fmac_f32 v232, s68, v224
v_mul_f32 v231, v231, v229
v_mul_f32 v232, v232, v230
v_cvt_pk_bf16_f32 v233, v231, v232
ds_write_b32 v4, v233 offset:33282
ds_write_b16 v4, v233 offset:37440
ds_write_b16_d16_hi v4, v233 offset:37442
v_and_b32 v234, 0xffff0000, v22
v_and_b32 v235, 0xffff0000, v18
v_and_b32 v236, 0xffff0000, v34
v_and_b32 v237, 0xffff0000, v58
v_and_b32 v238, 0xffff0000, v62
v_and_b32 v239, 0xffff0000, v26
v_and_b32 v240, 0xffff0000, v30
v_mul_f32 v241, s75, v238
v_mul_f32 v242, s75, v237
v_fmac_f32 v241, s74, v237
v_fmac_f32 v242, s74, v236
v_fmac_f32 v241, s73, v236
v_fmac_f32 v242, s73, v235
v_fmac_f32 v241, s72, v235
v_fmac_f32 v242, s72, v234
v_mul_f32 v241, v241, v239
v_mul_f32 v242, v242, v240
v_cvt_pk_bf16_f32 v243, v241, v242
ds_write_b32 v4, v243 offset:41602
ds_write_b16 v4, v243 offset:45760
ds_write_b16_d16_hi v4, v243 offset:45762
v_lshlrev_b32 v224, 16, v23
v_lshlrev_b32 v225, 16, v19
v_lshlrev_b32 v226, 16, v35
v_lshlrev_b32 v227, 16, v59
v_lshlrev_b32 v228, 16, v63
v_lshlrev_b32 v229, 16, v27
v_lshlrev_b32 v230, 16, v31
v_mul_f32 v231, s79, v228
v_mul_f32 v232, s79, v227
v_fmac_f32 v231, s78, v227
v_fmac_f32 v232, s78, v226
v_fmac_f32 v231, s77, v226
v_fmac_f32 v232, s77, v225
v_fmac_f32 v231, s76, v225
v_fmac_f32 v232, s76, v224
v_mul_f32 v231, v231, v229
v_mul_f32 v232, v232, v230
v_cvt_pk_bf16_f32 v233, v231, v232
ds_write_b32 v4, v233 offset:49922
ds_write_b16 v4, v233 offset:54080
ds_write_b16_d16_hi v4, v233 offset:54082
v_and_b32 v234, 0xffff0000, v23
v_and_b32 v235, 0xffff0000, v19
v_and_b32 v236, 0xffff0000, v35
v_and_b32 v237, 0xffff0000, v59
v_and_b32 v238, 0xffff0000, v63
v_and_b32 v239, 0xffff0000, v27
v_and_b32 v240, 0xffff0000, v31
v_mul_f32 v241, s83, v238
v_mul_f32 v242, s83, v237
v_fmac_f32 v241, s82, v237
v_fmac_f32 v242, s82, v236
v_fmac_f32 v241, s81, v236
v_fmac_f32 v242, s81, v235
v_fmac_f32 v241, s80, v235
v_fmac_f32 v242, s80, v234
v_mul_f32 v241, v241, v239
v_mul_f32 v242, v242, v240
v_cvt_pk_bf16_f32 v243, v241, v242
ds_write_b32 v4, v243 offset:58242
ds_write_b16 v4, v243 offset:62400
ds_write_b16_d16_hi v4, v243 offset:62402
s_waitcnt lgkmcnt(0)
s_barrier
ds_read2_b32 v[64:65], v6 offset0:0 offset1:1
ds_read2_b32 v[66:67], v6 offset0:2 offset1:3
ds_read2_b32 v[68:69], v6 offset0:16 offset1:17
ds_read2_b32 v[70:71], v6 offset0:18 offset1:19
ds_read2_b32 v[72:73], v6 offset0:32 offset1:33
ds_read2_b32 v[74:75], v6 offset0:34 offset1:35
ds_read2_b32 v[76:77], v6 offset0:48 offset1:49
ds_read2_b32 v[78:79], v6 offset0:50 offset1:51
ds_read2_b32 v[80:81], v6 offset0:64 offset1:65
ds_read2_b32 v[82:83], v6 offset0:66 offset1:67
ds_read2_b32 v[84:85], v6 offset0:80 offset1:81
ds_read2_b32 v[86:87], v6 offset0:82 offset1:83
ds_read2_b32 v[88:89], v6 offset0:96 offset1:97
ds_read2_b32 v[90:91], v6 offset0:98 offset1:99
ds_read2_b32 v[92:93], v6 offset0:112 offset1:113
ds_read2_b32 v[94:95], v6 offset0:114 offset1:115
s_waitcnt lgkmcnt(0)
v_mfma_f32_16x16x32_bf16 a[192:195], v[64:67], a[0:3], 0
ds_read2_b32 v[96:97], v6 offset0:128 offset1:129
v_mfma_f32_16x16x32_bf16 a[192:195], v[68:71], a[4:7], a[192:195]
ds_read2_b32 v[98:99], v6 offset0:130 offset1:131
v_mfma_f32_16x16x32_bf16 a[192:195], v[72:75], a[8:11], a[192:195]
ds_read2_b32 v[100:101], v6 offset0:144 offset1:145
v_mfma_f32_16x16x32_bf16 a[192:195], v[76:79], a[12:15], a[192:195]
ds_read2_b32 v[102:103], v6 offset0:146 offset1:147
v_mfma_f32_16x16x32_bf16 a[192:195], v[80:83], a[16:19], a[192:195]
ds_read2_b32 v[104:105], v6 offset0:160 offset1:161
v_mfma_f32_16x16x32_bf16 a[192:195], v[84:87], a[20:23], a[192:195]
ds_read2_b32 v[106:107], v6 offset0:162 offset1:163
v_mfma_f32_16x16x32_bf16 a[192:195], v[88:91], a[24:27], a[192:195]
ds_read2_b32 v[108:109], v6 offset0:176 offset1:177
v_mfma_f32_16x16x32_bf16 a[192:195], v[92:95], a[28:31], a[192:195]
v_mfma_f32_16x16x32_bf16 a[196:199], v[64:67], a[32:35], 0
ds_read2_b32 v[110:111], v6 offset0:178 offset1:179
v_mfma_f32_16x16x32_bf16 a[196:199], v[68:71], a[36:39], a[196:199]
ds_read2_b32 v[112:113], v6 offset0:192 offset1:193
v_mfma_f32_16x16x32_bf16 a[196:199], v[72:75], a[40:43], a[196:199]
ds_read2_b32 v[114:115], v6 offset0:194 offset1:195
v_mfma_f32_16x16x32_bf16 a[196:199], v[76:79], a[44:47], a[196:199]
ds_read2_b32 v[116:117], v6 offset0:208 offset1:209
v_mfma_f32_16x16x32_bf16 a[196:199], v[80:83], a[48:51], a[196:199]
s_add_u32 s97, s96, 2097152
ds_read2_b32 v[118:119], v6 offset0:210 offset1:211
v_mfma_f32_16x16x32_bf16 a[196:199], v[84:87], a[52:55], a[196:199]
ds_read2_b32 v[120:121], v6 offset0:224 offset1:225
v_mfma_f32_16x16x32_bf16 a[196:199], v[88:91], a[56:59], a[196:199]
ds_read2_b32 v[122:123], v6 offset0:226 offset1:227
v_mfma_f32_16x16x32_bf16 a[196:199], v[92:95], a[60:63], a[196:199]
ds_read2_b32 v[124:125], v6 offset0:240 offset1:241
v_mfma_f32_16x16x32_bf16 a[200:203], v[64:67], a[64:67], 0
s_sub_u32 s98, s97, 6144
v_accvgpr_read_b32 v248, a192
v_mfma_f32_16x16x32_bf16 a[200:203], v[68:71], a[68:71], a[200:203]
ds_read2_b32 v[126:127], v6 offset0:242 offset1:243
v_accvgpr_read_b32 v249, a193
v_mfma_f32_16x16x32_bf16 a[200:203], v[72:75], a[72:75], a[200:203]
v_accvgpr_read_b32 v250, a194
v_accvgpr_read_b32 v251, a195
v_mfma_f32_16x16x32_bf16 a[200:203], v[76:79], a[76:79], a[200:203]
v_cvt_pk_bf16_f32 v244, v248, v249
v_cvt_pk_bf16_f32 v245, v250, v251
v_mfma_f32_16x16x32_bf16 a[200:203], v[80:83], a[80:83], a[200:203]
buffer_load_dwordx4 v[32:35], v3, s[24:27], s98 offen
v_mfma_f32_16x16x32_bf16 a[200:203], v[84:87], a[84:87], a[200:203]
ds_read2_b32 v[128:129], v9 offset0:0 offset1:1
v_mfma_f32_16x16x32_bf16 a[200:203], v[88:91], a[88:91], a[200:203]
ds_write_b64 v7, v[244:245] offset:0
v_mfma_f32_16x16x32_bf16 a[200:203], v[92:95], a[92:95], a[200:203]
ds_read2_b32 v[130:131], v9 offset0:2 offset1:3
s_waitcnt lgkmcnt(3)
v_mfma_f32_16x16x32_bf16 a[196:199], v[96:99], a[0:3], a[196:199]
v_mfma_f32_16x16x32_bf16 a[196:199], v[100:103], a[4:7], a[196:199]
buffer_load_dwordx4 v[16:19], v2, s[24:27], s97 offen
v_mfma_f32_16x16x32_bf16 a[196:199], v[104:107], a[8:11], a[196:199]
ds_read2_b32 v[132:133], v9 offset0:16 offset1:17
v_mfma_f32_16x16x32_bf16 a[196:199], v[108:111], a[12:15], a[196:199]
v_mfma_f32_16x16x32_bf16 a[196:199], v[112:115], a[16:19], a[196:199]
v_mfma_f32_16x16x32_bf16 a[196:199], v[116:119], a[20:23], a[196:199]
buffer_load_dwordx4 v[20:23], v2, s[24:27], s97 offen offset:2048
v_mfma_f32_16x16x32_bf16 a[196:199], v[120:123], a[24:27], a[196:199]
ds_read2_b32 v[134:135], v9 offset0:18 offset1:19
s_waitcnt vmcnt(3)
v_mfma_f32_16x16x32_bf16 a[196:199], v[124:127], a[28:31], a[196:199]
v_mov_b32_dpp v56, v52 row_shl:1 row_mask:0xf bank_mask:0xf
v_mov_b32_dpp v57, v53 row_shl:1 row_mask:0xf bank_mask:0xf
v_mfma_f32_16x16x32_bf16 a[200:203], v[96:99], a[32:35], a[200:203]
ds_read_b128 v[192:195], v5 offset:2048
v_mov_b32_dpp v58, v54 row_shl:1 row_mask:0xf bank_mask:0xf
v_mfma_f32_16x16x32_bf16 a[200:203], v[100:103], a[36:39], a[200:203]
ds_read2_b32 v[136:137], v9 offset0:32 offset1:33
v_mov_b32_dpp v59, v55 row_shl:1 row_mask:0xf bank_mask:0xf
v_mfma_f32_16x16x32_bf16 a[200:203], v[104:107], a[40:43], a[200:203]
ds_read_b128 v[196:199], v5 offset:2112
v_mov_b32_dpp v60, v52 row_shl:2 row_mask:0xf bank_mask:0xf
v_mov_b32_dpp v61, v53 row_shl:2 row_mask:0xf bank_mask:0xf
v_mfma_f32_16x16x32_bf16 a[200:203], v[108:111], a[44:47], a[200:203]
buffer_load_dwordx4 v[24:27], v2, s[28:31], s97 offen
ds_read_b128 v[200:203], v5 offset:2176
v_mov_b32_dpp v62, v54 row_shl:2 row_mask:0xf bank_mask:0xf
v_mfma_f32_16x16x32_bf16 a[200:203], v[112:115], a[48:51], a[200:203]
ds_read_b128 v[204:207], v5 offset:2240
ds_read2_b32 v[138:139], v9 offset0:34 offset1:35
v_mov_b32_dpp v63, v55 row_shl:2 row_mask:0xf bank_mask:0xf
v_mov_b32_dpp v52, v40 wave_shr:1 row_mask:0xf bank_mask:0xf
v_mfma_f32_16x16x32_bf16 a[200:203], v[116:119], a[52:55], a[200:203]
ds_read_b128 v[208:211], v5 offset:2304
v_mov_b32_dpp v53, v41 wave_shr:1 row_mask:0xf bank_mask:0xf
v_mfma_f32_16x16x32_bf16 a[200:203], v[120:123], a[56:59], a[200:203]
ds_read_b128 v[212:215], v5 offset:2368
v_mov_b32_dpp v54, v42 wave_shr:1 row_mask:0xf bank_mask:0xf
v_mov_b32_dpp v55, v43 wave_shr:1 row_mask:0xf bank_mask:0xf
v_mfma_f32_16x16x32_bf16 a[200:203], v[124:127], a[60:63], a[200:203]
ds_read_b128 v[216:219], v5 offset:2432
ds_read2_b32 v[140:141], v9 offset0:48 offset1:49
v_mov_b32_dpp v56, v36 wave_shr:1 row_mask:0xf bank_mask:0xf
v_mfma_f32_16x16x32_bf16 a[204:207], v[96:99], a[64:67], 0
buffer_load_dwordx4 v[28:31], v2, s[28:31], s97 offen offset:2048
ds_read_b128 v[220:223], v5 offset:2496
v_mov_b32_dpp v57, v37 wave_shr:1 row_mask:0xf bank_mask:0xf
v_mfma_f32_16x16x32_bf16 a[204:207], v[100:103], a[68:71], a[204:207]
v_mov_b32_dpp v58, v38 wave_shr:1 row_mask:0xf bank_mask:0xf
v_mov_b32_dpp v59, v39 wave_shr:1 row_mask:0xf bank_mask:0xf
v_mfma_f32_16x16x32_bf16 a[204:207], v[104:107], a[72:75], a[204:207]
ds_read2_b32 v[142:143], v9 offset0:50 offset1:51
v_mov_b32_dpp v60, v52 wave_shr:1 row_mask:0xf bank_mask:0xf
v_mfma_f32_16x16x32_bf16 a[204:207], v[108:111], a[76:79], a[204:207]
v_mov_b32_dpp v61, v53 wave_shr:1 row_mask:0xf bank_mask:0xf
v_mov_b32_dpp v62, v54 wave_shr:1 row_mask:0xf bank_mask:0xf
v_mfma_f32_16x16x32_bf16 a[204:207], v[112:115], a[80:83], a[204:207]
ds_read2_b32 v[144:145], v9 offset0:64 offset1:65
v_mov_b32_dpp v63, v55 wave_shr:1 row_mask:0xf bank_mask:0xf
v_mfma_f32_16x16x32_bf16 a[204:207], v[116:119], a[84:87], a[204:207]
v_lshlrev_b32 v224, 16, v40
v_lshlrev_b32 v225, 16, v36
v_mfma_f32_16x16x32_bf16 a[204:207], v[120:123], a[88:91], a[204:207]
v_lshlrev_b32 v226, 16, v52
v_accvgpr_read_b32 v248, a196
v_mfma_f32_16x16x32_bf16 a[204:207], v[124:127], a[92:95], a[204:207]
v_lshlrev_b32 v227, 16, v56
v_lshlrev_b32 v228, 16, v60
v_accvgpr_read_b32 v249, a197
s_waitcnt lgkmcnt(8)
v_mfma_f32_16x16x32_bf16 a[204:207], v[64:67], v[192:195], a[204:207]
ds_read2_b32 v[146:147], v9 offset0:66 offset1:67
v_lshlrev_b32 v229, 16, v44
v_mfma_f32_16x16x32_bf16 a[208:211], v[96:99], v[192:195], 0
v_lshlrev_b32 v230, 16, v48
v_mul_f32 v231, s55, v228
v_accvgpr_read_b32 v250, a198
v_mfma_f32_16x16x32_bf16 a[204:207], v[68:71], v[196:199], a[204:207]
ds_read_b128 v[192:195], v5 offset:1536
v_mul_f32 v232, s55, v227
v_accvgpr_read_b32 v251, a199
v_mfma_f32_16x16x32_bf16 a[208:211], v[100:103], v[196:199], a[208:211]
ds_read2_b32 v[148:149], v9 offset0:80 offset1:81
v_fmac_f32 v231, s54, v227
v_mfma_f32_16x16x32_bf16 a[204:207], v[72:75], v[200:203], a[204:207]
ds_read_b128 v[196:199], v5 offset:1600
v_fmac_f32 v232, s54, v226
v_fmac_f32 v231, s53, v226
v_cvt_pk_bf16_f32 v246, v248, v249
v_mfma_f32_16x16x32_bf16 a[208:211], v[104:107], v[200:203], a[208:211]
v_fmac_f32 v232, s53, v225
v_cvt_pk_bf16_f32 v247, v250, v251
v_mfma_f32_16x16x32_bf16 a[204:207], v[76:79], v[204:207], a[204:207]
ds_read_b128 v[200:203], v5 offset:1664
ds_read2_b32 v[150:151], v9 offset0:82 offset1:83
v_fmac_f32 v231, s52, v225
v_fmac_f32 v232, s52, v224
v_mfma_f32_16x16x32_bf16 a[208:211], v[108:111], v[204:207], a[208:211]
ds_write_b64 v7, v[246:247] offset:4608
v_mul_f32 v231, v231, v229
s_waitcnt lgkmcnt(9)
v_mfma_f32_16x16x32_bf16 a[204:207], v[80:83], v[208:211], a[204:207]
ds_read_b128 v[204:207], v5 offset:1728
v_mul_f32 v232, v232, v230
v_cvt_pk_bf16_f32 v233, v231, v232
v_mfma_f32_16x16x32_bf16 a[208:211], v[112:115], v[208:211], a[208:211]
ds_read2_b32 v[152:153], v9 offset0:96 offset1:97
ds_write_b32 v4, v233 offset:1026
v_mfma_f32_16x16x32_bf16 a[204:207], v[84:87], v[212:215], a[204:207]
ds_read_b128 v[208:211], v5 offset:1792
ds_write_b16 v4, v233 offset:5184
ds_write_b16_d16_hi v4, v233 offset:5186
v_mfma_f32_16x16x32_bf16 a[208:211], v[116:119], v[212:215], a[208:211]
ds_read_b128 v[212:215], v5 offset:1856
v_and_b32 v234, 0xffff0000, v40
v_mfma_f32_16x16x32_bf16 a[204:207], v[88:91], v[216:219], a[204:207]
ds_read2_b32 v[154:155], v9 offset0:98 offset1:99
v_and_b32 v235, 0xffff0000, v36
v_and_b32 v236, 0xffff0000, v52
v_mfma_f32_16x16x32_bf16 a[208:211], v[120:123], v[216:219], a[208:211]
ds_read_b128 v[216:219], v5 offset:1920
v_and_b32 v237, 0xffff0000, v56
v_mfma_f32_16x16x32_bf16 a[204:207], v[92:95], v[220:223], a[204:207]
ds_read2_b32 v[156:157], v9 offset0:112 offset1:113
v_and_b32 v238, 0xffff0000, v60
v_mfma_f32_16x16x32_bf16 a[208:211], v[124:127], v[220:223], a[208:211]
v_and_b32 v239, 0xffff0000, v44
v_and_b32 v240, 0xffff0000, v48
s_waitcnt lgkmcnt(9)
v_mfma_f32_16x16x32_bf16 a[208:211], v[64:67], v[192:195], a[208:211]
ds_read_b128 v[220:223], v5 offset:1984
v_mul_f32 v241, s59, v238
v_mfma_f32_16x16x32_bf16 a[212:215], v[96:99], v[192:195], 0
v_mul_f32 v242, s59, v237
v_fmac_f32 v241, s58, v237
v_mfma_f32_16x16x32_bf16 a[208:211], v[68:71], v[196:199], a[208:211]
ds_read_b128 v[192:195], v5 offset:1024
ds_read2_b32 v[158:159], v9 offset0:114 offset1:115
v_fmac_f32 v242, s58, v236
v_mfma_f32_16x16x32_bf16 a[212:215], v[100:103], v[196:199], a[212:215]
v_fmac_f32 v241, s57, v236
v_fmac_f32 v242, s57, v235
v_mfma_f32_16x16x32_bf16 a[208:211], v[72:75], v[200:203], a[208:211]
ds_read_b128 v[196:199], v5 offset:1088
v_fmac_f32 v241, s56, v235
v_mfma_f32_16x16x32_bf16 a[212:215], v[104:107], v[200:203], a[212:215]
ds_read2_b32 v[160:161], v9 offset0:128 offset1:129
v_fmac_f32 v242, s56, v234
v_mul_f32 v241, v241, v239
v_mfma_f32_16x16x32_bf16 a[208:211], v[76:79], v[204:207], a[208:211]
ds_read_b128 v[200:203], v5 offset:1152
v_mul_f32 v242, v242, v240
v_mfma_f32_16x16x32_bf16 a[212:215], v[108:111], v[204:207], a[212:215]
v_cvt_pk_bf16_f32 v243, v241, v242
ds_write_b32 v4, v243 offset:9346
s_waitcnt lgkmcnt(6)
v_mfma_f32_16x16x32_bf16 a[208:211], v[80:83], v[208:211], a[208:211]
ds_read_b128 v[204:207], v5 offset:1216
ds_read2_b32 v[162:163], v9 offset0:130 offset1:131
ds_write_b16 v4, v243 offset:13504
v_mfma_f32_16x16x32_bf16 a[212:215], v[112:115], v[208:211], a[212:215]
ds_write_b16_d16_hi v4, v243 offset:13506
v_mfma_f32_16x16x32_bf16 a[208:211], v[84:87], v[212:215], a[208:211]
ds_read_b128 v[208:211], v5 offset:1280
v_lshlrev_b32 v224, 16, v41
v_lshlrev_b32 v225, 16, v37
v_mfma_f32_16x16x32_bf16 a[212:215], v[116:119], v[212:215], a[212:215]
ds_read2_b32 v[164:165], v9 offset0:144 offset1:145
v_lshlrev_b32 v226, 16, v53
v_mfma_f32_16x16x32_bf16 a[208:211], v[88:91], v[216:219], a[208:211]
ds_read_b128 v[212:215], v5 offset:1344
v_lshlrev_b32 v227, 16, v57
v_lshlrev_b32 v228, 16, v61
v_mfma_f32_16x16x32_bf16 a[212:215], v[120:123], v[216:219], a[212:215]
ds_read_b128 v[216:219], v5 offset:1408
v_lshlrev_b32 v229, 16, v45
v_mfma_f32_16x16x32_bf16 a[208:211], v[92:95], v[220:223], a[208:211]
ds_read2_b32 v[166:167], v9 offset0:146 offset1:147
v_lshlrev_b32 v230, 16, v49
v_mul_f32 v231, s63, v228
v_mfma_f32_16x16x32_bf16 a[212:215], v[124:127], v[220:223], a[212:215]
v_mul_f32 v232, s63, v227
s_waitcnt lgkmcnt(8)
v_mfma_f32_16x16x32_bf16 a[212:215], v[64:67], v[192:195], a[212:215]
ds_read_b128 v[220:223], v5 offset:1472
v_fmac_f32 v231, s62, v227
v_fmac_f32 v232, s62, v226
v_mfma_f32_16x16x32_bf16 a[216:219], v[96:99], v[192:195], 0
ds_read2_b32 v[168:169], v9 offset0:160 offset1:161
v_fmac_f32 v231, s61, v226
v_mfma_f32_16x16x32_bf16 a[212:215], v[68:71], v[196:199], a[212:215]
ds_read_b128 v[192:195], v5 offset:512
v_fmac_f32 v232, s61, v225
v_fmac_f32 v231, s60, v225
v_mfma_f32_16x16x32_bf16 a[216:219], v[100:103], v[196:199], a[216:219]
ds_read_b128 v[196:199], v5 offset:576
v_fmac_f32 v232, s60, v224
v_mfma_f32_16x16x32_bf16 a[212:215], v[72:75], v[200:203], a[212:215]
ds_read2_b32 v[170:171], v9 offset0:162 offset1:163
v_mul_f32 v231, v231, v229
v_mfma_f32_16x16x32_bf16 a[216:219], v[104:107], v[200:203], a[216:219]
v_mul_f32 v232, v232, v230
v_cvt_pk_bf16_f32 v233, v231, v232
v_mfma_f32_16x16x32_bf16 a[212:215], v[76:79], v[204:207], a[212:215]
ds_read_b128 v[200:203], v5 offset:640
ds_write_b32 v4, v233 offset:17666
v_mfma_f32_16x16x32_bf16 a[216:219], v[108:111], v[204:207], a[216:219]
ds_read2_b32 v[172:173], v9 offset0:176 offset1:177
ds_write_b16 v4, v233 offset:21824
ds_write_b16_d16_hi v4, v233 offset:21826
s_waitcnt lgkmcnt(9)
v_mfma_f32_16x16x32_bf16 a[212:215], v[80:83], v[208:211], a[212:215]
ds_read_b128 v[204:207], v5 offset:704
v_and_b32 v234, 0xffff0000, v41
v_mfma_f32_16x16x32_bf16 a[216:219], v[112:115], v[208:211], a[216:219]
v_and_b32 v235, 0xffff0000, v37
v_and_b32 v236, 0xffff0000, v53
v_mfma_f32_16x16x32_bf16 a[212:215], v[84:87], v[212:215], a[212:215]
ds_read_b128 v[208:211], v5 offset:768
ds_read2_b32 v[174:175], v9 offset0:178 offset1:179
v_and_b32 v237, 0xffff0000, v57
v_mfma_f32_16x16x32_bf16 a[216:219], v[116:119], v[212:215], a[216:219]
v_and_b32 v238, 0xffff0000, v61
v_and_b32 v239, 0xffff0000, v45
v_mfma_f32_16x16x32_bf16 a[212:215], v[88:91], v[216:219], a[212:215]
ds_read_b128 v[212:215], v5 offset:832
v_and_b32 v240, 0xffff0000, v49
v_mfma_f32_16x16x32_bf16 a[216:219], v[120:123], v[216:219], a[216:219]
ds_read2_b32 v[176:177], v9 offset0:192 offset1:193
v_mul_f32 v241, s67, v238
v_mul_f32 v242, s67, v237
v_mfma_f32_16x16x32_bf16 a[212:215], v[92:95], v[220:223], a[212:215]
ds_read_b128 v[216:219], v5 offset:896
v_fmac_f32 v241, s66, v237
v_mfma_f32_16x16x32_bf16 a[216:219], v[124:127], v[220:223], a[216:219]
v_fmac_f32 v242, s66, v236
s_waitcnt lgkmcnt(5)
v_mfma_f32_16x16x32_bf16 a[216:219], v[64:67], v[192:195], a[216:219]
ds_read_b128 v[220:223], v5 offset:960
ds_read2_b32 v[178:179], v9 offset0:194 offset1:195
v_fmac_f32 v241, s65, v236
v_fmac_f32 v242, s65, v235
v_mfma_f32_16x16x32_bf16 a[220:223], v[96:99], v[192:195], 0
ds_read_b128 v[192:195], v5 offset:0
v_fmac_f32 v241, s64, v235
v_mfma_f32_16x16x32_bf16 a[216:219], v[68:71], v[196:199], a[216:219]
v_fmac_f32 v242, s64, v234
v_mul_f32 v241, v241, v239
v_mfma_f32_16x16x32_bf16 a[220:223], v[100:103], v[196:199], a[220:223]
ds_read2_b32 v[180:181], v9 offset0:208 offset1:209
v_mul_f32 v242, v242, v240
v_mfma_f32_16x16x32_bf16 a[216:219], v[72:75], v[200:203], a[216:219]
ds_read_b128 v[196:199], v5 offset:64
v_cvt_pk_bf16_f32 v243, v241, v242
v_mfma_f32_16x16x32_bf16 a[220:223], v[104:107], v[200:203], a[220:223]
ds_write_b32 v4, v243 offset:25986
ds_write_b16 v4, v243 offset:30144
v_mfma_f32_16x16x32_bf16 a[216:219], v[76:79], v[204:207], a[216:219]
ds_read_b128 v[200:203], v5 offset:128
ds_read2_b32 v[182:183], v9 offset0:210 offset1:211
ds_write_b16_d16_hi v4, v243 offset:30146
v_lshlrev_b32 v224, 16, v42
v_mfma_f32_16x16x32_bf16 a[220:223], v[108:111], v[204:207], a[220:223]
v_lshlrev_b32 v225, 16, v38
s_waitcnt lgkmcnt(9)
v_mfma_f32_16x16x32_bf16 a[216:219], v[80:83], v[208:211], a[216:219]
ds_read_b128 v[204:207], v5 offset:192
v_lshlrev_b32 v226, 16, v54
v_lshlrev_b32 v227, 16, v58
v_mfma_f32_16x16x32_bf16 a[220:223], v[112:115], v[208:211], a[220:223]
ds_read2_b32 v[184:185], v9 offset0:224 offset1:225
v_lshlrev_b32 v228, 16, v62
v_mfma_f32_16x16x32_bf16 a[216:219], v[84:87], v[212:215], a[216:219]
ds_read_b128 v[208:211], v5 offset:256
v_lshlrev_b32 v229, 16, v46
v_mfma_f32_16x16x32_bf16 a[220:223], v[116:119], v[212:215], a[220:223]
v_lshlrev_b32 v230, 16, v50
v_mul_f32 v231, s71, v228
v_mfma_f32_16x16x32_bf16 a[216:219], v[88:91], v[216:219], a[216:219]
ds_read_b128 v[212:215], v5 offset:320
ds_read2_b32 v[186:187], v9 offset0:226 offset1:227
v_mul_f32 v232, s71, v227
v_mfma_f32_16x16x32_bf16 a[220:223], v[120:123], v[216:219], a[220:223]
v_fmac_f32 v231, s70, v227
v_fmac_f32 v232, s70, v226
v_mfma_f32_16x16x32_bf16 a[216:219], v[92:95], v[220:223], a[216:219]
ds_read_b128 v[216:219], v5 offset:384
v_fmac_f32 v231, s69, v226
v_mfma_f32_16x16x32_bf16 a[220:223], v[124:127], v[220:223], a[220:223]
ds_read2_b32 v[188:189], v9 offset0:240 offset1:241
v_fmac_f32 v232, s69, v225
v_fmac_f32 v231, s68, v225
s_waitcnt lgkmcnt(6)
v_mfma_f32_16x16x32_bf16 a[220:223], v[64:67], v[192:195], a[220:223]
ds_read_b128 v[220:223], v5 offset:448
v_fmac_f32 v232, s68, v224
v_mfma_f32_16x16x32_bf16 a[220:223], v[68:71], v[196:199], a[220:223]
v_mul_f32 v231, v231, v229
v_mul_f32 v232, v232, v230
v_mfma_f32_16x16x32_bf16 a[220:223], v[72:75], v[200:203], a[220:223]
ds_read2_b32 v[190:191], v9 offset0:242 offset1:243
v_cvt_pk_bf16_f32 v233, v231, v232
v_mfma_f32_16x16x32_bf16 a[220:223], v[76:79], v[204:207], a[220:223]
ds_write_b32 v4, v233 offset:34306
ds_write_b16 v4, v233 offset:38464
s_waitcnt lgkmcnt(3)
v_mfma_f32_16x16x32_bf16 a[220:223], v[80:83], v[208:211], a[220:223]
ds_write_b16_d16_hi v4, v233 offset:38466
v_mfma_f32_16x16x32_bf16 a[220:223], v[84:87], v[212:215], a[220:223]
v_and_b32 v234, 0xffff0000, v42
v_and_b32 v235, 0xffff0000, v38
v_mfma_f32_16x16x32_bf16 a[220:223], v[88:91], v[216:219], a[220:223]
v_and_b32 v236, 0xffff0000, v54
v_and_b32 v237, 0xffff0000, v58
v_mfma_f32_16x16x32_bf16 a[220:223], v[92:95], v[220:223], a[220:223]
v_and_b32 v238, 0xffff0000, v62
v_mfma_f32_16x16x32_bf16 a[224:227], v[128:131], a[96:99], 0
v_and_b32 v239, 0xffff0000, v46
v_add_u32 v6, 0x400, v6
v_mfma_f32_16x16x32_bf16 a[224:227], v[132:135], a[100:103], a[224:227]
v_and_b32 v240, 0xffff0000, v50
v_add_u32 v9, 0x400, v9
v_mfma_f32_16x16x32_bf16 a[224:227], v[136:139], a[104:107], a[224:227]
v_mul_f32 v241, s75, v238
v_mul_f32 v242, s75, v237
v_mfma_f32_16x16x32_bf16 a[224:227], v[140:143], a[108:111], a[224:227]
v_fmac_f32 v241, s74, v237
v_fmac_f32 v242, s74, v236
v_mfma_f32_16x16x32_bf16 a[224:227], v[144:147], a[112:115], a[224:227]
v_fmac_f32 v241, s73, v236
v_fmac_f32 v242, s73, v235
v_mfma_f32_16x16x32_bf16 a[224:227], v[148:151], a[116:119], a[224:227]
v_fmac_f32 v241, s72, v235
v_fmac_f32 v242, s72, v234
v_mfma_f32_16x16x32_bf16 a[224:227], v[152:155], a[120:123], a[224:227]
v_mul_f32 v241, v241, v239
v_mul_f32 v242, v242, v240
v_mfma_f32_16x16x32_bf16 a[224:227], v[156:159], a[124:127], a[224:227]
v_cvt_pk_bf16_f32 v243, v241, v242
v_mfma_f32_16x16x32_bf16 a[228:231], v[128:131], a[128:131], 0
ds_write_b32 v4, v243 offset:42626
v_mfma_f32_16x16x32_bf16 a[228:231], v[132:135], a[132:135], a[228:231]
ds_write_b16 v4, v243 offset:46784
v_mfma_f32_16x16x32_bf16 a[228:231], v[136:139], a[136:139], a[228:231]
ds_write_b16_d16_hi v4, v243 offset:46786
v_mfma_f32_16x16x32_bf16 a[228:231], v[140:143], a[140:143], a[228:231]
v_lshlrev_b32 v224, 16, v43
v_lshlrev_b32 v225, 16, v39
v_mfma_f32_16x16x32_bf16 a[228:231], v[144:147], a[144:147], a[228:231]
v_lshlrev_b32 v226, 16, v55
v_lshlrev_b32 v227, 16, v59
v_mfma_f32_16x16x32_bf16 a[228:231], v[148:151], a[148:151], a[228:231]
v_lshlrev_b32 v228, 16, v63
v_lshlrev_b32 v229, 16, v47
v_mfma_f32_16x16x32_bf16 a[228:231], v[152:155], a[152:155], a[228:231]
v_lshlrev_b32 v230, 16, v51
v_mul_f32 v231, s79, v228
v_mfma_f32_16x16x32_bf16 a[228:231], v[156:159], a[156:159], a[228:231]
v_mul_f32 v232, s79, v227
v_fmac_f32 v231, s78, v227
v_mfma_f32_16x16x32_bf16 a[232:235], v[128:131], a[160:163], 0
v_fmac_f32 v232, s78, v226
v_fmac_f32 v231, s77, v226
v_mfma_f32_16x16x32_bf16 a[232:235], v[132:135], a[164:167], a[232:235]
v_fmac_f32 v232, s77, v225
v_fmac_f32 v231, s76, v225
v_mfma_f32_16x16x32_bf16 a[232:235], v[136:139], a[168:171], a[232:235]
v_fmac_f32 v232, s76, v224
v_mul_f32 v231, v231, v229
v_mfma_f32_16x16x32_bf16 a[232:235], v[140:143], a[172:175], a[232:235]
v_mul_f32 v232, v232, v230
v_cvt_pk_bf16_f32 v233, v231, v232
v_mfma_f32_16x16x32_bf16 a[232:235], v[144:147], a[176:179], a[232:235]
ds_write_b32 v4, v233 offset:50946
v_mfma_f32_16x16x32_bf16 a[232:235], v[148:151], a[180:183], a[232:235]
ds_write_b16 v4, v233 offset:55104
v_mfma_f32_16x16x32_bf16 a[232:235], v[152:155], a[184:187], a[232:235]
v_accvgpr_read_b32 v248, a224
v_accvgpr_read_b32 v249, a225
v_mfma_f32_16x16x32_bf16 a[232:235], v[156:159], a[188:191], a[232:235]
v_accvgpr_read_b32 v250, a226
s_waitcnt lgkmcnt(8)
v_mfma_f32_16x16x32_bf16 a[228:231], v[160:163], a[96:99], a[228:231]
ds_write_b16_d16_hi v4, v233 offset:55106
v_mfma_f32_16x16x32_bf16 a[228:231], v[164:167], a[100:103], a[228:231]
v_and_b32 v234, 0xffff0000, v43
v_and_b32 v235, 0xffff0000, v39
v_mfma_f32_16x16x32_bf16 a[228:231], v[168:171], a[104:107], a[228:231]
v_accvgpr_read_b32 v251, a227
v_and_b32 v236, 0xffff0000, v55
v_mfma_f32_16x16x32_bf16 a[228:231], v[172:175], a[108:111], a[228:231]
v_and_b32 v237, 0xffff0000, v59
v_and_b32 v238, 0xffff0000, v63
v_mfma_f32_16x16x32_bf16 a[228:231], v[176:179], a[112:115], a[228:231]
v_cvt_pk_bf16_f32 v244, v248, v249
v_and_b32 v239, 0xffff0000, v47
v_mfma_f32_16x16x32_bf16 a[228:231], v[180:183], a[116:119], a[228:231]
v_cvt_pk_bf16_f32 v245, v250, v251
v_and_b32 v240, 0xffff0000, v51
v_mfma_f32_16x16x32_bf16 a[228:231], v[184:187], a[120:123], a[228:231]
v_mul_f32 v241, s83, v238
v_mul_f32 v242, s83, v237
v_mfma_f32_16x16x32_bf16 a[228:231], v[188:191], a[124:127], a[228:231]
ds_write_b64 v7, v[244:245] offset:16
v_mfma_f32_16x16x32_bf16 a[232:235], v[160:163], a[128:131], a[232:235]
ds_read_b128 v[192:195], v5 offset:6656
v_fmac_f32 v241, s82, v237
v_mfma_f32_16x16x32_bf16 a[232:235], v[164:167], a[132:135], a[232:235]
v_fmac_f32 v242, s82, v236
v_fmac_f32 v241, s81, v236
v_mfma_f32_16x16x32_bf16 a[232:235], v[168:171], a[136:139], a[232:235]
ds_read_b128 v[196:199], v5 offset:6720
v_fmac_f32 v242, s81, v235
v_mfma_f32_16x16x32_bf16 a[232:235], v[172:175], a[140:143], a[232:235]
ds_read_b128 v[200:203], v5 offset:6784
v_fmac_f32 v241, s80, v235
v_fmac_f32 v242, s80, v234
v_mfma_f32_16x16x32_bf16 a[232:235], v[176:179], a[144:147], a[232:235]
ds_read_b128 v[204:207], v5 offset:6848
v_mul_f32 v241, v241, v239
v_mfma_f32_16x16x32_bf16 a[232:235], v[180:183], a[148:151], a[232:235]
ds_read_b128 v[208:211], v5 offset:6912
v_mul_f32 v242, v242, v240
v_cvt_pk_bf16_f32 v243, v241, v242
v_mfma_f32_16x16x32_bf16 a[232:235], v[184:187], a[152:155], a[232:235]
ds_read_b128 v[212:215], v5 offset:6976
ds_write_b32 v4, v243 offset:59266
v_mfma_f32_16x16x32_bf16 a[232:235], v[188:191], a[156:159], a[232:235]
ds_read_b128 v[216:219], v5 offset:7040
ds_write_b16 v4, v243 offset:63424
v_mfma_f32_16x16x32_bf16 a[236:239], v[160:163], a[160:163], 0
ds_read_b128 v[220:223], v5 offset:7104
ds_write_b16_d16_hi v4, v243 offset:63426
s_waitcnt vmcnt(0)
v_mfma_f32_16x16x32_bf16 a[236:239], v[164:167], a[164:167], a[236:239]
v_mov_b32_dpp v56, v32 row_shl:1 row_mask:0xf bank_mask:0xf
v_mov_b32_dpp v57, v33 row_shl:1 row_mask:0xf bank_mask:0xf
v_mfma_f32_16x16x32_bf16 a[236:239], v[168:171], a[168:171], a[236:239]
v_mov_b32_dpp v58, v34 row_shl:1 row_mask:0xf bank_mask:0xf
v_mov_b32_dpp v59, v35 row_shl:1 row_mask:0xf bank_mask:0xf
v_mfma_f32_16x16x32_bf16 a[236:239], v[172:175], a[172:175], a[236:239]
s_add_u32 s97, s96, 3145728
v_mov_b32_dpp v60, v32 row_shl:2 row_mask:0xf bank_mask:0xf
v_mfma_f32_16x16x32_bf16 a[236:239], v[176:179], a[176:179], a[236:239]
v_mov_b32_dpp v61, v33 row_shl:2 row_mask:0xf bank_mask:0xf
v_mov_b32_dpp v62, v34 row_shl:2 row_mask:0xf bank_mask:0xf
v_mfma_f32_16x16x32_bf16 a[236:239], v[180:183], a[180:183], a[236:239]
v_mov_b32_dpp v63, v35 row_shl:2 row_mask:0xf bank_mask:0xf
v_mov_b32_dpp v32, v20 wave_shr:1 row_mask:0xf bank_mask:0xf
v_mfma_f32_16x16x32_bf16 a[236:239], v[184:187], a[184:187], a[236:239]
v_accvgpr_read_b32 v248, a228
v_mov_b32_dpp v33, v21 wave_shr:1 row_mask:0xf bank_mask:0xf
v_mfma_f32_16x16x32_bf16 a[236:239], v[188:191], a[188:191], a[236:239]
v_accvgpr_read_b32 v249, a229
s_waitcnt lgkmcnt(7)
v_mfma_f32_16x16x32_bf16 a[236:239], v[128:131], v[192:195], a[236:239]
s_sub_u32 s98, s97, 6144
v_mov_b32_dpp v34, v22 wave_shr:1 row_mask:0xf bank_mask:0xf
v_mfma_f32_16x16x32_bf16 a[240:243], v[160:163], v[192:195], 0
v_mov_b32_dpp v35, v23 wave_shr:1 row_mask:0xf bank_mask:0xf
v_accvgpr_read_b32 v250, a230
v_mfma_f32_16x16x32_bf16 a[236:239], v[132:135], v[196:199], a[236:239]
ds_read_b128 v[192:195], v5 offset:6144
v_mov_b32_dpp v56, v16 wave_shr:1 row_mask:0xf bank_mask:0xf
v_accvgpr_read_b32 v251, a231
v_mfma_f32_16x16x32_bf16 a[240:243], v[164:167], v[196:199], a[240:243]
v_mov_b32_dpp v57, v17 wave_shr:1 row_mask:0xf bank_mask:0xf
v_mov_b32_dpp v58, v18 wave_shr:1 row_mask:0xf bank_mask:0xf
v_mfma_f32_16x16x32_bf16 a[236:239], v[136:139], v[200:203], a[236:239]
ds_read_b128 v[196:199], v5 offset:6208
v_mov_b32_dpp v59, v19 wave_shr:1 row_mask:0xf bank_mask:0xf
v_cvt_pk_bf16_f32 v246, v248, v249
v_mfma_f32_16x16x32_bf16 a[240:243], v[168:171], v[200:203], a[240:243]
buffer_load_dwordx4 v[52:55], v3, s[24:27], s98 offen
v_mov_b32_dpp v60, v32 wave_shr:1 row_mask:0xf bank_mask:0xf
v_cvt_pk_bf16_f32 v247, v250, v251
v_mfma_f32_16x16x32_bf16 a[236:239], v[140:143], v[204:207], a[236:239]
ds_read_b128 v[200:203], v5 offset:6272
v_mov_b32_dpp v61, v33 wave_shr:1 row_mask:0xf bank_mask:0xf
v_mov_b32_dpp v62, v34 wave_shr:1 row_mask:0xf bank_mask:0xf
v_mfma_f32_16x16x32_bf16 a[240:243], v[172:175], v[204:207], a[240:243]
ds_write_b64 v7, v[246:247] offset:4624
v_mov_b32_dpp v63, v35 wave_shr:1 row_mask:0xf bank_mask:0xf
s_waitcnt lgkmcnt(5)
v_mfma_f32_16x16x32_bf16 a[236:239], v[144:147], v[208:211], a[236:239]
ds_read_b128 v[204:207], v5 offset:6336
v_lshlrev_b32 v224, 16, v20
v_mfma_f32_16x16x32_bf16 a[240:243], v[176:179], v[208:211], a[240:243]
buffer_load_dwordx4 v[36:39], v2, s[24:27], s97 offen
v_lshlrev_b32 v225, 16, v16
v_lshlrev_b32 v226, 16, v32
v_mfma_f32_16x16x32_bf16 a[236:239], v[148:151], v[212:215], a[236:239]
ds_read_b128 v[208:211], v5 offset:6400
v_lshlrev_b32 v227, 16, v56
v_mfma_f32_16x16x32_bf16 a[240:243], v[180:183], v[212:215], a[240:243]
ds_read_b128 v[212:215], v5 offset:6464
v_lshlrev_b32 v228, 16, v60
v_mfma_f32_16x16x32_bf16 a[236:239], v[152:155], v[216:219], a[236:239]
v_lshlrev_b32 v229, 16, v24
v_lshlrev_b32 v230, 16, v28
v_mfma_f32_16x16x32_bf16 a[240:243], v[184:187], v[216:219], a[240:243]
buffer_load_dwordx4 v[40:43], v2, s[24:27], s97 offen offset:2048
v_mul_f32 v231, s55, v228
v_mfma_f32_16x16x32_bf16 a[236:239], v[156:159], v[220:223], a[236:239]
ds_read_b128 v[216:219], v5 offset:6528
v_mul_f32 v232, s55, v227
v_fmac_f32 v231, s54, v227
v_mfma_f32_16x16x32_bf16 a[240:243], v[188:191], v[220:223], a[240:243]
v_fmac_f32 v232, s54, v226
s_waitcnt lgkmcnt(3)
v_mfma_f32_16x16x32_bf16 a[240:243], v[128:131], v[192:195], a[240:243]
ds_read_b128 v[220:223], v5 offset:6592
v_fmac_f32 v231, s53, v226
v_mfma_f32_16x16x32_bf16 a[244:247], v[160:163], v[192:195], 0
buffer_load_dwordx4 v[44:47], v2, s[28:31], s97 offen
v_fmac_f32 v232, s53, v225
v_fmac_f32 v231, s52, v225
v_mfma_f32_16x16x32_bf16 a[240:243], v[132:135], v[196:199], a[240:243]
ds_read_b128 v[192:195], v5 offset:5632
v_fmac_f32 v232, s52, v224
v_mfma_f32_16x16x32_bf16 a[244:247], v[164:167], v[196:199], a[244:247]
ds_read_b128 v[196:199], v5 offset:5696
v_mul_f32 v231, v231, v229
v_mfma_f32_16x16x32_bf16 a[240:243], v[136:139], v[200:203], a[240:243]
v_mul_f32 v232, v232, v230
v_cvt_pk_bf16_f32 v233, v231, v232
v_mfma_f32_16x16x32_bf16 a[244:247], v[168:171], v[200:203], a[244:247]
ds_write_b32 v4, v233 offset:2050
v_mfma_f32_16x16x32_bf16 a[240:243], v[140:143], v[204:207], a[240:243]
buffer_load_dwordx4 v[48:51], v2, s[28:31], s97 offen offset:2048
ds_read_b128 v[200:203], v5 offset:5760
ds_write_b16 v4, v233 offset:6208
v_mfma_f32_16x16x32_bf16 a[244:247], v[172:175], v[204:207], a[244:247]
ds_write_b16_d16_hi v4, v233 offset:6210
v_and_b32 v234, 0xffff0000, v20
s_waitcnt lgkmcnt(6)
v_mfma_f32_16x16x32_bf16 a[240:243], v[144:147], v[208:211], a[240:243]
ds_read_b128 v[204:207], v5 offset:5824
v_and_b32 v235, 0xffff0000, v16
v_mfma_f32_16x16x32_bf16 a[244:247], v[176:179], v[208:211], a[244:247]
ds_read_b128 v[208:211], v5 offset:5888
v_and_b32 v236, 0xffff0000, v32
v_mfma_f32_16x16x32_bf16 a[240:243], v[148:151], v[212:215], a[240:243]
v_and_b32 v237, 0xffff0000, v56
v_and_b32 v238, 0xffff0000, v60
v_mfma_f32_16x16x32_bf16 a[244:247], v[180:183], v[212:215], a[244:247]
ds_read_b128 v[212:215], v5 offset:5952
v_and_b32 v239, 0xffff0000, v24
v_mfma_f32_16x16x32_bf16 a[240:243], v[152:155], v[216:219], a[240:243]
v_and_b32 v240, 0xffff0000, v28
v_mul_f32 v241, s59, v238
v_mfma_f32_16x16x32_bf16 a[244:247], v[184:187], v[216:219], a[244:247]
ds_read_b128 v[216:219], v5 offset:6016
v_mul_f32 v242, s59, v237
v_mfma_f32_16x16x32_bf16 a[240:243], v[156:159], v[220:223], a[240:243]
v_fmac_f32 v241, s58, v237
v_fmac_f32 v242, s58, v236
v_mfma_f32_16x16x32_bf16 a[244:247], v[188:191], v[220:223], a[244:247]
s_waitcnt lgkmcnt(3)
s_barrier
v_mfma_f32_16x16x32_bf16 a[244:247], v[128:131], v[192:195], a[244:247]
ds_read_b128 v[220:223], v5 offset:6080
v_fmac_f32 v241, s57, v236
v_fmac_f32 v242, s57, v235
v_mfma_f32_16x16x32_bf16 a[248:251], v[160:163], v[192:195], 0
ds_read_b128 v[192:195], v5 offset:5120
v_fmac_f32 v241, s56, v235
v_mfma_f32_16x16x32_bf16 a[244:247], v[132:135], v[196:199], a[244:247]
ds_read2_b32 v[64:65], v6 offset0:0 offset1:1
v_fmac_f32 v242, s56, v234
v_mul_f32 v241, v241, v239
v_mfma_f32_16x16x32_bf16 a[248:251], v[164:167], v[196:199], a[248:251]
ds_read_b128 v[196:199], v5 offset:5184
v_mul_f32 v242, v242, v240
v_mfma_f32_16x16x32_bf16 a[244:247], v[136:139], v[200:203], a[244:247]
ds_read2_b32 v[66:67], v6 offset0:2 offset1:3
v_cvt_pk_bf16_f32 v243, v241, v242
v_mfma_f32_16x16x32_bf16 a[248:251], v[168:171], v[200:203], a[248:251]
ds_write_b32 v4, v243 offset:10370
ds_write_b16 v4, v243 offset:14528
v_mfma_f32_16x16x32_bf16 a[244:247], v[140:143], v[204:207], a[244:247]
ds_read_b128 v[200:203], v5 offset:5248
ds_read2_b32 v[68:69], v6 offset0:16 offset1:17
ds_write_b16_d16_hi v4, v243 offset:14530
v_mfma_f32_16x16x32_bf16 a[248:251], v[172:175], v[204:207], a[248:251]
v_lshlrev_b32 v224, 16, v21
s_waitcnt lgkmcnt(9)
v_mfma_f32_16x16x32_bf16 a[244:247], v[144:147], v[208:211], a[244:247]
ds_read_b128 v[204:207], v5 offset:5312
ds_read2_b32 v[70:71], v6 offset0:18 offset1:19
v_lshlrev_b32 v225, 16, v17
v_lshlrev_b32 v226, 16, v33
v_mfma_f32_16x16x32_bf16 a[248:251], v[176:179], v[208:211], a[248:251]
ds_read_b128 v[208:211], v5 offset:5376
v_lshlrev_b32 v227, 16, v57
v_mfma_f32_16x16x32_bf16 a[244:247], v[148:151], v[212:215], a[244:247]
ds_read2_b32 v[72:73], v6 offset0:32 offset1:33
v_lshlrev_b32 v228, 16, v61
v_mfma_f32_16x16x32_bf16 a[248:251], v[180:183], v[212:215], a[248:251]
v_lshlrev_b32 v229, 16, v25
v_lshlrev_b32 v230, 16, v29
v_mfma_f32_16x16x32_bf16 a[244:247], v[152:155], v[216:219], a[244:247]
ds_read_b128 v[212:215], v5 offset:5440
ds_read2_b32 v[74:75], v6 offset0:34 offset1:35
v_mul_f32 v231, s63, v228
v_mfma_f32_16x16x32_bf16 a[248:251], v[184:187], v[216:219], a[248:251]
ds_read_b128 v[216:219], v5 offset:5504
v_mul_f32 v232, s63, v227
v_mfma_f32_16x16x32_bf16 a[244:247], v[156:159], v[220:223], a[244:247]
ds_read2_b32 v[76:77], v6 offset0:48 offset1:49
v_fmac_f32 v231, s62, v227
v_fmac_f32 v232, s62, v226
v_mfma_f32_16x16x32_bf16 a[248:251], v[188:191], v[220:223], a[248:251]
v_fmac_f32 v231, s61, v226
s_waitcnt lgkmcnt(7)
v_mfma_f32_16x16x32_bf16 a[248:251], v[128:131], v[192:195], a[248:251]
ds_read_b128 v[220:223], v5 offset:5568
ds_read2_b32 v[78:79], v6 offset0:50 offset1:51
v_fmac_f32 v232, s61, v225
v_mfma_f32_16x16x32_bf16 a[252:255], v[160:163], v[192:195], 0
v_fmac_f32 v231, s60, v225
v_fmac_f32 v232, s60, v224
v_mfma_f32_16x16x32_bf16 a[248:251], v[132:135], v[196:199], a[248:251]
ds_read_b128 v[192:195], v5 offset:4608
ds_read2_b32 v[80:81], v6 offset0:64 offset1:65
v_mul_f32 v231, v231, v229
v_mfma_f32_16x16x32_bf16 a[252:255], v[164:167], v[196:199], a[252:255]
ds_read_b128 v[196:199], v5 offset:4672
v_mul_f32 v232, v232, v230
v_mfma_f32_16x16x32_bf16 a[248:251], v[136:139], v[200:203], a[248:251]
ds_read2_b32 v[82:83], v6 offset0:66 offset1:67
v_cvt_pk_bf16_f32 v233, v231, v232
v_mfma_f32_16x16x32_bf16 a[252:255], v[168:171], v[200:203], a[252:255]
ds_write_b32 v4, v233 offset:18690
ds_write_b16 v4, v233 offset:22848
v_mfma_f32_16x16x32_bf16 a[248:251], v[140:143], v[204:207], a[248:251]
ds_read_b128 v[200:203], v5 offset:4736
ds_read2_b32 v[84:85], v6 offset0:80 offset1:81
ds_write_b16_d16_hi v4, v233 offset:22850
v_and_b32 v234, 0xffff0000, v21
v_mfma_f32_16x16x32_bf16 a[252:255], v[172:175], v[204:207], a[252:255]
v_and_b32 v235, 0xffff0000, v17
s_waitcnt lgkmcnt(10)
v_mfma_f32_16x16x32_bf16 a[248:251], v[144:147], v[208:211], a[248:251]
ds_read_b128 v[204:207], v5 offset:4800
ds_read2_b32 v[86:87], v6 offset0:82 offset1:83
v_and_b32 v236, 0xffff0000, v33
v_mfma_f32_16x16x32_bf16 a[252:255], v[176:179], v[208:211], a[252:255]
v_and_b32 v237, 0xffff0000, v57
v_and_b32 v238, 0xffff0000, v61
v_mfma_f32_16x16x32_bf16 a[248:251], v[148:151], v[212:215], a[248:251]
ds_read_b128 v[208:211], v5 offset:4864
ds_read2_b32 v[88:89], v6 offset0:96 offset1:97
v_and_b32 v239, 0xffff0000, v25
v_mfma_f32_16x16x32_bf16 a[252:255], v[180:183], v[212:215], a[252:255]
ds_read_b128 v[212:215], v5 offset:4928
v_and_b32 v240, 0xffff0000, v29
v_mfma_f32_16x16x32_bf16 a[248:251], v[152:155], v[216:219], a[248:251]
ds_read2_b32 v[90:91], v6 offset0:98 offset1:99
v_mul_f32 v241, s67, v238
v_mul_f32 v242, s67, v237
v_mfma_f32_16x16x32_bf16 a[252:255], v[184:187], v[216:219], a[252:255]
ds_read_b128 v[216:219], v5 offset:4992
v_fmac_f32 v241, s66, v237
v_mfma_f32_16x16x32_bf16 a[248:251], v[156:159], v[220:223], a[248:251]
ds_read2_b32 v[92:93], v6 offset0:112 offset1:113
v_fmac_f32 v242, s66, v236
v_mfma_f32_16x16x32_bf16 a[252:255], v[188:191], v[220:223], a[252:255]
v_fmac_f32 v241, s65, v236
v_fmac_f32 v242, s65, v235
s_waitcnt lgkmcnt(7)
v_mfma_f32_16x16x32_bf16 a[252:255], v[128:131], v[192:195], a[252:255]
ds_read_b128 v[220:223], v5 offset:5056
ds_read2_b32 v[94:95], v6 offset0:114 offset1:115
v_fmac_f32 v241, s64, v235
v_mfma_f32_16x16x32_bf16 a[252:255], v[132:135], v[196:199], a[252:255]
ds_read2_b32 v[96:97], v6 offset0:128 offset1:129
v_fmac_f32 v242, s64, v234
v_mfma_f32_16x16x32_bf16 a[252:255], v[136:139], v[200:203], a[252:255]
v_mul_f32 v241, v241, v239
v_mul_f32 v242, v242, v240
v_mfma_f32_16x16x32_bf16 a[252:255], v[140:143], v[204:207], a[252:255]
ds_read2_b32 v[98:99], v6 offset0:130 offset1:131
v_cvt_pk_bf16_f32 v243, v241, v242
s_waitcnt lgkmcnt(3)
v_mfma_f32_16x16x32_bf16 a[252:255], v[144:147], v[208:211], a[252:255]
ds_read2_b32 v[100:101], v6 offset0:144 offset1:145
ds_write_b32 v4, v243 offset:27010
v_mfma_f32_16x16x32_bf16 a[252:255], v[148:151], v[212:215], a[252:255]
ds_write_b16 v4, v243 offset:31168
ds_write_b16_d16_hi v4, v243 offset:31170
v_mfma_f32_16x16x32_bf16 a[252:255], v[152:155], v[216:219], a[252:255]
ds_read2_b32 v[102:103], v6 offset0:146 offset1:147
v_lshlrev_b32 v224, 16, v22
v_mfma_f32_16x16x32_bf16 a[252:255], v[156:159], v[220:223], a[252:255]
ds_read2_b32 v[104:105], v6 offset0:160 offset1:161
v_lshlrev_b32 v225, 16, v18
s_waitcnt lgkmcnt(8)
v_mfma_f32_16x16x32_bf16 a[200:203], v[64:67], a[0:3], a[200:203]
v_lshlrev_b32 v226, 16, v34
v_lshlrev_b32 v227, 16, v58
v_mfma_f32_16x16x32_bf16 a[200:203], v[68:71], a[4:7], a[200:203]
ds_read2_b32 v[106:107], v6 offset0:162 offset1:163
v_lshlrev_b32 v228, 16, v62
v_mfma_f32_16x16x32_bf16 a[200:203], v[72:75], a[8:11], a[200:203]
ds_read2_b32 v[108:109], v6 offset0:176 offset1:177
v_lshlrev_b32 v229, 16, v26
v_lshlrev_b32 v230, 16, v30
v_mfma_f32_16x16x32_bf16 a[200:203], v[76:79], a[12:15], a[200:203]
ds_read2_b32 v[110:111], v6 offset0:178 offset1:179
v_mul_f32 v231, s71, v228
v_mfma_f32_16x16x32_bf16 a[200:203], v[80:83], a[16:19], a[200:203]
ds_read2_b32 v[112:113], v6 offset0:192 offset1:193
v_mul_f32 v232, s71, v227
v_mfma_f32_16x16x32_bf16 a[200:203], v[84:87], a[20:23], a[200:203]
v_fmac_f32 v231, s70, v227
v_fmac_f32 v232, s70, v226
v_mfma_f32_16x16x32_bf16 a[200:203], v[88:91], a[24:27], a[200:203]
ds_read2_b32 v[114:115], v6 offset0:194 offset1:195
v_fmac_f32 v231, s69, v226
v_mfma_f32_16x16x32_bf16 a[200:203], v[92:95], a[28:31], a[200:203]
ds_read2_b32 v[116:117], v6 offset0:208 offset1:209
v_fmac_f32 v232, s69, v225
v_mfma_f32_16x16x32_bf16 a[204:207], v[64:67], a[32:35], a[204:207]
v_fmac_f32 v231, s68, v225
v_fmac_f32 v232, s68, v224
v_mfma_f32_16x16x32_bf16 a[204:207], v[68:71], a[36:39], a[204:207]
ds_read2_b32 v[118:119], v6 offset0:210 offset1:211
v_mul_f32 v231, v231, v229
v_mfma_f32_16x16x32_bf16 a[204:207], v[72:75], a[40:43], a[204:207]
ds_read2_b32 v[120:121], v6 offset0:224 offset1:225
v_mul_f32 v232, v232, v230
v_mfma_f32_16x16x32_bf16 a[204:207], v[76:79], a[44:47], a[204:207]
v_cvt_pk_bf16_f32 v233, v231, v232
v_mfma_f32_16x16x32_bf16 a[204:207], v[80:83], a[48:51], a[204:207]
ds_write_b32 v4, v233 offset:35330
ds_write_b16 v4, v233 offset:39488
v_mfma_f32_16x16x32_bf16 a[204:207], v[84:87], a[52:55], a[204:207]
ds_read2_b32 v[122:123], v6 offset0:226 offset1:227
ds_write_b16_d16_hi v4, v233 offset:39490
v_mfma_f32_16x16x32_bf16 a[204:207], v[88:91], a[56:59], a[204:207]
ds_read2_b32 v[124:125], v6 offset0:240 offset1:241
v_and_b32 v234, 0xffff0000, v22
v_and_b32 v235, 0xffff0000, v18
v_mfma_f32_16x16x32_bf16 a[204:207], v[92:95], a[60:63], a[204:207]
ds_read2_b32 v[126:127], v6 offset0:242 offset1:243
v_and_b32 v236, 0xffff0000, v34
v_mfma_f32_16x16x32_bf16 a[208:211], v[64:67], a[64:67], a[208:211]
v_and_b32 v237, 0xffff0000, v58
v_and_b32 v238, 0xffff0000, v62
v_mfma_f32_16x16x32_bf16 a[208:211], v[68:71], a[68:71], a[208:211]
v_and_b32 v239, 0xffff0000, v26
v_and_b32 v240, 0xffff0000, v30
v_mfma_f32_16x16x32_bf16 a[208:211], v[72:75], a[72:75], a[208:211]
v_mul_f32 v241, s75, v238
v_mul_f32 v242, s75, v237
v_mfma_f32_16x16x32_bf16 a[208:211], v[76:79], a[76:79], a[208:211]
ds_read2_b32 v[128:129], v9 offset0:0 offset1:1
v_fmac_f32 v241, s74, v237
v_mfma_f32_16x16x32_bf16 a[208:211], v[80:83], a[80:83], a[208:211]
v_fmac_f32 v242, s74, v236
v_fmac_f32 v241, s73, v236
v_mfma_f32_16x16x32_bf16 a[208:211], v[84:87], a[84:87], a[208:211]
ds_read2_b32 v[130:131], v9 offset0:2 offset1:3
v_fmac_f32 v242, s73, v235
v_mfma_f32_16x16x32_bf16 a[208:211], v[88:91], a[88:91], a[208:211]
v_accvgpr_read_b32 v248, a200
v_fmac_f32 v241, s72, v235
v_mfma_f32_16x16x32_bf16 a[208:211], v[92:95], a[92:95], a[208:211]
v_accvgpr_read_b32 v249, a201
s_waitcnt lgkmcnt(2)
v_mfma_f32_16x16x32_bf16 a[204:207], v[96:99], a[0:3], a[204:207]
ds_read2_b32 v[132:133], v9 offset0:16 offset1:17
v_fmac_f32 v242, s72, v234
v_mfma_f32_16x16x32_bf16 a[204:207], v[100:103], a[4:7], a[204:207]
v_mul_f32 v241, v241, v239
v_mul_f32 v242, v242, v240
v_accvgpr_read_b32 v250, a202
v_mfma_f32_16x16x32_bf16 a[204:207], v[104:107], a[8:11], a[204:207]
ds_read2_b32 v[134:135], v9 offset0:18 offset1:19
v_cvt_pk_bf16_f32 v243, v241, v242
v_accvgpr_read_b32 v251, a203
v_mfma_f32_16x16x32_bf16 a[204:207], v[108:111], a[12:15], a[204:207]
ds_write_b32 v4, v243 offset:43650
v_mfma_f32_16x16x32_bf16 a[204:207], v[112:115], a[16:19], a[204:207]
ds_read2_b32 v[136:137], v9 offset0:32 offset1:33
ds_write_b16 v4, v243 offset:47808
ds_write_b16_d16_hi v4, v243 offset:47810
v_cvt_pk_bf16_f32 v244, v248, v249
v_mfma_f32_16x16x32_bf16 a[204:207], v[116:119], a[20:23], a[204:207]
v_lshlrev_b32 v224, 16, v23
v_cvt_pk_bf16_f32 v245, v250, v251
v_mfma_f32_16x16x32_bf16 a[204:207], v[120:123], a[24:27], a[204:207]
ds_read2_b32 v[138:139], v9 offset0:34 offset1:35
v_lshlrev_b32 v225, 16, v19
v_mfma_f32_16x16x32_bf16 a[204:207], v[124:127], a[28:31], a[204:207]
ds_write_b64 v7, v[244:245] offset:9216
v_lshlrev_b32 v226, 16, v35
v_lshlrev_b32 v227, 16, v59
v_mfma_f32_16x16x32_bf16 a[208:211], v[96:99], a[32:35], a[208:211]
ds_read2_b32 v[140:141], v9 offset0:48 offset1:49
v_lshlrev_b32 v228, 16, v63
v_mfma_f32_16x16x32_bf16 a[208:211], v[100:103], a[36:39], a[208:211]
ds_read_b128 v[192:195], v5 offset:2048
v_lshlrev_b32 v229, 16, v27
v_mfma_f32_16x16x32_bf16 a[208:211], v[104:107], a[40:43], a[208:211]
ds_read_b128 v[196:199], v5 offset:2112
ds_read2_b32 v[142:143], v9 offset0:50 offset1:51
v_lshlrev_b32 v230, 16, v31
v_mul_f32 v231, s79, v228
v_mfma_f32_16x16x32_bf16 a[208:211], v[108:111], a[44:47], a[208:211]
ds_read_b128 v[200:203], v5 offset:2176
v_mul_f32 v232, s79, v227
v_mfma_f32_16x16x32_bf16 a[208:211], v[112:115], a[48:51], a[208:211]
ds_read_b128 v[204:207], v5 offset:2240
ds_read2_b32 v[144:145], v9 offset0:64 offset1:65
v_fmac_f32 v231, s78, v227
v_mfma_f32_16x16x32_bf16 a[208:211], v[116:119], a[52:55], a[208:211]
ds_read_b128 v[208:211], v5 offset:2304
v_fmac_f32 v232, s78, v226
v_fmac_f32 v231, s77, v226
v_mfma_f32_16x16x32_bf16 a[208:211], v[120:123], a[56:59], a[208:211]
ds_read_b128 v[212:215], v5 offset:2368
ds_read2_b32 v[146:147], v9 offset0:66 offset1:67
v_fmac_f32 v232, s77, v225
v_mfma_f32_16x16x32_bf16 a[208:211], v[124:127], a[60:63], a[208:211]
ds_read_b128 v[216:219], v5 offset:2432
v_fmac_f32 v231, s76, v225
v_mfma_f32_16x16x32_bf16 a[212:215], v[96:99], a[64:67], a[212:215]
ds_read_b128 v[220:223], v5 offset:2496
ds_read2_b32 v[148:149], v9 offset0:80 offset1:81
v_fmac_f32 v232, s76, v224
v_mul_f32 v231, v231, v229
v_mfma_f32_16x16x32_bf16 a[212:215], v[100:103], a[68:71], a[212:215]
ds_read2_b32 v[150:151], v9 offset0:82 offset1:83
v_mul_f32 v232, v232, v230
v_mfma_f32_16x16x32_bf16 a[212:215], v[104:107], a[72:75], a[212:215]
v_cvt_pk_bf16_f32 v233, v231, v232
v_mfma_f32_16x16x32_bf16 a[212:215], v[108:111], a[76:79], a[212:215]
ds_write_b32 v4, v233 offset:51970
ds_write_b16 v4, v233 offset:56128
v_mfma_f32_16x16x32_bf16 a[212:215], v[112:115], a[80:83], a[212:215]
ds_read2_b32 v[152:153], v9 offset0:96 offset1:97
ds_write_b16_d16_hi v4, v233 offset:56130
v_mfma_f32_16x16x32_bf16 a[212:215], v[116:119], a[84:87], a[212:215]
v_and_b32 v234, 0xffff0000, v23
v_and_b32 v235, 0xffff0000, v19
v_mfma_f32_16x16x32_bf16 a[212:215], v[120:123], a[88:91], a[212:215]
ds_read2_b32 v[154:155], v9 offset0:98 offset1:99
v_and_b32 v236, 0xffff0000, v35
v_accvgpr_read_b32 v248, a204
v_mfma_f32_16x16x32_bf16 a[212:215], v[124:127], a[92:95], a[212:215]
v_and_b32 v237, 0xffff0000, v59
v_accvgpr_read_b32 v249, a205
s_waitcnt lgkmcnt(13)
v_mfma_f32_16x16x32_bf16 a[212:215], v[64:67], v[192:195], a[212:215]
ds_read2_b32 v[156:157], v9 offset0:112 offset1:113
v_and_b32 v238, 0xffff0000, v63
v_and_b32 v239, 0xffff0000, v27
v_mfma_f32_16x16x32_bf16 a[216:219], v[96:99], v[192:195], a[216:219]
v_and_b32 v240, 0xffff0000, v31
v_accvgpr_read_b32 v250, a206
v_mfma_f32_16x16x32_bf16 a[212:215], v[68:71], v[196:199], a[212:215]
ds_read_b128 v[192:195], v5 offset:1536
ds_read2_b32 v[158:159], v9 offset0:114 offset1:115
v_mul_f32 v241, s83, v238
v_accvgpr_read_b32 v251, a207
v_mfma_f32_16x16x32_bf16 a[216:219], v[100:103], v[196:199], a[216:219]
v_mul_f32 v242, s83, v237
v_fmac_f32 v241, s82, v237
v_mfma_f32_16x16x32_bf16 a[212:215], v[72:75], v[200:203], a[212:215]
ds_read_b128 v[196:199], v5 offset:1600
ds_read2_b32 v[160:161], v9 offset0:128 offset1:129
v_fmac_f32 v242, s82, v236
v_cvt_pk_bf16_f32 v246, v248, v249
v_mfma_f32_16x16x32_bf16 a[216:219], v[104:107], v[200:203], a[216:219]
v_fmac_f32 v241, s81, v236
v_cvt_pk_bf16_f32 v247, v250, v251
v_mfma_f32_16x16x32_bf16 a[212:215], v[76:79], v[204:207], a[212:215]
ds_read_b128 v[200:203], v5 offset:1664
ds_read2_b32 v[162:163], v9 offset0:130 offset1:131
v_fmac_f32 v242, s81, v235
v_fmac_f32 v241, s80, v235
v_mfma_f32_16x16x32_bf16 a[216:219], v[108:111], v[204:207], a[216:219]
ds_write_b64 v7, v[246:247] offset:13824
v_fmac_f32 v242, s80, v234
s_waitcnt lgkmcnt(15)
v_mfma_f32_16x16x32_bf16 a[212:215], v[80:83], v[208:211], a[212:215]
ds_read_b128 v[204:207], v5 offset:1728
ds_read2_b32 v[164:165], v9 offset0:144 offset1:145
v_mul_f32 v241, v241, v239
v_mfma_f32_16x16x32_bf16 a[216:219], v[112:115], v[208:211], a[216:219]
v_mul_f32 v242, v242, v240
v_cvt_pk_bf16_f32 v243, v241, v242
v_mfma_f32_16x16x32_bf16 a[212:215], v[84:87], v[212:215], a[212:215]
ds_read_b128 v[208:211], v5 offset:1792
ds_read2_b32 v[166:167], v9 offset0:146 offset1:147
ds_write_b32 v4, v243 offset:60290
v_mfma_f32_16x16x32_bf16 a[216:219], v[116:119], v[212:215], a[216:219]
ds_write_b16 v4, v243 offset:64448
v_mfma_f32_16x16x32_bf16 a[212:215], v[88:91], v[216:219], a[212:215]
ds_read_b128 v[212:215], v5 offset:1856
ds_read2_b32 v[168:169], v9 offset0:160 offset1:161
ds_write_b16_d16_hi v4, v243 offset:64450
s_waitcnt vmcnt(0)
v_mfma_f32_16x16x32_bf16 a[216:219], v[120:123], v[216:219], a[216:219]
ds_read_b128 v[216:219], v5 offset:1920
v_mov_b32_dpp v56, v52 row_shl:1 row_mask:0xf bank_mask:0xf
v_mfma_f32_16x16x32_bf16 a[212:215], v[92:95], v[220:223], a[212:215]
ds_read2_b32 v[170:171], v9 offset0:162 offset1:163
v_mov_b32_dpp v57, v53 row_shl:1 row_mask:0xf bank_mask:0xf
v_mov_b32_dpp v58, v54 row_shl:1 row_mask:0xf bank_mask:0xf
v_mfma_f32_16x16x32_bf16 a[216:219], v[124:127], v[220:223], a[216:219]
v_mov_b32_dpp v59, v55 row_shl:1 row_mask:0xf bank_mask:0xf
s_waitcnt lgkmcnt(10)
v_mfma_f32_16x16x32_bf16 a[216:219], v[64:67], v[192:195], a[216:219]
ds_read_b128 v[220:223], v5 offset:1984
ds_read2_b32 v[172:173], v9 offset0:176 offset1:177
v_mov_b32_dpp v60, v52 row_shl:2 row_mask:0xf bank_mask:0xf
v_mfma_f32_16x16x32_bf16 a[220:223], v[96:99], v[192:195], a[220:223]
v_mov_b32_dpp v61, v53 row_shl:2 row_mask:0xf bank_mask:0xf
v_mov_b32_dpp v62, v54 row_shl:2 row_mask:0xf bank_mask:0xf
v_mfma_f32_16x16x32_bf16 a[216:219], v[68:71], v[196:199], a[216:219]
ds_read_b128 v[192:195], v5 offset:1024
ds_read2_b32 v[174:175], v9 offset0:178 offset1:179
v_mov_b32_dpp v63, v55 row_shl:2 row_mask:0xf bank_mask:0xf
v_mfma_f32_16x16x32_bf16 a[220:223], v[100:103], v[196:199], a[220:223]
ds_read_b128 v[196:199], v5 offset:1088
v_mov_b32_dpp v52, v40 wave_shr:1 row_mask:0xf bank_mask:0xf
v_mfma_f32_16x16x32_bf16 a[216:219], v[72:75], v[200:203], a[216:219]
ds_read2_b32 v[176:177], v9 offset0:192 offset1:193
v_mov_b32_dpp v53, v41 wave_shr:1 row_mask:0xf bank_mask:0xf
v_mov_b32_dpp v54, v42 wave_shr:1 row_mask:0xf bank_mask:0xf
v_mfma_f32_16x16x32_bf16 a[220:223], v[104:107], v[200:203], a[220:223]
ds_read_b128 v[200:203], v5 offset:1152
v_mov_b32_dpp v55, v43 wave_shr:1 row_mask:0xf bank_mask:0xf
v_mfma_f32_16x16x32_bf16 a[216:219], v[76:79], v[204:207], a[216:219]
ds_read2_b32 v[178:179], v9 offset0:194 offset1:195
v_mov_b32_dpp v56, v36 wave_shr:1 row_mask:0xf bank_mask:0xf
v_mfma_f32_16x16x32_bf16 a[220:223], v[108:111], v[204:207], a[220:223]
v_mov_b32_dpp v57, v37 wave_shr:1 row_mask:0xf bank_mask:0xf
v_mov_b32_dpp v58, v38 wave_shr:1 row_mask:0xf bank_mask:0xf
s_waitcnt lgkmcnt(7)
v_mfma_f32_16x16x32_bf16 a[216:219], v[80:83], v[208:211], a[216:219]
ds_read_b128 v[204:207], v5 offset:1216
ds_read2_b32 v[180:181], v9 offset0:208 offset1:209
v_mov_b32_dpp v59, v39 wave_shr:1 row_mask:0xf bank_mask:0xf
v_mfma_f32_16x16x32_bf16 a[220:223], v[112:115], v[208:211], a[220:223]
ds_read_b128 v[208:211], v5 offset:1280
v_mov_b32_dpp v60, v52 wave_shr:1 row_mask:0xf bank_mask:0xf
v_mfma_f32_16x16x32_bf16 a[216:219], v[84:87], v[212:215], a[216:219]
ds_read2_b32 v[182:183], v9 offset0:210 offset1:211
v_mov_b32_dpp v61, v53 wave_shr:1 row_mask:0xf bank_mask:0xf
v_mov_b32_dpp v62, v54 wave_shr:1 row_mask:0xf bank_mask:0xf
v_mfma_f32_16x16x32_bf16 a[220:223], v[116:119], v[212:215], a[220:223]
ds_read_b128 v[212:215], v5 offset:1344
v_mov_b32_dpp v63, v55 wave_shr:1 row_mask:0xf bank_mask:0xf
v_mfma_f32_16x16x32_bf16 a[216:219], v[88:91], v[216:219], a[216:219]
ds_read2_b32 v[184:185], v9 offset0:224 offset1:225
v_lshlrev_b32 v224, 16, v40
v_mfma_f32_16x16x32_bf16 a[220:223], v[120:123], v[216:219], a[220:223]
v_lshlrev_b32 v225, 16, v36
v_lshlrev_b32 v226, 16, v52
v_mfma_f32_16x16x32_bf16 a[216:219], v[92:95], v[220:223], a[216:219]
ds_read_b128 v[216:219], v5 offset:1408
ds_read2_b32 v[186:187], v9 offset0:226 offset1:227
v_lshlrev_b32 v227, 16, v56
v_mfma_f32_16x16x32_bf16 a[220:223], v[124:127], v[220:223], a[220:223]
v_lshlrev_b32 v228, 16, v60
s_waitcnt lgkmcnt(7)
v_mfma_f32_16x16x32_bf16 a[220:223], v[64:67], v[192:195], a[220:223]
ds_read_b128 v[220:223], v5 offset:1472
ds_read2_b32 v[188:189], v9 offset0:240 offset1:241
v_lshlrev_b32 v229, 16, v44
v_lshlrev_b32 v230, 16, v48
v_mfma_f32_16x16x32_bf16 a[220:223], v[68:71], v[196:199], a[220:223]
ds_read2_b32 v[190:191], v9 offset0:242 offset1:243
v_mul_f32 v231, s55, v228
v_mfma_f32_16x16x32_bf16 a[220:223], v[72:75], v[200:203], a[220:223]
ds_read_b128 v[16:19], v11 offset:0
v_mul_f32 v232, s55, v227
v_fmac_f32 v231, s54, v227
v_mfma_f32_16x16x32_bf16 a[220:223], v[76:79], v[204:207], a[220:223]
v_fmac_f32 v232, s54, v226
s_waitcnt lgkmcnt(3)
v_mfma_f32_16x16x32_bf16 a[220:223], v[80:83], v[208:211], a[220:223]
ds_read_b128 v[20:23], v11 offset:1152
v_fmac_f32 v231, s53, v226
v_mfma_f32_16x16x32_bf16 a[220:223], v[84:87], v[212:215], a[220:223]
v_fmac_f32 v232, s53, v225
v_fmac_f32 v231, s52, v225
v_mfma_f32_16x16x32_bf16 a[220:223], v[88:91], v[216:219], a[220:223]
s_add_u32 s94, s99, 0
v_fmac_f32 v232, s52, v224
v_mfma_f32_16x16x32_bf16 a[220:223], v[92:95], v[220:223], a[220:223]
v_mul_f32 v231, v231, v229
v_mfma_f32_16x16x32_bf16 a[232:235], v[128:131], a[96:99], a[232:235]
s_add_u32 s95, s99, 131072
v_mul_f32 v232, v232, v230
v_cvt_pk_bf16_f32 v233, v231, v232
v_mfma_f32_16x16x32_bf16 a[232:235], v[132:135], a[100:103], a[232:235]
ds_write_b32 v4, v233 offset:3074
v_mfma_f32_16x16x32_bf16 a[232:235], v[136:139], a[104:107], a[232:235]
ds_write_b16 v4, v233 offset:7232
s_waitcnt lgkmcnt(2)
v_mfma_f32_16x16x32_bf16 a[232:235], v[140:143], a[108:111], a[232:235]
ds_write_b16_d16_hi v4, v233 offset:7234
v_and_b32 v234, 0xffff0000, v40
v_mfma_f32_16x16x32_bf16 a[232:235], v[144:147], a[112:115], a[232:235]
buffer_store_dwordx4 v[16:19], v12, s[40:43], s94 offen sc1
v_and_b32 v235, 0xffff0000, v36
v_mfma_f32_16x16x32_bf16 a[232:235], v[148:151], a[116:119], a[232:235]
v_and_b32 v236, 0xffff0000, v52
v_add_u32 v6, 0x400, v6
v_mfma_f32_16x16x32_bf16 a[232:235], v[152:155], a[120:123], a[232:235]
buffer_store_dwordx4 v[20:23], v12, s[40:43], s95 offen sc1
v_and_b32 v237, 0xffff0000, v56
v_and_b32 v238, 0xffff0000, v60
v_mfma_f32_16x16x32_bf16 a[232:235], v[156:159], a[124:127], a[232:235]
v_and_b32 v239, 0xffff0000, v44
v_add_u32 v9, 0x400, v9
v_mfma_f32_16x16x32_bf16 a[236:239], v[128:131], a[128:131], a[236:239]
v_and_b32 v240, 0xffff0000, v48
v_mul_f32 v241, s59, v238
v_mfma_f32_16x16x32_bf16 a[236:239], v[132:135], a[132:135], a[236:239]
v_mul_f32 v242, s59, v237
v_fmac_f32 v241, s58, v237
v_mfma_f32_16x16x32_bf16 a[236:239], v[136:139], a[136:139], a[236:239]
v_fmac_f32 v242, s58, v236
v_fmac_f32 v241, s57, v236
v_mfma_f32_16x16x32_bf16 a[236:239], v[140:143], a[140:143], a[236:239]
v_fmac_f32 v242, s57, v235
v_fmac_f32 v241, s56, v235
v_mfma_f32_16x16x32_bf16 a[236:239], v[144:147], a[144:147], a[236:239]
v_fmac_f32 v242, s56, v234
v_mul_f32 v241, v241, v239
v_mfma_f32_16x16x32_bf16 a[236:239], v[148:151], a[148:151], a[236:239]
v_mul_f32 v242, v242, v240
v_cvt_pk_bf16_f32 v243, v241, v242
v_mfma_f32_16x16x32_bf16 a[236:239], v[152:155], a[152:155], a[236:239]
ds_write_b32 v4, v243 offset:11394
v_mfma_f32_16x16x32_bf16 a[236:239], v[156:159], a[156:159], a[236:239]
ds_write_b16 v4, v243 offset:15552
v_mfma_f32_16x16x32_bf16 a[240:243], v[128:131], a[160:163], a[240:243]
ds_write_b16_d16_hi v4, v243 offset:15554
v_mfma_f32_16x16x32_bf16 a[240:243], v[132:135], a[164:167], a[240:243]
v_lshlrev_b32 v224, 16, v41
v_lshlrev_b32 v225, 16, v37
v_mfma_f32_16x16x32_bf16 a[240:243], v[136:139], a[168:171], a[240:243]
v_lshlrev_b32 v226, 16, v53
v_lshlrev_b32 v227, 16, v57
v_mfma_f32_16x16x32_bf16 a[240:243], v[140:143], a[172:175], a[240:243]
v_lshlrev_b32 v228, 16, v61
v_lshlrev_b32 v229, 16, v45
v_mfma_f32_16x16x32_bf16 a[240:243], v[144:147], a[176:179], a[240:243]
v_lshlrev_b32 v230, 16, v49
v_mul_f32 v231, s63, v228
v_mfma_f32_16x16x32_bf16 a[240:243], v[148:151], a[180:183], a[240:243]
v_mul_f32 v232, s63, v227
v_fmac_f32 v231, s62, v227
v_mfma_f32_16x16x32_bf16 a[240:243], v[152:155], a[184:187], a[240:243]
v_accvgpr_read_b32 v248, a232
v_fmac_f32 v232, s62, v226
v_mfma_f32_16x16x32_bf16 a[240:243], v[156:159], a[188:191], a[240:243]
v_accvgpr_read_b32 v249, a233
v_mfma_f32_16x16x32_bf16 a[236:239], v[160:163], a[96:99], a[236:239]
v_fmac_f32 v231, s61, v226
v_fmac_f32 v232, s61, v225
v_mfma_f32_16x16x32_bf16 a[236:239], v[164:167], a[100:103], a[236:239]
v_accvgpr_read_b32 v250, a234
v_fmac_f32 v231, s60, v225
v_mfma_f32_16x16x32_bf16 a[236:239], v[168:171], a[104:107], a[236:239]
v_accvgpr_read_b32 v251, a235
v_fmac_f32 v232, s60, v224
v_mfma_f32_16x16x32_bf16 a[236:239], v[172:175], a[108:111], a[236:239]
v_mul_f32 v231, v231, v229
v_mul_f32 v232, v232, v230
v_mfma_f32_16x16x32_bf16 a[236:239], v[176:179], a[112:115], a[236:239]
v_cvt_pk_bf16_f32 v244, v248, v249
v_cvt_pk_bf16_f32 v233, v231, v232
v_mfma_f32_16x16x32_bf16 a[236:239], v[180:183], a[116:119], a[236:239]
v_cvt_pk_bf16_f32 v245, v250, v251
v_mfma_f32_16x16x32_bf16 a[236:239], v[184:187], a[120:123], a[236:239]
ds_write_b32 v4, v233 offset:19714
v_mfma_f32_16x16x32_bf16 a[236:239], v[188:191], a[124:127], a[236:239]
ds_write_b64 v7, v[244:245] offset:9232
v_mfma_f32_16x16x32_bf16 a[240:243], v[160:163], a[128:131], a[240:243]
ds_read_b128 v[192:195], v5 offset:6656
v_mfma_f32_16x16x32_bf16 a[240:243], v[164:167], a[132:135], a[240:243]
ds_write_b16 v4, v233 offset:23872
v_mfma_f32_16x16x32_bf16 a[240:243], v[168:171], a[136:139], a[240:243]
ds_read_b128 v[196:199], v5 offset:6720
ds_write_b16_d16_hi v4, v233 offset:23874
v_and_b32 v234, 0xffff0000, v41
v_mfma_f32_16x16x32_bf16 a[240:243], v[172:175], a[140:143], a[240:243]
ds_read_b128 v[200:203], v5 offset:6784
v_and_b32 v235, 0xffff0000, v37
v_mfma_f32_16x16x32_bf16 a[240:243], v[176:179], a[144:147], a[240:243]
ds_read_b128 v[204:207], v5 offset:6848
v_and_b32 v236, 0xffff0000, v53
v_mfma_f32_16x16x32_bf16 a[240:243], v[180:183], a[148:151], a[240:243]
ds_read_b128 v[208:211], v5 offset:6912
v_and_b32 v237, 0xffff0000, v57
v_and_b32 v238, 0xffff0000, v61
v_mfma_f32_16x16x32_bf16 a[240:243], v[184:187], a[152:155], a[240:243]
ds_read_b128 v[212:215], v5 offset:6976
v_and_b32 v239, 0xffff0000, v45
v_mfma_f32_16x16x32_bf16 a[240:243], v[188:191], a[156:159], a[240:243]
ds_read_b128 v[216:219], v5 offset:7040
v_and_b32 v240, 0xffff0000, v49
v_mfma_f32_16x16x32_bf16 a[244:247], v[160:163], a[160:163], a[244:247]
ds_read_b128 v[220:223], v5 offset:7104
v_mul_f32 v241, s67, v238
v_mul_f32 v242, s67, v237
v_mfma_f32_16x16x32_bf16 a[244:247], v[164:167], a[164:167], a[244:247]
v_fmac_f32 v241, s66, v237
v_fmac_f32 v242, s66, v236
v_mfma_f32_16x16x32_bf16 a[244:247], v[168:171], a[168:171], a[244:247]
v_fmac_f32 v241, s65, v236
v_fmac_f32 v242, s65, v235
v_mfma_f32_16x16x32_bf16 a[244:247], v[172:175], a[172:175], a[244:247]
v_fmac_f32 v241, s64, v235
v_fmac_f32 v242, s64, v234
v_mfma_f32_16x16x32_bf16 a[244:247], v[176:179], a[176:179], a[244:247]
v_mul_f32 v241, v241, v239
v_mul_f32 v242, v242, v240
v_mfma_f32_16x16x32_bf16 a[244:247], v[180:183], a[180:183], a[244:247]
v_accvgpr_read_b32 v248, a236
v_accvgpr_read_b32 v249, a237
v_mfma_f32_16x16x32_bf16 a[244:247], v[184:187], a[184:187], a[244:247]
v_accvgpr_read_b32 v250, a238
v_accvgpr_read_b32 v251, a239
v_cvt_pk_bf16_f32 v246, v248, v249
v_mfma_f32_16x16x32_bf16 a[244:247], v[188:191], a[188:191], a[244:247]
v_cvt_pk_bf16_f32 v243, v241, v242
v_cvt_pk_bf16_f32 v247, v250, v251
ds_write_b64 v7, v[246:247] offset:13840
s_waitcnt lgkmcnt(0)
s_barrier
v_mfma_f32_16x16x32_bf16 a[244:247], v[128:131], v[192:195], a[244:247]
ds_write_b32 v4, v243 offset:28034
v_mfma_f32_16x16x32_bf16 a[248:251], v[160:163], v[192:195], a[248:251]
ds_write_b16 v4, v243 offset:32192
ds_write_b16_d16_hi v4, v243 offset:32194
v_mfma_f32_16x16x32_bf16 a[244:247], v[132:135], v[196:199], a[244:247]
ds_read_b128 v[192:195], v5 offset:6144
ds_read2_b32 v[64:65], v6 offset0:0 offset1:1
v_lshlrev_b32 v224, 16, v42
v_mfma_f32_16x16x32_bf16 a[248:251], v[164:167], v[196:199], a[248:251]
ds_read_b128 v[196:199], v5 offset:6208
v_lshlrev_b32 v225, 16, v38
v_mfma_f32_16x16x32_bf16 a[244:247], v[136:139], v[200:203], a[244:247]
ds_read2_b32 v[66:67], v6 offset0:2 offset1:3
v_lshlrev_b32 v226, 16, v54
v_lshlrev_b32 v227, 16, v58
v_mfma_f32_16x16x32_bf16 a[248:251], v[168:171], v[200:203], a[248:251]
ds_read_b128 v[200:203], v5 offset:6272
v_lshlrev_b32 v228, 16, v62
v_mfma_f32_16x16x32_bf16 a[244:247], v[140:143], v[204:207], a[244:247]
ds_read2_b32 v[68:69], v6 offset0:16 offset1:17
v_lshlrev_b32 v229, 16, v46
v_lshlrev_b32 v230, 16, v50
v_mfma_f32_16x16x32_bf16 a[248:251], v[172:175], v[204:207], a[248:251]
v_mul_f32 v231, s71, v228
v_mfma_f32_16x16x32_bf16 a[244:247], v[144:147], v[208:211], a[244:247]
ds_read_b128 v[204:207], v5 offset:6336
ds_read2_b32 v[70:71], v6 offset0:18 offset1:19
v_mul_f32 v232, s71, v227
v_mfma_f32_16x16x32_bf16 a[248:251], v[176:179], v[208:211], a[248:251]
v_fmac_f32 v231, s70, v227
v_fmac_f32 v232, s70, v226
v_mfma_f32_16x16x32_bf16 a[244:247], v[148:151], v[212:215], a[244:247]
ds_read_b128 v[208:211], v5 offset:6400
ds_read2_b32 v[72:73], v6 offset0:32 offset1:33
v_fmac_f32 v231, s69, v226
v_mfma_f32_16x16x32_bf16 a[248:251], v[180:183], v[212:215], a[248:251]
ds_read_b128 v[212:215], v5 offset:6464
v_fmac_f32 v232, s69, v225
v_mfma_f32_16x16x32_bf16 a[244:247], v[152:155], v[216:219], a[244:247]
ds_read2_b32 v[74:75], v6 offset0:34 offset1:35
v_fmac_f32 v231, s68, v225
v_fmac_f32 v232, s68, v224
v_mfma_f32_16x16x32_bf16 a[248:251], v[184:187], v[216:219], a[248:251]
ds_read_b128 v[216:219], v5 offset:6528
v_mul_f32 v231, v231, v229
v_mfma_f32_16x16x32_bf16 a[244:247], v[156:159], v[220:223], a[244:247]
ds_read2_b32 v[76:77], v6 offset0:48 offset1:49
v_mul_f32 v232, v232, v230
v_mfma_f32_16x16x32_bf16 a[248:251], v[188:191], v[220:223], a[248:251]
v_cvt_pk_bf16_f32 v233, v231, v232
ds_write_b32 v4, v233 offset:36354
s_waitcnt lgkmcnt(8)
v_mfma_f32_16x16x32_bf16 a[248:251], v[128:131], v[192:195], a[248:251]
ds_read_b128 v[220:223], v5 offset:6592
ds_read2_b32 v[78:79], v6 offset0:50 offset1:51
ds_write_b16 v4, v233 offset:40512
v_mfma_f32_16x16x32_bf16 a[252:255], v[160:163], v[192:195], a[252:255]
ds_write_b16_d16_hi v4, v233 offset:40514
v_mfma_f32_16x16x32_bf16 a[248:251], v[132:135], v[196:199], a[248:251]
ds_read_b128 v[192:195], v5 offset:5632
ds_read2_b32 v[80:81], v6 offset0:64 offset1:65
v_and_b32 v234, 0xffff0000, v42
v_and_b32 v235, 0xffff0000, v38
v_mfma_f32_16x16x32_bf16 a[252:255], v[164:167], v[196:199], a[252:255]
ds_read_b128 v[196:199], v5 offset:5696
v_and_b32 v236, 0xffff0000, v54
v_mfma_f32_16x16x32_bf16 a[248:251], v[136:139], v[200:203], a[248:251]
ds_read2_b32 v[82:83], v6 offset0:66 offset1:67
ds_read_b128 v[16:19], v11 offset:9216
v_and_b32 v237, 0xffff0000, v58
v_mfma_f32_16x16x32_bf16 a[252:255], v[168:171], v[200:203], a[252:255]
v_and_b32 v238, 0xffff0000, v62
v_and_b32 v239, 0xffff0000, v46
v_mfma_f32_16x16x32_bf16 a[248:251], v[140:143], v[204:207], a[248:251]
ds_read_b128 v[200:203], v5 offset:5760
ds_read2_b32 v[84:85], v6 offset0:80 offset1:81
ds_read_b128 v[20:23], v11 offset:10368
v_and_b32 v240, 0xffff0000, v50
v_mfma_f32_16x16x32_bf16 a[252:255], v[172:175], v[204:207], a[252:255]
v_mul_f32 v241, s75, v238
s_waitcnt lgkmcnt(11)
v_mfma_f32_16x16x32_bf16 a[248:251], v[144:147], v[208:211], a[248:251]
ds_read_b128 v[204:207], v5 offset:5824
ds_read2_b32 v[86:87], v6 offset0:82 offset1:83
s_add_u32 s94, s99, 1048576
v_mul_f32 v242, s75, v237
v_fmac_f32 v241, s74, v237
v_mfma_f32_16x16x32_bf16 a[252:255], v[176:179], v[208:211], a[252:255]
ds_read_b128 v[208:211], v5 offset:5888
v_fmac_f32 v242, s74, v236
v_mfma_f32_16x16x32_bf16 a[248:251], v[148:151], v[212:215], a[248:251]
ds_read2_b32 v[88:89], v6 offset0:96 offset1:97
s_add_u32 s95, s99, 1179648
v_fmac_f32 v241, s73, v236
v_fmac_f32 v242, s73, v235
v_mfma_f32_16x16x32_bf16 a[252:255], v[180:183], v[212:215], a[252:255]
ds_read_b128 v[212:215], v5 offset:5952
v_fmac_f32 v241, s72, v235
v_mfma_f32_16x16x32_bf16 a[248:251], v[152:155], v[216:219], a[248:251]
ds_read2_b32 v[90:91], v6 offset0:98 offset1:99
v_fmac_f32 v242, s72, v234
s_waitcnt lgkmcnt(6)
v_mfma_f32_16x16x32_bf16 a[252:255], v[184:187], v[216:219], a[252:255]
v_mul_f32 v241, v241, v239
v_mul_f32 v242, v242, v240
v_mfma_f32_16x16x32_bf16 a[248:251], v[156:159], v[220:223], a[248:251]
ds_read_b128 v[216:219], v5 offset:6016
ds_read2_b32 v[92:93], v6 offset0:112 offset1:113
buffer_store_dwordx4 v[16:19], v12, s[40:43], s94 offen sc1
v_cvt_pk_bf16_f32 v243, v241, v242
v_mfma_f32_16x16x32_bf16 a[252:255], v[188:191], v[220:223], a[252:255]
ds_write_b32 v4, v243 offset:44674
s_waitcnt lgkmcnt(8)
v_mfma_f32_16x16x32_bf16 a[252:255], v[128:131], v[192:195], a[252:255]
ds_read_b128 v[220:223], v5 offset:6080
ds_read2_b32 v[94:95], v6 offset0:114 offset1:115
ds_write_b16 v4, v243 offset:48832
ds_write_b16_d16_hi v4, v243 offset:48834
buffer_store_dwordx4 v[20:23], v12, s[40:43], s95 offen sc1
v_mfma_f32_16x16x32_bf16 a[252:255], v[132:135], v[196:199], a[252:255]
ds_read2_b32 v[96:97], v6 offset0:128 offset1:129
v_lshlrev_b32 v224, 16, v43
v_mfma_f32_16x16x32_bf16 a[252:255], v[136:139], v[200:203], a[252:255]
ds_read2_b32 v[98:99], v6 offset0:130 offset1:131
v_lshlrev_b32 v225, 16, v39
v_mfma_f32_16x16x32_bf16 a[252:255], v[140:143], v[204:207], a[252:255]
v_lshlrev_b32 v226, 16, v55
v_lshlrev_b32 v227, 16, v59
s_waitcnt lgkmcnt(5)
v_mfma_f32_16x16x32_bf16 a[252:255], v[144:147], v[208:211], a[252:255]
ds_read2_b32 v[100:101], v6 offset0:144 offset1:145
v_lshlrev_b32 v228, 16, v63
v_mfma_f32_16x16x32_bf16 a[252:255], v[148:151], v[212:215], a[252:255]
ds_read2_b32 v[102:103], v6 offset0:146 offset1:147
v_lshlrev_b32 v229, 16, v47
v_mfma_f32_16x16x32_bf16 a[252:255], v[152:155], v[216:219], a[252:255]
v_lshlrev_b32 v230, 16, v51
v_mul_f32 v231, s79, v228
v_mfma_f32_16x16x32_bf16 a[252:255], v[156:159], v[220:223], a[252:255]
ds_read2_b32 v[104:105], v6 offset0:160 offset1:161
v_mul_f32 v232, s79, v227
s_waitcnt lgkmcnt(7)
v_mfma_f32_16x16x32_bf16 a[208:211], v[64:67], a[0:3], a[208:211]
ds_read2_b32 v[106:107], v6 offset0:162 offset1:163
v_fmac_f32 v231, s78, v227
v_mfma_f32_16x16x32_bf16 a[208:211], v[68:71], a[4:7], a[208:211]
v_fmac_f32 v232, s78, v226
v_fmac_f32 v231, s77, v226
v_mfma_f32_16x16x32_bf16 a[208:211], v[72:75], a[8:11], a[208:211]
ds_read2_b32 v[108:109], v6 offset0:176 offset1:177
v_fmac_f32 v232, s77, v225
v_mfma_f32_16x16x32_bf16 a[208:211], v[76:79], a[12:15], a[208:211]
ds_read2_b32 v[110:111], v6 offset0:178 offset1:179
v_fmac_f32 v231, s76, v225
v_mfma_f32_16x16x32_bf16 a[208:211], v[80:83], a[16:19], a[208:211]
v_fmac_f32 v232, s76, v224
v_mul_f32 v231, v231, v229
v_mfma_f32_16x16x32_bf16 a[208:211], v[84:87], a[20:23], a[208:211]
ds_read2_b32 v[112:113], v6 offset0:192 offset1:193
v_mul_f32 v232, v232, v230
v_mfma_f32_16x16x32_bf16 a[208:211], v[88:91], a[24:27], a[208:211]
v_cvt_pk_bf16_f32 v233, v231, v232
v_mfma_f32_16x16x32_bf16 a[208:211], v[92:95], a[28:31], a[208:211]
ds_write_b32 v4, v233 offset:52994
ds_read2_b32 v[114:115], v6 offset0:194 offset1:195
ds_write_b16 v4, v233 offset:57152
v_mfma_f32_16x16x32_bf16 a[212:215], v[64:67], a[32:35], a[212:215]
ds_read2_b32 v[116:117], v6 offset0:208 offset1:209
ds_write_b16_d16_hi v4, v233 offset:57154
v_mfma_f32_16x16x32_bf16 a[212:215], v[68:71], a[36:39], a[212:215]
v_and_b32 v234, 0xffff0000, v43
v_and_b32 v235, 0xffff0000, v39
v_mfma_f32_16x16x32_bf16 a[212:215], v[72:75], a[40:43], a[212:215]
ds_read2_b32 v[118:119], v6 offset0:210 offset1:211
v_and_b32 v236, 0xffff0000, v55
v_mfma_f32_16x16x32_bf16 a[212:215], v[76:79], a[44:47], a[212:215]
ds_read2_b32 v[120:121], v6 offset0:224 offset1:225
v_and_b32 v237, 0xffff0000, v59
v_mfma_f32_16x16x32_bf16 a[212:215], v[80:83], a[48:51], a[212:215]
v_and_b32 v238, 0xffff0000, v63
v_and_b32 v239, 0xffff0000, v47
v_mfma_f32_16x16x32_bf16 a[212:215], v[84:87], a[52:55], a[212:215]
ds_read2_b32 v[122:123], v6 offset0:226 offset1:227
v_and_b32 v240, 0xffff0000, v51
v_mfma_f32_16x16x32_bf16 a[212:215], v[88:91], a[56:59], a[212:215]
ds_read2_b32 v[124:125], v6 offset0:240 offset1:241
v_mul_f32 v241, s83, v238
v_mfma_f32_16x16x32_bf16 a[212:215], v[92:95], a[60:63], a[212:215]
v_mul_f32 v242, s83, v237
v_fmac_f32 v241, s82, v237
v_mfma_f32_16x16x32_bf16 a[216:219], v[64:67], a[64:67], a[216:219]
ds_read2_b32 v[126:127], v6 offset0:242 offset1:243
v_fmac_f32 v242, s82, v236
v_mfma_f32_16x16x32_bf16 a[216:219], v[68:71], a[68:71], a[216:219]
v_fmac_f32 v241, s81, v236
v_fmac_f32 v242, s81, v235
v_mfma_f32_16x16x32_bf16 a[216:219], v[72:75], a[72:75], a[216:219]
ds_read2_b32 v[128:129], v9 offset0:0 offset1:1
v_fmac_f32 v241, s80, v235
v_mfma_f32_16x16x32_bf16 a[216:219], v[76:79], a[76:79], a[216:219]
ds_read2_b32 v[130:131], v9 offset0:2 offset1:3
v_fmac_f32 v242, s80, v234
v_mfma_f32_16x16x32_bf16 a[216:219], v[80:83], a[80:83], a[216:219]
ds_read2_b32 v[132:133], v9 offset0:16 offset1:17
v_mul_f32 v241, v241, v239
v_mfma_f32_16x16x32_bf16 a[216:219], v[84:87], a[84:87], a[216:219]
v_mul_f32 v242, v242, v240
v_cvt_pk_bf16_f32 v243, v241, v242
v_mfma_f32_16x16x32_bf16 a[216:219], v[88:91], a[88:91], a[216:219]
ds_read2_b32 v[134:135], v9 offset0:18 offset1:19
ds_write_b32 v4, v243 offset:61314
v_accvgpr_read_b32 v248, a208
v_mfma_f32_16x16x32_bf16 a[216:219], v[92:95], a[92:95], a[216:219]
ds_read2_b32 v[136:137], v9 offset0:32 offset1:33
ds_write_b16 v4, v243 offset:65472
v_accvgpr_read_b32 v249, a209
s_waitcnt lgkmcnt(7)
v_mfma_f32_16x16x32_bf16 a[212:215], v[96:99], a[0:3], a[212:215]
ds_read2_b32 v[138:139], v9 offset0:34 offset1:35
ds_write_b16_d16_hi v4, v243 offset:65474
v_mfma_f32_16x16x32_bf16 a[212:215], v[100:103], a[4:7], a[212:215]
ds_read2_b32 v[140:141], v9 offset0:48 offset1:49
v_accvgpr_read_b32 v250, a210
v_mfma_f32_16x16x32_bf16 a[212:215], v[104:107], a[8:11], a[212:215]
ds_read2_b32 v[142:143], v9 offset0:50 offset1:51
v_accvgpr_read_b32 v251, a211
v_mfma_f32_16x16x32_bf16 a[212:215], v[108:111], a[12:15], a[212:215]
ds_read2_b32 v[144:145], v9 offset0:64 offset1:65
s_lshl_b32 s97, s2, 2
v_mfma_f32_16x16x32_bf16 a[212:215], v[112:115], a[16:19], a[212:215]
ds_read2_b32 v[146:147], v9 offset0:66 offset1:67
v_cvt_pk_bf16_f32 v244, v248, v249
v_mfma_f32_16x16x32_bf16 a[212:215], v[116:119], a[20:23], a[212:215]
ds_read2_b32 v[148:149], v9 offset0:80 offset1:81
v_cvt_pk_bf16_f32 v245, v250, v251
v_mfma_f32_16x16x32_bf16 a[212:215], v[120:123], a[24:27], a[212:215]
ds_read2_b32 v[150:151], v9 offset0:82 offset1:83
s_add_u32 s97, s97, s3
v_mfma_f32_16x16x32_bf16 a[212:215], v[124:127], a[28:31], a[212:215]
ds_read2_b32 v[152:153], v9 offset0:96 offset1:97
ds_write_b64 v7, v[244:245] offset:0
v_mfma_f32_16x16x32_bf16 a[216:219], v[96:99], a[32:35], a[216:219]
ds_read2_b32 v[154:155], v9 offset0:98 offset1:99
s_lshl_b32 s97, s97, 7
v_mfma_f32_16x16x32_bf16 a[216:219], v[100:103], a[36:39], a[216:219]
ds_read_b128 v[192:195], v5 offset:2048
ds_read2_b32 v[156:157], v9 offset0:112 offset1:113
v_mfma_f32_16x16x32_bf16 a[216:219], v[104:107], a[40:43], a[216:219]
ds_read_b128 v[196:199], v5 offset:2112
ds_read2_b32 v[158:159], v9 offset0:114 offset1:115
v_mfma_f32_16x16x32_bf16 a[216:219], v[108:111], a[44:47], a[216:219]
ds_read_b128 v[200:203], v5 offset:2176
ds_read2_b32 v[160:161], v9 offset0:128 offset1:129
v_mfma_f32_16x16x32_bf16 a[216:219], v[112:115], a[48:51], a[216:219]
ds_read_b128 v[204:207], v5 offset:2240
ds_read2_b32 v[162:163], v9 offset0:130 offset1:131
v_mfma_f32_16x16x32_bf16 a[216:219], v[116:119], a[52:55], a[216:219]
ds_read_b128 v[208:211], v5 offset:2304
ds_read2_b32 v[164:165], v9 offset0:144 offset1:145
v_mfma_f32_16x16x32_bf16 a[216:219], v[120:123], a[56:59], a[216:219]
ds_read_b128 v[212:215], v5 offset:2368
ds_read2_b32 v[166:167], v9 offset0:146 offset1:147
v_mfma_f32_16x16x32_bf16 a[216:219], v[124:127], a[60:63], a[216:219]
ds_read_b128 v[216:219], v5 offset:2432
ds_read2_b32 v[168:169], v9 offset0:160 offset1:161
v_mfma_f32_16x16x32_bf16 a[220:223], v[96:99], a[64:67], a[220:223]
ds_read_b128 v[220:223], v5 offset:2496
ds_read2_b32 v[170:171], v9 offset0:162 offset1:163
v_mfma_f32_16x16x32_bf16 a[220:223], v[100:103], a[68:71], a[220:223]
ds_read2_b32 v[172:173], v9 offset0:176 offset1:177
v_and_b32 v10, 7, v1
v_mfma_f32_16x16x32_bf16 a[220:223], v[104:107], a[72:75], a[220:223]
ds_read2_b32 v[174:175], v9 offset0:178 offset1:179
v_lshlrev_b32 v10, 2, v10
v_mfma_f32_16x16x32_bf16 a[220:223], v[108:111], a[76:79], a[220:223]
ds_read2_b32 v[176:177], v9 offset0:192 offset1:193
ds_read2_b32 v[178:179], v9 offset0:194 offset1:195
v_mfma_f32_16x16x32_bf16 a[220:223], v[112:115], a[80:83], a[220:223]
buffer_store_dword v15, v10, s[36:39], s97 offen sc1
v_mfma_f32_16x16x32_bf16 a[220:223], v[116:119], a[84:87], a[220:223]
ds_read2_b32 v[180:181], v9 offset0:208 offset1:209
ds_read2_b32 v[182:183], v9 offset0:210 offset1:211
v_mfma_f32_16x16x32_bf16 a[220:223], v[120:123], a[88:91], a[220:223]
ds_read2_b32 v[184:185], v9 offset0:224 offset1:225
v_accvgpr_read_b32 v248, a212
v_mfma_f32_16x16x32_bf16 a[220:223], v[124:127], a[92:95], a[220:223]
v_accvgpr_read_b32 v249, a213
s_waitcnt lgkmcnt(15)
v_mfma_f32_16x16x32_bf16 a[220:223], v[64:67], v[192:195], a[220:223]
ds_read2_b32 v[186:187], v9 offset0:226 offset1:227
ds_read2_b32 v[188:189], v9 offset0:240 offset1:241
v_mfma_f32_16x16x32_bf16 a[220:223], v[68:71], v[196:199], a[220:223]
ds_read2_b32 v[190:191], v9 offset0:242 offset1:243
v_accvgpr_read_b32 v250, a214
v_mfma_f32_16x16x32_bf16 a[220:223], v[72:75], v[200:203], a[220:223]
v_accvgpr_read_b32 v251, a215
v_cvt_pk_bf16_f32 v246, v248, v249
v_mfma_f32_16x16x32_bf16 a[220:223], v[76:79], v[204:207], a[220:223]
v_cvt_pk_bf16_f32 v247, v250, v251
s_waitcnt lgkmcnt(11)
v_mfma_f32_16x16x32_bf16 a[220:223], v[80:83], v[208:211], a[220:223]
ds_write_b64 v7, v[246:247] offset:4608
v_mfma_f32_16x16x32_bf16 a[220:223], v[84:87], v[212:215], a[220:223]
v_mfma_f32_16x16x32_bf16 a[220:223], v[88:91], v[216:219], a[220:223]
v_mfma_f32_16x16x32_bf16 a[220:223], v[92:95], v[220:223], a[220:223]
v_mfma_f32_16x16x32_bf16 a[240:243], v[128:131], a[96:99], a[240:243]
v_add_u32 v6, 0x400, v6
v_add_u32 v9, 0x400, v9
v_mfma_f32_16x16x32_bf16 a[240:243], v[132:135], a[100:103], a[240:243]
v_mfma_f32_16x16x32_bf16 a[240:243], v[136:139], a[104:107], a[240:243]
v_mfma_f32_16x16x32_bf16 a[240:243], v[140:143], a[108:111], a[240:243]
v_mfma_f32_16x16x32_bf16 a[240:243], v[144:147], a[112:115], a[240:243]
v_mfma_f32_16x16x32_bf16 a[240:243], v[148:151], a[116:119], a[240:243]
v_mfma_f32_16x16x32_bf16 a[240:243], v[152:155], a[120:123], a[240:243]
v_mfma_f32_16x16x32_bf16 a[240:243], v[156:159], a[124:127], a[240:243]
v_mfma_f32_16x16x32_bf16 a[244:247], v[128:131], a[128:131], a[244:247]
v_mfma_f32_16x16x32_bf16 a[244:247], v[132:135], a[132:135], a[244:247]
v_mfma_f32_16x16x32_bf16 a[244:247], v[136:139], a[136:139], a[244:247]
v_mfma_f32_16x16x32_bf16 a[244:247], v[140:143], a[140:143], a[244:247]
v_mfma_f32_16x16x32_bf16 a[244:247], v[144:147], a[144:147], a[244:247]
v_mfma_f32_16x16x32_bf16 a[244:247], v[148:151], a[148:151], a[244:247]
v_mfma_f32_16x16x32_bf16 a[244:247], v[152:155], a[152:155], a[244:247]
v_mfma_f32_16x16x32_bf16 a[244:247], v[156:159], a[156:159], a[244:247]
s_barrier
v_mfma_f32_16x16x32_bf16 a[248:251], v[128:131], a[160:163], a[248:251]
v_accvgpr_read_b32 v248, a240
v_accvgpr_read_b32 v249, a241
v_mfma_f32_16x16x32_bf16 a[248:251], v[132:135], a[164:167], a[248:251]
ds_read2_b32 v[64:65], v6 offset0:0 offset1:1
v_accvgpr_read_b32 v250, a242
v_mfma_f32_16x16x32_bf16 a[248:251], v[136:139], a[168:171], a[248:251]
v_accvgpr_read_b32 v251, a243
v_cvt_pk_bf16_f32 v244, v248, v249
v_mfma_f32_16x16x32_bf16 a[248:251], v[140:143], a[172:175], a[248:251]
ds_read2_b32 v[66:67], v6 offset0:2 offset1:3
v_cvt_pk_bf16_f32 v245, v250, v251
v_mfma_f32_16x16x32_bf16 a[248:251], v[144:147], a[176:179], a[248:251]
ds_write_b64 v7, v[244:245] offset:16
v_mfma_f32_16x16x32_bf16 a[248:251], v[148:151], a[180:183], a[248:251]
ds_read2_b32 v[68:69], v6 offset0:16 offset1:17
v_mfma_f32_16x16x32_bf16 a[248:251], v[152:155], a[184:187], a[248:251]
v_mfma_f32_16x16x32_bf16 a[248:251], v[156:159], a[188:191], a[248:251]
ds_read2_b32 v[70:71], v6 offset0:18 offset1:19
s_waitcnt lgkmcnt(6)
v_mfma_f32_16x16x32_bf16 a[244:247], v[160:163], a[96:99], a[244:247]
v_mfma_f32_16x16x32_bf16 a[244:247], v[164:167], a[100:103], a[244:247]
ds_read2_b32 v[72:73], v6 offset0:32 offset1:33
v_mfma_f32_16x16x32_bf16 a[244:247], v[168:171], a[104:107], a[244:247]
v_mfma_f32_16x16x32_bf16 a[244:247], v[172:175], a[108:111], a[244:247]
ds_read2_b32 v[74:75], v6 offset0:34 offset1:35
v_mfma_f32_16x16x32_bf16 a[244:247], v[176:179], a[112:115], a[244:247]
v_mfma_f32_16x16x32_bf16 a[244:247], v[180:183], a[116:119], a[244:247]
ds_read2_b32 v[76:77], v6 offset0:48 offset1:49
v_mfma_f32_16x16x32_bf16 a[244:247], v[184:187], a[120:123], a[244:247]
v_mfma_f32_16x16x32_bf16 a[244:247], v[188:191], a[124:127], a[244:247]
ds_read2_b32 v[78:79], v6 offset0:50 offset1:51
v_mfma_f32_16x16x32_bf16 a[248:251], v[160:163], a[128:131], a[248:251]
ds_read_b128 v[192:195], v5 offset:6656
v_mfma_f32_16x16x32_bf16 a[248:251], v[164:167], a[132:135], a[248:251]
ds_read_b128 v[196:199], v5 offset:6720
ds_read2_b32 v[80:81], v6 offset0:64 offset1:65
v_mfma_f32_16x16x32_bf16 a[248:251], v[168:171], a[136:139], a[248:251]
ds_read_b128 v[200:203], v5 offset:6784
v_mfma_f32_16x16x32_bf16 a[248:251], v[172:175], a[140:143], a[248:251]
ds_read_b128 v[204:207], v5 offset:6848
ds_read2_b32 v[82:83], v6 offset0:66 offset1:67
v_mfma_f32_16x16x32_bf16 a[248:251], v[176:179], a[144:147], a[248:251]
ds_read_b128 v[208:211], v5 offset:6912
v_mfma_f32_16x16x32_bf16 a[248:251], v[180:183], a[148:151], a[248:251]
ds_read_b128 v[212:215], v5 offset:6976
ds_read2_b32 v[84:85], v6 offset0:80 offset1:81
v_mfma_f32_16x16x32_bf16 a[248:251], v[184:187], a[152:155], a[248:251]
ds_read_b128 v[216:219], v5 offset:7040
v_mfma_f32_16x16x32_bf16 a[248:251], v[188:191], a[156:159], a[248:251]
ds_read_b128 v[220:223], v5 offset:7104
ds_read2_b32 v[86:87], v6 offset0:82 offset1:83
v_mfma_f32_16x16x32_bf16 a[252:255], v[160:163], a[160:163], a[252:255]
v_accvgpr_read_b32 v248, a244
v_accvgpr_read_b32 v249, a245
v_mfma_f32_16x16x32_bf16 a[252:255], v[164:167], a[164:167], a[252:255]
ds_read2_b32 v[88:89], v6 offset0:96 offset1:97
v_accvgpr_read_b32 v250, a246
v_mfma_f32_16x16x32_bf16 a[252:255], v[168:171], a[168:171], a[252:255]
v_accvgpr_read_b32 v251, a247
v_cvt_pk_bf16_f32 v246, v248, v249
v_mfma_f32_16x16x32_bf16 a[252:255], v[172:175], a[172:175], a[252:255]
ds_read2_b32 v[90:91], v6 offset0:98 offset1:99
v_cvt_pk_bf16_f32 v247, v250, v251
v_mfma_f32_16x16x32_bf16 a[252:255], v[176:179], a[176:179], a[252:255]
ds_write_b64 v7, v[246:247] offset:4624
v_mfma_f32_16x16x32_bf16 a[252:255], v[180:183], a[180:183], a[252:255]
ds_read2_b32 v[92:93], v6 offset0:112 offset1:113
v_mfma_f32_16x16x32_bf16 a[252:255], v[184:187], a[184:187], a[252:255]
v_mfma_f32_16x16x32_bf16 a[252:255], v[188:191], a[188:191], a[252:255]
ds_read2_b32 v[94:95], v6 offset0:114 offset1:115
s_waitcnt lgkmcnt(12)
v_mfma_f32_16x16x32_bf16 a[252:255], v[128:131], v[192:195], a[252:255]
ds_read2_b32 v[96:97], v6 offset0:128 offset1:129
v_mfma_f32_16x16x32_bf16 a[252:255], v[132:135], v[196:199], a[252:255]
ds_read2_b32 v[98:99], v6 offset0:130 offset1:131
v_mfma_f32_16x16x32_bf16 a[252:255], v[136:139], v[200:203], a[252:255]
ds_read2_b32 v[100:101], v6 offset0:144 offset1:145
v_mfma_f32_16x16x32_bf16 a[252:255], v[140:143], v[204:207], a[252:255]
ds_read2_b32 v[102:103], v6 offset0:146 offset1:147
s_waitcnt lgkmcnt(10)
v_mfma_f32_16x16x32_bf16 a[252:255], v[144:147], v[208:211], a[252:255]
ds_read2_b32 v[104:105], v6 offset0:160 offset1:161
v_mfma_f32_16x16x32_bf16 a[252:255], v[148:151], v[212:215], a[252:255]
ds_read2_b32 v[106:107], v6 offset0:162 offset1:163
v_mfma_f32_16x16x32_bf16 a[252:255], v[152:155], v[216:219], a[252:255]
ds_read2_b32 v[108:109], v6 offset0:176 offset1:177
v_mfma_f32_16x16x32_bf16 a[252:255], v[156:159], v[220:223], a[252:255]
ds_read2_b32 v[110:111], v6 offset0:178 offset1:179
s_waitcnt lgkmcnt(8)
v_mfma_f32_16x16x32_bf16 a[216:219], v[64:67], a[0:3], a[216:219]
ds_read2_b32 v[112:113], v6 offset0:192 offset1:193
v_mfma_f32_16x16x32_bf16 a[216:219], v[68:71], a[4:7], a[216:219]
ds_read2_b32 v[114:115], v6 offset0:194 offset1:195
v_mfma_f32_16x16x32_bf16 a[216:219], v[72:75], a[8:11], a[216:219]
ds_read2_b32 v[116:117], v6 offset0:208 offset1:209
v_mfma_f32_16x16x32_bf16 a[216:219], v[76:79], a[12:15], a[216:219]
ds_read2_b32 v[118:119], v6 offset0:210 offset1:211
v_mfma_f32_16x16x32_bf16 a[216:219], v[80:83], a[16:19], a[216:219]
ds_read2_b32 v[120:121], v6 offset0:224 offset1:225
v_mfma_f32_16x16x32_bf16 a[216:219], v[84:87], a[20:23], a[216:219]
ds_read2_b32 v[122:123], v6 offset0:226 offset1:227
v_mfma_f32_16x16x32_bf16 a[216:219], v[88:91], a[24:27], a[216:219]
ds_read2_b32 v[124:125], v6 offset0:240 offset1:241
v_mfma_f32_16x16x32_bf16 a[216:219], v[92:95], a[28:31], a[216:219]
ds_read2_b32 v[126:127], v6 offset0:242 offset1:243
v_mfma_f32_16x16x32_bf16 a[220:223], v[64:67], a[32:35], a[220:223]
v_mfma_f32_16x16x32_bf16 a[220:223], v[68:71], a[36:39], a[220:223]
v_mfma_f32_16x16x32_bf16 a[220:223], v[72:75], a[40:43], a[220:223]
ds_read2_b32 v[128:129], v9 offset0:0 offset1:1
ds_read2_b32 v[130:131], v9 offset0:2 offset1:3
v_mfma_f32_16x16x32_bf16 a[220:223], v[76:79], a[44:47], a[220:223]
ds_read2_b32 v[132:133], v9 offset0:16 offset1:17
ds_read2_b32 v[134:135], v9 offset0:18 offset1:19
v_mfma_f32_16x16x32_bf16 a[220:223], v[80:83], a[48:51], a[220:223]
ds_read2_b32 v[136:137], v9 offset0:32 offset1:33
ds_read2_b32 v[138:139], v9 offset0:34 offset1:35
v_mfma_f32_16x16x32_bf16 a[220:223], v[84:87], a[52:55], a[220:223]
ds_read2_b32 v[140:141], v9 offset0:48 offset1:49
v_mfma_f32_16x16x32_bf16 a[220:223], v[88:91], a[56:59], a[220:223]
ds_read2_b32 v[142:143], v9 offset0:50 offset1:51
ds_read2_b32 v[144:145], v9 offset0:64 offset1:65
v_mfma_f32_16x16x32_bf16 a[220:223], v[92:95], a[60:63], a[220:223]
ds_read2_b32 v[146:147], v9 offset0:66 offset1:67
s_waitcnt lgkmcnt(10)
v_mfma_f32_16x16x32_bf16 a[220:223], v[96:99], a[0:3], a[220:223]
ds_read2_b32 v[148:149], v9 offset0:80 offset1:81
ds_read2_b32 v[150:151], v9 offset0:82 offset1:83
v_mfma_f32_16x16x32_bf16 a[220:223], v[100:103], a[4:7], a[220:223]
ds_read2_b32 v[152:153], v9 offset0:96 offset1:97
ds_read2_b32 v[154:155], v9 offset0:98 offset1:99
v_mfma_f32_16x16x32_bf16 a[220:223], v[104:107], a[8:11], a[220:223]
ds_read2_b32 v[156:157], v9 offset0:112 offset1:113
ds_read2_b32 v[158:159], v9 offset0:114 offset1:115
v_mfma_f32_16x16x32_bf16 a[220:223], v[108:111], a[12:15], a[220:223]
ds_read2_b32 v[160:161], v9 offset0:128 offset1:129
v_accvgpr_read_b32 v248, a216
v_mfma_f32_16x16x32_bf16 a[220:223], v[112:115], a[16:19], a[220:223]
ds_read2_b32 v[162:163], v9 offset0:130 offset1:131
ds_read2_b32 v[164:165], v9 offset0:144 offset1:145
v_mfma_f32_16x16x32_bf16 a[220:223], v[116:119], a[20:23], a[220:223]
ds_read2_b32 v[166:167], v9 offset0:146 offset1:147
v_accvgpr_read_b32 v249, a217
v_mfma_f32_16x16x32_bf16 a[220:223], v[120:123], a[24:27], a[220:223]
ds_read2_b32 v[168:169], v9 offset0:160 offset1:161
ds_read2_b32 v[170:171], v9 offset0:162 offset1:163
v_mfma_f32_16x16x32_bf16 a[220:223], v[124:127], a[28:31], a[220:223]
ds_read2_b32 v[172:173], v9 offset0:176 offset1:177
s_waitcnt lgkmcnt(7)
v_mfma_f32_16x16x32_bf16 a[248:251], v[128:131], a[96:99], a[248:251]
ds_read2_b32 v[174:175], v9 offset0:178 offset1:179
ds_read2_b32 v[176:177], v9 offset0:192 offset1:193
v_mfma_f32_16x16x32_bf16 a[248:251], v[132:135], a[100:103], a[248:251]
ds_read2_b32 v[178:179], v9 offset0:194 offset1:195
v_accvgpr_read_b32 v250, a218
v_mfma_f32_16x16x32_bf16 a[248:251], v[136:139], a[104:107], a[248:251]
ds_read2_b32 v[180:181], v9 offset0:208 offset1:209
v_accvgpr_read_b32 v251, a219
v_mfma_f32_16x16x32_bf16 a[248:251], v[140:143], a[108:111], a[248:251]
ds_read2_b32 v[182:183], v9 offset0:210 offset1:211
ds_read2_b32 v[184:185], v9 offset0:224 offset1:225
v_mfma_f32_16x16x32_bf16 a[248:251], v[144:147], a[112:115], a[248:251]
ds_read2_b32 v[186:187], v9 offset0:226 offset1:227
v_cvt_pk_bf16_f32 v244, v248, v249
v_mfma_f32_16x16x32_bf16 a[248:251], v[148:151], a[116:119], a[248:251]
ds_read2_b32 v[188:189], v9 offset0:240 offset1:241
v_cvt_pk_bf16_f32 v245, v250, v251
v_mfma_f32_16x16x32_bf16 a[248:251], v[152:155], a[120:123], a[248:251]
ds_read2_b32 v[190:191], v9 offset0:242 offset1:243
v_mfma_f32_16x16x32_bf16 a[248:251], v[156:159], a[124:127], a[248:251]
ds_write_b64 v7, v[244:245] offset:9216
v_mfma_f32_16x16x32_bf16 a[252:255], v[128:131], a[128:131], a[252:255]
v_accvgpr_read_b32 v248, a220
v_accvgpr_read_b32 v249, a221
v_mfma_f32_16x16x32_bf16 a[252:255], v[132:135], a[132:135], a[252:255]
v_accvgpr_read_b32 v250, a222
v_accvgpr_read_b32 v251, a223
v_mfma_f32_16x16x32_bf16 a[252:255], v[136:139], a[136:139], a[252:255]
v_cvt_pk_bf16_f32 v246, v248, v249
v_cvt_pk_bf16_f32 v247, v250, v251
v_mfma_f32_16x16x32_bf16 a[252:255], v[140:143], a[140:143], a[252:255]
ds_write_b64 v7, v[246:247] offset:13824
v_mfma_f32_16x16x32_bf16 a[252:255], v[144:147], a[144:147], a[252:255]
v_mfma_f32_16x16x32_bf16 a[252:255], v[148:151], a[148:151], a[252:255]
v_mfma_f32_16x16x32_bf16 a[252:255], v[152:155], a[152:155], a[252:255]
v_mfma_f32_16x16x32_bf16 a[252:255], v[156:159], a[156:159], a[252:255]
s_waitcnt lgkmcnt(2)
v_mfma_f32_16x16x32_bf16 a[252:255], v[160:163], a[96:99], a[252:255]
v_accvgpr_read_b32 v248, a248
v_accvgpr_read_b32 v249, a249
v_mfma_f32_16x16x32_bf16 a[252:255], v[164:167], a[100:103], a[252:255]
v_accvgpr_read_b32 v250, a250
v_accvgpr_read_b32 v251, a251
v_mfma_f32_16x16x32_bf16 a[252:255], v[168:171], a[104:107], a[252:255]
v_cvt_pk_bf16_f32 v244, v248, v249
v_cvt_pk_bf16_f32 v245, v250, v251
v_mfma_f32_16x16x32_bf16 a[252:255], v[172:175], a[108:111], a[252:255]
ds_write_b64 v7, v[244:245] offset:9232
v_mfma_f32_16x16x32_bf16 a[252:255], v[176:179], a[112:115], a[252:255]
v_mfma_f32_16x16x32_bf16 a[252:255], v[180:183], a[116:119], a[252:255]
v_mfma_f32_16x16x32_bf16 a[252:255], v[184:187], a[120:123], a[252:255]
v_mfma_f32_16x16x32_bf16 a[252:255], v[188:191], a[124:127], a[252:255]
s_nop 7
v_accvgpr_read_b32 v248, a252
v_accvgpr_read_b32 v249, a253
v_accvgpr_read_b32 v250, a254
v_accvgpr_read_b32 v251, a255
v_cvt_pk_bf16_f32 v246, v248, v249
v_cvt_pk_bf16_f32 v247, v250, v251
ds_write_b64 v7, v[246:247] offset:13840
s_waitcnt lgkmcnt(0)
s_barrier
ds_read_b128 v[64:67], v11 offset:0
ds_read_b128 v[68:71], v11 offset:1152
ds_read_b128 v[72:75], v11 offset:9216
ds_read_b128 v[76:79], v11 offset:10368
s_add_u32 s94, s99, 2097152
s_add_u32 s95, s99, 2228224
s_waitcnt lgkmcnt(2)
buffer_store_dwordx4 v[64:67], v12, s[40:43], s94 offen sc1
buffer_store_dwordx4 v[68:71], v12, s[40:43], s95 offen sc1
s_add_u32 s94, s99, 3145728
s_add_u32 s95, s99, 3276800
s_waitcnt lgkmcnt(0)
buffer_store_dwordx4 v[72:75], v12, s[40:43], s94 offen sc1
buffer_store_dwordx4 v[76:79], v12, s[40:43], s95 offen sc1
s_endpgm
conv_kernel_aux:
s_load_dwordx2 s[12:13], s[0:1], 0
s_load_dwordx4 s[16:19], s[0:1], 72
s_load_dwordx4 s[40:43], s[0:1], 56
v_lshrrev_b32 v10, 1, v1
v_lshlrev_b32 v10, 11, v10
v_and_b32 v11, 1, v1
v_lshl_add_u32 v10, v11, 7, v10
s_lshl_b32 s94, s89, 2
s_add_u32 s94, s94, s3
s_lshl_b32 s93, s94, 16
s_lshl_b32 s95, s88, 8
s_add_u32 s93, s93, s95
s_and_b32 s91, s89, 7
s_lshl_b32 s92, s88, 3
s_add_u32 s91, s91, s92
s_lshr_b32 s92, s89, 3
v_lshrrev_b32 v12, 4, v1
v_lshlrev_b32 v11, 6, v12
s_mov_b32 s95, 393216
v_mul_lo_u32 v9, s95, v12
v_and_b32 v13, 15, v1
v_mul_u32_u24 v14, 12, v13
v_add_u32 v9, v9, v14
s_lshl_b32 s96, s92, 2
s_add_u32 s96, s96, s3
s_lshl_b32 s97, s96, 8
s_mul_i32 s96, s96, 1572864
s_mul_i32 s95, s91, 192
s_add_u32 s96, s96, s95
s_waitcnt lgkmcnt(0)
s_mov_b32 s24, s4
s_and_b32 s25, s5, 0xffff
s_mov_b32 s26, 4194304
s_mov_b32 s27, 0x00020000
s_mov_b32 s28, s6
s_and_b32 s29, s7, 0xffff
s_mov_b32 s30, 4194304
s_mov_b32 s31, 0x00020000
v_mov_b32 v14, 1073741824
v_cmp_gt_u32 vcc, 16, v1
s_lshl_b32 s93, s94, 14
s_lshl_b32 s95, s88, 8
v_cndmask_b32 v15, v14, v10, vcc
v_cmp_gt_u32 vcc, 48, v1
s_add_u32 s93, s93, s95
s_mul_i32 s98, s94, 49152
v_cndmask_b32 v10, v14, v10, vcc
s_add_u32 s98, s98, s95
s_add_u32 s98, s98, 1048576
buffer_load_dword v255, v15, s[24:27], s93 offen
buffer_load_dword v255, v15, s[28:31], s93 offen
s_mov_b32 s32, s16
s_and_b32 s33, s17, 0xffff
s_mov_b32 s34, 2048
s_mov_b32 s35, 0x00020000
s_mov_b32 s36, s18
s_and_b32 s37, s19, 0xffff
s_mov_b32 s38, 12582912
s_mov_b32 s39, 0x00020000
buffer_load_dwordx4 v[16:19], v11, s[32:35], s97 offen offset:0
buffer_load_dwordx4 v[20:23], v11, s[32:35], s97 offen offset:16
buffer_load_dwordx4 v[24:27], v11, s[32:35], s97 offen offset:32
buffer_load_dwordx4 v[28:31], v11, s[32:35], s97 offen offset:48
s_waitcnt vmcnt(4)
buffer_load_dword v255, v10, s[24:27], s98 offen
buffer_load_dword v255, v10, s[28:31], s98 offen
buffer_load_dwordx3 v[96:98], v9, s[36:39], s96 offen
s_add_u32 s96, s96, 12288
buffer_load_dwordx3 v[100:102], v9, s[36:39], s96 offen
s_add_u32 s96, s96, 12288
buffer_load_dwordx3 v[104:106], v9, s[36:39], s96 offen
s_add_u32 s96, s96, 12288
buffer_load_dwordx3 v[108:110], v9, s[36:39], s96 offen
s_add_u32 s96, s96, 12288
s_mov_b32 s44, s12
s_and_b32 s45, s13, 0xffff
s_mov_b32 s46, 4194304
s_mov_b32 s47, 0x00020000
s_mov_b32 s48, s40
s_and_b32 s49, s41, 0xffff
s_mov_b32 s50, 7340032
s_mov_b32 s51, 0x00020000
s_mov_b32 s56, s42
s_and_b32 s57, s43, 0xffff
s_mov_b32 s58, 7340032
s_mov_b32 s59, 0x00020000
s_add_u32 s52, s22, 262144
s_addc_u32 s53, s23, 0
s_and_b32 s53, s53, 0xffff
s_mov_b32 s54, 131072
s_mov_b32 s55, 0x00020000
s_add_u32 s60, s22, 0
s_addc_u32 s61, s23, 0
s_and_b32 s61, s61, 0xffff
s_mov_b32 s62, 49152
s_mov_b32 s63, 0x00020000
s_waitcnt vmcnt(6)
v_lshlrev_b32 v32, 16, v16
v_and_b32 v33, 0xffff0000, v16
v_lshlrev_b32 v34, 16, v17
v_and_b32 v35, 0xffff0000, v17
v_lshlrev_b32 v36, 16, v18
v_and_b32 v37, 0xffff0000, v18
v_lshlrev_b32 v38, 16, v19
v_and_b32 v39, 0xffff0000, v19
v_lshlrev_b32 v40, 16, v20
v_and_b32 v41, 0xffff0000, v20
v_lshlrev_b32 v42, 16, v21
v_and_b32 v43, 0xffff0000, v21
v_lshlrev_b32 v44, 16, v22
v_and_b32 v45, 0xffff0000, v22
v_lshlrev_b32 v46, 16, v23
v_and_b32 v47, 0xffff0000, v23
v_lshlrev_b32 v48, 16, v24
v_and_b32 v49, 0xffff0000, v24
v_lshlrev_b32 v50, 16, v25
v_and_b32 v51, 0xffff0000, v25
v_lshlrev_b32 v52, 16, v26
v_and_b32 v53, 0xffff0000, v26
v_lshlrev_b32 v54, 16, v27
v_and_b32 v55, 0xffff0000, v27
v_lshlrev_b32 v56, 16, v28
v_and_b32 v57, 0xffff0000, v28
v_lshlrev_b32 v58, 16, v29
v_and_b32 v59, 0xffff0000, v29
v_lshlrev_b32 v60, 16, v30
v_and_b32 v61, 0xffff0000, v30
v_lshlrev_b32 v62, 16, v31
v_and_b32 v63, 0xffff0000, v31
v_mul_f32 v64, 0xbfb8aa3b, v32
v_mul_f32 v65, 0xbfb8aa3b, v33
v_mul_f32 v66, 0xbfb8aa3b, v34
v_mul_f32 v67, 0xbfb8aa3b, v35
v_mul_f32 v68, 0xbfb8aa3b, v36
v_mul_f32 v69, 0xbfb8aa3b, v37
v_mul_f32 v70, 0xbfb8aa3b, v38
v_mul_f32 v71, 0xbfb8aa3b, v39
v_mul_f32 v72, 0xbfb8aa3b, v40
v_mul_f32 v73, 0xbfb8aa3b, v41
v_mul_f32 v74, 0xbfb8aa3b, v42
v_mul_f32 v75, 0xbfb8aa3b, v43
v_mul_f32 v76, 0xbfb8aa3b, v44
v_mul_f32 v77, 0xbfb8aa3b, v45
v_mul_f32 v78, 0xbfb8aa3b, v46
v_mul_f32 v79, 0xbfb8aa3b, v47
v_mul_f32 v80, 0xbfb8aa3b, v48
v_mul_f32 v81, 0xbfb8aa3b, v49
v_mul_f32 v82, 0xbfb8aa3b, v50
v_mul_f32 v83, 0xbfb8aa3b, v51
v_mul_f32 v84, 0xbfb8aa3b, v52
v_mul_f32 v85, 0xbfb8aa3b, v53
v_mul_f32 v86, 0xbfb8aa3b, v54
v_mul_f32 v87, 0xbfb8aa3b, v55
v_mul_f32 v88, 0xbfb8aa3b, v56
v_mul_f32 v89, 0xbfb8aa3b, v57
v_mul_f32 v90, 0xbfb8aa3b, v58
v_mul_f32 v91, 0xbfb8aa3b, v59
v_mul_f32 v92, 0xbfb8aa3b, v60
v_mul_f32 v93, 0xbfb8aa3b, v61
v_mul_f32 v94, 0xbfb8aa3b, v62
v_mul_f32 v95, 0xbfb8aa3b, v63
v_exp_f32 v64, v64
v_exp_f32 v65, v65
v_exp_f32 v66, v66
v_exp_f32 v67, v67
v_exp_f32 v68, v68
v_exp_f32 v69, v69
v_exp_f32 v70, v70
v_exp_f32 v71, v71
v_exp_f32 v72, v72
v_exp_f32 v73, v73
v_exp_f32 v74, v74
v_exp_f32 v75, v75
v_exp_f32 v76, v76
v_exp_f32 v77, v77
v_exp_f32 v78, v78
v_exp_f32 v79, v79
v_exp_f32 v80, v80
v_exp_f32 v81, v81
v_exp_f32 v82, v82
v_exp_f32 v83, v83
v_exp_f32 v84, v84
v_exp_f32 v85, v85
v_exp_f32 v86, v86
v_exp_f32 v87, v87
v_exp_f32 v88, v88
v_exp_f32 v89, v89
v_exp_f32 v90, v90
v_exp_f32 v91, v91
v_exp_f32 v92, v92
v_exp_f32 v93, v93
v_exp_f32 v94, v94
v_exp_f32 v95, v95
buffer_load_dwordx3 v[112:114], v9, s[36:39], s96 offen
s_add_u32 s96, s96, 12288
buffer_load_dwordx3 v[116:118], v9, s[36:39], s96 offen
s_add_u32 s96, s96, 12288
buffer_load_dwordx3 v[120:122], v9, s[36:39], s96 offen
s_add_u32 s96, s96, 12288
buffer_load_dwordx3 v[124:126], v9, s[36:39], s96 offen
s_add_u32 s96, s96, 12288
buffer_load_dwordx3 v[128:130], v9, s[36:39], s96 offen
s_add_u32 s96, s96, 12288
buffer_load_dwordx3 v[132:134], v9, s[36:39], s96 offen
s_add_u32 s96, s96, 12288
v_add_f32 v64, 1.0, v64
v_add_f32 v65, 1.0, v65
v_add_f32 v66, 1.0, v66
v_add_f32 v67, 1.0, v67
v_add_f32 v68, 1.0, v68
v_add_f32 v69, 1.0, v69
v_add_f32 v70, 1.0, v70
v_add_f32 v71, 1.0, v71
v_add_f32 v72, 1.0, v72
v_add_f32 v73, 1.0, v73
v_add_f32 v74, 1.0, v74
v_add_f32 v75, 1.0, v75
v_add_f32 v76, 1.0, v76
v_add_f32 v77, 1.0, v77
v_add_f32 v78, 1.0, v78
v_add_f32 v79, 1.0, v79
v_add_f32 v80, 1.0, v80
v_add_f32 v81, 1.0, v81
v_add_f32 v82, 1.0, v82
v_add_f32 v83, 1.0, v83
v_add_f32 v84, 1.0, v84
v_add_f32 v85, 1.0, v85
v_add_f32 v86, 1.0, v86
v_add_f32 v87, 1.0, v87
v_add_f32 v88, 1.0, v88
v_add_f32 v89, 1.0, v89
v_add_f32 v90, 1.0, v90
v_add_f32 v91, 1.0, v91
v_add_f32 v92, 1.0, v92
v_add_f32 v93, 1.0, v93
v_add_f32 v94, 1.0, v94
v_add_f32 v95, 1.0, v95
v_rcp_f32 v64, v64
v_rcp_f32 v65, v65
v_rcp_f32 v66, v66
v_rcp_f32 v67, v67
v_rcp_f32 v68, v68
v_rcp_f32 v69, v69
v_rcp_f32 v70, v70
v_rcp_f32 v71, v71
v_rcp_f32 v72, v72
v_rcp_f32 v73, v73
v_rcp_f32 v74, v74
v_rcp_f32 v75, v75
v_rcp_f32 v76, v76
v_rcp_f32 v77, v77
v_rcp_f32 v78, v78
v_rcp_f32 v79, v79
v_rcp_f32 v80, v80
v_rcp_f32 v81, v81
v_rcp_f32 v82, v82
v_rcp_f32 v83, v83
v_rcp_f32 v84, v84
v_rcp_f32 v85, v85
v_rcp_f32 v86, v86
v_rcp_f32 v87, v87
v_rcp_f32 v88, v88
v_rcp_f32 v89, v89
v_rcp_f32 v90, v90
v_rcp_f32 v91, v91
v_rcp_f32 v92, v92
v_rcp_f32 v93, v93
v_rcp_f32 v94, v94
v_rcp_f32 v95, v95
v_mul_f32 v64, v32, v64
v_mul_f32 v65, v33, v65
v_mul_f32 v66, v34, v66
v_mul_f32 v67, v35, v67
v_mul_f32 v68, v36, v68
v_mul_f32 v69, v37, v69
v_mul_f32 v70, v38, v70
v_mul_f32 v71, v39, v71
v_mul_f32 v72, v40, v72
v_mul_f32 v73, v41, v73
v_mul_f32 v74, v42, v74
v_mul_f32 v75, v43, v75
v_mul_f32 v76, v44, v76
v_mul_f32 v77, v45, v77
v_mul_f32 v78, v46, v78
v_mul_f32 v79, v47, v79
v_mul_f32 v80, v48, v80
v_mul_f32 v81, v49, v81
v_mul_f32 v82, v50, v82
v_mul_f32 v83, v51, v83
v_mul_f32 v84, v52, v84
v_mul_f32 v85, v53, v85
v_mul_f32 v86, v54, v86
v_mul_f32 v87, v55, v87
v_mul_f32 v88, v56, v88
v_mul_f32 v89, v57, v89
v_mul_f32 v90, v58, v90
v_mul_f32 v91, v59, v91
v_mul_f32 v92, v60, v92
v_mul_f32 v93, v61, v93
v_mul_f32 v94, v62, v94
v_mul_f32 v95, v63, v95
v_cvt_pk_bf16_f32 v16, v64, v65
v_cvt_pk_bf16_f32 v17, v66, v67
v_cvt_pk_bf16_f32 v18, v68, v69
v_cvt_pk_bf16_f32 v19, v70, v71
v_cvt_pk_bf16_f32 v20, v72, v73
v_cvt_pk_bf16_f32 v21, v74, v75
v_cvt_pk_bf16_f32 v22, v76, v77
v_cvt_pk_bf16_f32 v23, v78, v79
v_cvt_pk_bf16_f32 v24, v80, v81
v_cvt_pk_bf16_f32 v25, v82, v83
v_cvt_pk_bf16_f32 v26, v84, v85
v_cvt_pk_bf16_f32 v27, v86, v87
v_cvt_pk_bf16_f32 v28, v88, v89
v_cvt_pk_bf16_f32 v29, v90, v91
v_cvt_pk_bf16_f32 v30, v92, v93
v_cvt_pk_bf16_f32 v31, v94, v95
v_lshlrev_b32 v32, 16, v16
v_and_b32 v33, 0xffff0000, v16
v_lshlrev_b32 v34, 16, v17
v_and_b32 v35, 0xffff0000, v17
v_lshlrev_b32 v36, 16, v18
v_and_b32 v37, 0xffff0000, v18
v_lshlrev_b32 v38, 16, v19
v_and_b32 v39, 0xffff0000, v19
v_lshlrev_b32 v40, 16, v20
v_and_b32 v41, 0xffff0000, v20
v_lshlrev_b32 v42, 16, v21
v_and_b32 v43, 0xffff0000, v21
v_lshlrev_b32 v44, 16, v22
v_and_b32 v45, 0xffff0000, v22
v_lshlrev_b32 v46, 16, v23
v_and_b32 v47, 0xffff0000, v23
v_lshlrev_b32 v48, 16, v24
v_and_b32 v49, 0xffff0000, v24
v_lshlrev_b32 v50, 16, v25
v_and_b32 v51, 0xffff0000, v25
v_lshlrev_b32 v52, 16, v26
v_and_b32 v53, 0xffff0000, v26
v_lshlrev_b32 v54, 16, v27
v_and_b32 v55, 0xffff0000, v27
v_lshlrev_b32 v56, 16, v28
v_and_b32 v57, 0xffff0000, v28
v_lshlrev_b32 v58, 16, v29
v_and_b32 v59, 0xffff0000, v29
v_lshlrev_b32 v60, 16, v30
v_and_b32 v61, 0xffff0000, v30
v_lshlrev_b32 v62, 16, v31
v_and_b32 v63, 0xffff0000, v31
buffer_load_dwordx3 v[136:138], v9, s[36:39], s96 offen
s_add_u32 s96, s96, 12288
buffer_load_dwordx3 v[140:142], v9, s[36:39], s96 offen
s_add_u32 s96, s96, 12288
buffer_load_dwordx3 v[144:146], v9, s[36:39], s96 offen
s_add_u32 s96, s96, 12288
buffer_load_dwordx3 v[148:150], v9, s[36:39], s96 offen
s_add_u32 s96, s96, 12288
buffer_load_dwordx3 v[152:154], v9, s[36:39], s96 offen
s_add_u32 s96, s96, 12288
buffer_load_dwordx3 v[156:158], v9, s[36:39], s96 offen
s_add_u32 s96, s96, 12288
buffer_load_dwordx3 v[160:162], v9, s[36:39], s96 offen
s_add_u32 s96, s96, 12288
buffer_load_dwordx3 v[164:166], v9, s[36:39], s96 offen
s_add_u32 s96, s96, 12288
buffer_load_dwordx3 v[168:170], v9, s[36:39], s96 offen
s_add_u32 s96, s96, 12288
buffer_load_dwordx3 v[172:174], v9, s[36:39], s96 offen
s_add_u32 s96, s96, 12288
buffer_load_dwordx3 v[176:178], v9, s[36:39], s96 offen
s_add_u32 s96, s96, 12288
buffer_load_dwordx3 v[180:182], v9, s[36:39], s96 offen
s_add_u32 s96, s96, 12288
buffer_load_dwordx3 v[184:186], v9, s[36:39], s96 offen
s_add_u32 s96, s96, 12288
buffer_load_dwordx3 v[188:190], v9, s[36:39], s96 offen
s_add_u32 s96, s96, 12288
buffer_load_dwordx3 v[192:194], v9, s[36:39], s96 offen
s_add_u32 s96, s96, 12288
buffer_load_dwordx3 v[196:198], v9, s[36:39], s96 offen
s_add_u32 s96, s96, 12288
buffer_load_dwordx3 v[200:202], v9, s[36:39], s96 offen
s_add_u32 s96, s96, 12288
buffer_load_dwordx3 v[204:206], v9, s[36:39], s96 offen
s_add_u32 s96, s96, 12288
buffer_load_dwordx3 v[208:210], v9, s[36:39], s96 offen
s_add_u32 s96, s96, 12288
buffer_load_dwordx3 v[212:214], v9, s[36:39], s96 offen
s_add_u32 s96, s96, 12288
buffer_load_dwordx3 v[216:218], v9, s[36:39], s96 offen
s_add_u32 s96, s96, 12288
buffer_load_dwordx3 v[220:222], v9, s[36:39], s96 offen
s_add_u32 s96, s96, 12288
s_lshr_b32 s95, s88, 2
s_lshl_b32 s95, s95, 3
s_lshr_b32 s96, s94, 3
s_add_u32 s95, s95, s96
s_lshl_b32 s95, s95, 7
s_and_b32 s96, s88, 3
s_lshl_b32 s96, s96, 5
s_add_u32 s95, s95, s96
s_and_b32 s96, s94, 7
s_lshl_b32 s96, s96, 2
s_add_u32 s95, s95, s96
s_lshl_b32 s90, s95, 3
s_lshl_b32 s95, s95, 11
v_lshlrev_b32 v10, 4, v1
v_add_u32 v8, 0x1000, v10
buffer_load_dwordx4 v[224:227], v10, s[44:47], s95 offen offset:0
buffer_load_dwordx4 v[228:231], v10, s[44:47], s95 offen offset:1024
buffer_load_dwordx4 v[232:235], v10, s[44:47], s95 offen offset:2048
buffer_load_dwordx4 v[236:239], v10, s[44:47], s95 offen offset:3072
buffer_load_dwordx4 v[240:243], v8, s[44:47], s95 offen offset:0
buffer_load_dwordx4 v[244:247], v8, s[44:47], s95 offen offset:1024
buffer_load_dwordx4 v[248:251], v8, s[44:47], s95 offen offset:2048
buffer_load_dwordx4 v[252:255], v8, s[44:47], s95 offen offset:3072
s_lshl_b32 s95, s88, 6
s_add_u32 s95, s95, s94
s_mul_i32 s95, s95, 14336
s_add_u32 s96, s95, 7168
v_min_u32 v10, 55, v1
v_lshlrev_b32 v10, 7, v10
s_getpc_b64 s[64:65]
conv_kernel_pc:
s_add_u32 s64, s64, mlp_kernel-conv_kernel_pc
s_addc_u32 s65, s65, 0
s_and_b32 s65, s65, 0xffff
s_mov_b32 s66, mlp_kernel_end-mlp_kernel
s_mov_b32 s67, 0x00020000
s_lshl_b32 s68, s94, 13
v_lshlrev_b32 v6, 7, v1
v_lshlrev_b32 v5, 19, v1
s_mov_b32 s72, s22
s_and_b32 s73, s23, 0xffff
s_mov_b32 s74, 0x2400000
s_mov_b32 s75, 0x00020000
s_lshl_b32 s69, s94, 13
buffer_load_dword v7, v6, s[64:67], s68 offen
buffer_load_dword v7, v10, s[56:59], s95 offen
buffer_load_dword v7, v10, s[56:59], s96 offen
s_and_b32 s95, s88, 3
s_mul_i32 s95, s95, 1792
s_mul_i32 s96, s94, 114688
s_add_u32 s95, s95, s96
v_lshrrev_b32 v10, 3, v1
v_mul_u32_u24 v10, 7168, v10
v_bfe_u32 v6, v1, 2, 1
v_mul_u32_u24 v6, 896, v6
v_add_u32 v10, v10, v6
v_and_b32 v6, 1, v1
v_lshl_add_u32 v5, v6, 7, v10
v_bfe_u32 v6, v1, 1, 1
v_lshl_add_u32 v5, v6, 9, v5
v_and_b32 v6, 3, v1
v_add_u32 v4, 2, v6
v_min_u32 v4, 4, v4
v_lshrrev_b32 v6, 1, v6
v_lshl_add_u32 v4, v6, 1, v4
v_lshl_add_u32 v4, v4, 7, v10
s_add_u32 s96, s95, 57344
buffer_load_dword v7, v5, s[48:51], s95 offen
buffer_load_dword v7, v5, s[48:51], s96 offen
s_waitcnt vmcnt(37)
v_lshlrev_b32 v64, 16, v96
v_and_b32 v65, 0xffff0000, v96
v_lshlrev_b32 v66, 16, v97
v_and_b32 v67, 0xffff0000, v97
v_lshlrev_b32 v68, 16, v98
v_and_b32 v69, 0xffff0000, v98
v_mul_f32 v72, v32, v64
v_mul_f32 v73, v32, v65
v_mul_f32 v74, v32, v66
v_mul_f32 v75, v32, v67
v_mul_f32 v76, v32, v68
v_mul_f32 v77, v32, v69
v_lshlrev_b32 v64, 16, v100
v_and_b32 v65, 0xffff0000, v100
v_lshlrev_b32 v66, 16, v101
v_and_b32 v67, 0xffff0000, v101
v_lshlrev_b32 v68, 16, v102
v_and_b32 v69, 0xffff0000, v102
v_fmac_f32 v72, v33, v64
v_fmac_f32 v73, v33, v65
v_fmac_f32 v74, v33, v66
v_fmac_f32 v75, v33, v67
v_fmac_f32 v76, v33, v68
v_fmac_f32 v77, v33, v69
v_lshlrev_b32 v64, 16, v104
v_and_b32 v65, 0xffff0000, v104
v_lshlrev_b32 v66, 16, v105
v_and_b32 v67, 0xffff0000, v105
v_lshlrev_b32 v68, 16, v106
v_and_b32 v69, 0xffff0000, v106
v_fmac_f32 v72, v34, v64
v_fmac_f32 v73, v34, v65
v_fmac_f32 v74, v34, v66
v_fmac_f32 v75, v34, v67
v_fmac_f32 v76, v34, v68
v_fmac_f32 v77, v34, v69
v_lshlrev_b32 v64, 16, v108
v_and_b32 v65, 0xffff0000, v108
v_lshlrev_b32 v66, 16, v109
v_and_b32 v67, 0xffff0000, v109
v_lshlrev_b32 v68, 16, v110
v_and_b32 v69, 0xffff0000, v110
v_fmac_f32 v72, v35, v64
v_fmac_f32 v73, v35, v65
v_fmac_f32 v74, v35, v66
v_fmac_f32 v75, v35, v67
v_fmac_f32 v76, v35, v68
v_fmac_f32 v77, v35, v69
v_lshlrev_b32 v64, 16, v112
v_and_b32 v65, 0xffff0000, v112
v_lshlrev_b32 v66, 16, v113
v_and_b32 v67, 0xffff0000, v113
v_lshlrev_b32 v68, 16, v114
v_and_b32 v69, 0xffff0000, v114
v_fmac_f32 v72, v36, v64
v_fmac_f32 v73, v36, v65
v_fmac_f32 v74, v36, v66
v_fmac_f32 v75, v36, v67
v_fmac_f32 v76, v36, v68
v_fmac_f32 v77, v36, v69
v_lshlrev_b32 v64, 16, v116
v_and_b32 v65, 0xffff0000, v116
v_lshlrev_b32 v66, 16, v117
v_and_b32 v67, 0xffff0000, v117
v_lshlrev_b32 v68, 16, v118
v_and_b32 v69, 0xffff0000, v118
v_fmac_f32 v72, v37, v64
v_fmac_f32 v73, v37, v65
v_fmac_f32 v74, v37, v66
v_fmac_f32 v75, v37, v67
v_fmac_f32 v76, v37, v68
v_fmac_f32 v77, v37, v69
v_lshlrev_b32 v64, 16, v120
v_and_b32 v65, 0xffff0000, v120
v_lshlrev_b32 v66, 16, v121
v_and_b32 v67, 0xffff0000, v121
v_lshlrev_b32 v68, 16, v122
v_and_b32 v69, 0xffff0000, v122
v_fmac_f32 v72, v38, v64
v_fmac_f32 v73, v38, v65
v_fmac_f32 v74, v38, v66
v_fmac_f32 v75, v38, v67
v_fmac_f32 v76, v38, v68
v_fmac_f32 v77, v38, v69
v_lshlrev_b32 v64, 16, v124
v_and_b32 v65, 0xffff0000, v124
v_lshlrev_b32 v66, 16, v125
v_and_b32 v67, 0xffff0000, v125
v_lshlrev_b32 v68, 16, v126
v_and_b32 v69, 0xffff0000, v126
v_fmac_f32 v72, v39, v64
v_fmac_f32 v73, v39, v65
v_fmac_f32 v74, v39, v66
v_fmac_f32 v75, v39, v67
v_fmac_f32 v76, v39, v68
v_fmac_f32 v77, v39, v69
s_waitcnt vmcnt(29)
v_lshlrev_b32 v64, 16, v128
v_and_b32 v65, 0xffff0000, v128
v_lshlrev_b32 v66, 16, v129
v_and_b32 v67, 0xffff0000, v129
v_lshlrev_b32 v68, 16, v130
v_and_b32 v69, 0xffff0000, v130
v_fmac_f32 v72, v40, v64
v_fmac_f32 v73, v40, v65
v_fmac_f32 v74, v40, v66
v_fmac_f32 v75, v40, v67
v_fmac_f32 v76, v40, v68
v_fmac_f32 v77, v40, v69
v_lshlrev_b32 v64, 16, v132
v_and_b32 v65, 0xffff0000, v132
v_lshlrev_b32 v66, 16, v133
v_and_b32 v67, 0xffff0000, v133
v_lshlrev_b32 v68, 16, v134
v_and_b32 v69, 0xffff0000, v134
v_fmac_f32 v72, v41, v64
v_fmac_f32 v73, v41, v65
v_fmac_f32 v74, v41, v66
v_fmac_f32 v75, v41, v67
v_fmac_f32 v76, v41, v68
v_fmac_f32 v77, v41, v69
v_lshlrev_b32 v64, 16, v136
v_and_b32 v65, 0xffff0000, v136
v_lshlrev_b32 v66, 16, v137
v_and_b32 v67, 0xffff0000, v137
v_lshlrev_b32 v68, 16, v138
v_and_b32 v69, 0xffff0000, v138
v_fmac_f32 v72, v42, v64
v_fmac_f32 v73, v42, v65
v_fmac_f32 v74, v42, v66
v_fmac_f32 v75, v42, v67
v_fmac_f32 v76, v42, v68
v_fmac_f32 v77, v42, v69
v_lshlrev_b32 v64, 16, v140
v_and_b32 v65, 0xffff0000, v140
v_lshlrev_b32 v66, 16, v141
v_and_b32 v67, 0xffff0000, v141
v_lshlrev_b32 v68, 16, v142
v_and_b32 v69, 0xffff0000, v142
v_fmac_f32 v72, v43, v64
v_fmac_f32 v73, v43, v65
v_fmac_f32 v74, v43, v66
v_fmac_f32 v75, v43, v67
v_fmac_f32 v76, v43, v68
v_fmac_f32 v77, v43, v69
v_lshlrev_b32 v64, 16, v144
v_and_b32 v65, 0xffff0000, v144
v_lshlrev_b32 v66, 16, v145
v_and_b32 v67, 0xffff0000, v145
v_lshlrev_b32 v68, 16, v146
v_and_b32 v69, 0xffff0000, v146
v_fmac_f32 v72, v44, v64
v_fmac_f32 v73, v44, v65
v_fmac_f32 v74, v44, v66
v_fmac_f32 v75, v44, v67
v_fmac_f32 v76, v44, v68
v_fmac_f32 v77, v44, v69
v_lshlrev_b32 v64, 16, v148
v_and_b32 v65, 0xffff0000, v148
v_lshlrev_b32 v66, 16, v149
v_and_b32 v67, 0xffff0000, v149
v_lshlrev_b32 v68, 16, v150
v_and_b32 v69, 0xffff0000, v150
v_fmac_f32 v72, v45, v64
v_fmac_f32 v73, v45, v65
v_fmac_f32 v74, v45, v66
v_fmac_f32 v75, v45, v67
v_fmac_f32 v76, v45, v68
v_fmac_f32 v77, v45, v69
v_lshlrev_b32 v64, 16, v152
v_and_b32 v65, 0xffff0000, v152
v_lshlrev_b32 v66, 16, v153
v_and_b32 v67, 0xffff0000, v153
v_lshlrev_b32 v68, 16, v154
v_and_b32 v69, 0xffff0000, v154
v_fmac_f32 v72, v46, v64
v_fmac_f32 v73, v46, v65
v_fmac_f32 v74, v46, v66
v_fmac_f32 v75, v46, v67
v_fmac_f32 v76, v46, v68
v_fmac_f32 v77, v46, v69
v_lshlrev_b32 v64, 16, v156
v_and_b32 v65, 0xffff0000, v156
v_lshlrev_b32 v66, 16, v157
v_and_b32 v67, 0xffff0000, v157
v_lshlrev_b32 v68, 16, v158
v_and_b32 v69, 0xffff0000, v158
v_fmac_f32 v72, v47, v64
v_fmac_f32 v73, v47, v65
v_fmac_f32 v74, v47, v66
v_fmac_f32 v75, v47, v67
v_fmac_f32 v76, v47, v68
v_fmac_f32 v77, v47, v69
s_waitcnt vmcnt(21)
v_lshlrev_b32 v64, 16, v160
v_and_b32 v65, 0xffff0000, v160
v_lshlrev_b32 v66, 16, v161
v_and_b32 v67, 0xffff0000, v161
v_lshlrev_b32 v68, 16, v162
v_and_b32 v69, 0xffff0000, v162
v_fmac_f32 v72, v48, v64
v_fmac_f32 v73, v48, v65
v_fmac_f32 v74, v48, v66
v_fmac_f32 v75, v48, v67
v_fmac_f32 v76, v48, v68
v_fmac_f32 v77, v48, v69
v_lshlrev_b32 v64, 16, v164
v_and_b32 v65, 0xffff0000, v164
v_lshlrev_b32 v66, 16, v165
v_and_b32 v67, 0xffff0000, v165
v_lshlrev_b32 v68, 16, v166
v_and_b32 v69, 0xffff0000, v166
v_fmac_f32 v72, v49, v64
v_fmac_f32 v73, v49, v65
v_fmac_f32 v74, v49, v66
v_fmac_f32 v75, v49, v67
v_fmac_f32 v76, v49, v68
v_fmac_f32 v77, v49, v69
v_lshlrev_b32 v64, 16, v168
v_and_b32 v65, 0xffff0000, v168
v_lshlrev_b32 v66, 16, v169
v_and_b32 v67, 0xffff0000, v169
v_lshlrev_b32 v68, 16, v170
v_and_b32 v69, 0xffff0000, v170
v_fmac_f32 v72, v50, v64
v_fmac_f32 v73, v50, v65
v_fmac_f32 v74, v50, v66
v_fmac_f32 v75, v50, v67
v_fmac_f32 v76, v50, v68
v_fmac_f32 v77, v50, v69
v_lshlrev_b32 v64, 16, v172
v_and_b32 v65, 0xffff0000, v172
v_lshlrev_b32 v66, 16, v173
v_and_b32 v67, 0xffff0000, v173
v_lshlrev_b32 v68, 16, v174
v_and_b32 v69, 0xffff0000, v174
v_fmac_f32 v72, v51, v64
v_fmac_f32 v73, v51, v65
v_fmac_f32 v74, v51, v66
v_fmac_f32 v75, v51, v67
v_fmac_f32 v76, v51, v68
v_fmac_f32 v77, v51, v69
v_lshlrev_b32 v64, 16, v176
v_and_b32 v65, 0xffff0000, v176
v_lshlrev_b32 v66, 16, v177
v_and_b32 v67, 0xffff0000, v177
v_lshlrev_b32 v68, 16, v178
v_and_b32 v69, 0xffff0000, v178
v_fmac_f32 v72, v52, v64
v_fmac_f32 v73, v52, v65
v_fmac_f32 v74, v52, v66
v_fmac_f32 v75, v52, v67
v_fmac_f32 v76, v52, v68
v_fmac_f32 v77, v52, v69
v_lshlrev_b32 v64, 16, v180
v_and_b32 v65, 0xffff0000, v180
v_lshlrev_b32 v66, 16, v181
v_and_b32 v67, 0xffff0000, v181
v_lshlrev_b32 v68, 16, v182
v_and_b32 v69, 0xffff0000, v182
v_fmac_f32 v72, v53, v64
v_fmac_f32 v73, v53, v65
v_fmac_f32 v74, v53, v66
v_fmac_f32 v75, v53, v67
v_fmac_f32 v76, v53, v68
v_fmac_f32 v77, v53, v69
v_lshlrev_b32 v64, 16, v184
v_and_b32 v65, 0xffff0000, v184
v_lshlrev_b32 v66, 16, v185
v_and_b32 v67, 0xffff0000, v185
v_lshlrev_b32 v68, 16, v186
v_and_b32 v69, 0xffff0000, v186
v_fmac_f32 v72, v54, v64
v_fmac_f32 v73, v54, v65
v_fmac_f32 v74, v54, v66
v_fmac_f32 v75, v54, v67
v_fmac_f32 v76, v54, v68
v_fmac_f32 v77, v54, v69
v_lshlrev_b32 v64, 16, v188
v_and_b32 v65, 0xffff0000, v188
v_lshlrev_b32 v66, 16, v189
v_and_b32 v67, 0xffff0000, v189
v_lshlrev_b32 v68, 16, v190
v_and_b32 v69, 0xffff0000, v190
v_fmac_f32 v72, v55, v64
v_fmac_f32 v73, v55, v65
v_fmac_f32 v74, v55, v66
v_fmac_f32 v75, v55, v67
v_fmac_f32 v76, v55, v68
v_fmac_f32 v77, v55, v69
s_waitcnt vmcnt(13)
v_lshlrev_b32 v64, 16, v192
v_and_b32 v65, 0xffff0000, v192
v_lshlrev_b32 v66, 16, v193
v_and_b32 v67, 0xffff0000, v193
v_lshlrev_b32 v68, 16, v194
v_and_b32 v69, 0xffff0000, v194
v_fmac_f32 v72, v56, v64
v_fmac_f32 v73, v56, v65
v_fmac_f32 v74, v56, v66
v_fmac_f32 v75, v56, v67
v_fmac_f32 v76, v56, v68
v_fmac_f32 v77, v56, v69
v_lshlrev_b32 v64, 16, v196
v_and_b32 v65, 0xffff0000, v196
v_lshlrev_b32 v66, 16, v197
v_and_b32 v67, 0xffff0000, v197
v_lshlrev_b32 v68, 16, v198
v_and_b32 v69, 0xffff0000, v198
v_fmac_f32 v72, v57, v64
v_fmac_f32 v73, v57, v65
v_fmac_f32 v74, v57, v66
v_fmac_f32 v75, v57, v67
v_fmac_f32 v76, v57, v68
v_fmac_f32 v77, v57, v69
v_lshlrev_b32 v64, 16, v200
v_and_b32 v65, 0xffff0000, v200
v_lshlrev_b32 v66, 16, v201
v_and_b32 v67, 0xffff0000, v201
v_lshlrev_b32 v68, 16, v202
v_and_b32 v69, 0xffff0000, v202
v_fmac_f32 v72, v58, v64
v_fmac_f32 v73, v58, v65
v_fmac_f32 v74, v58, v66
v_fmac_f32 v75, v58, v67
v_fmac_f32 v76, v58, v68
v_fmac_f32 v77, v58, v69
v_lshlrev_b32 v64, 16, v204
v_and_b32 v65, 0xffff0000, v204
v_lshlrev_b32 v66, 16, v205
v_and_b32 v67, 0xffff0000, v205
v_lshlrev_b32 v68, 16, v206
v_and_b32 v69, 0xffff0000, v206
v_fmac_f32 v72, v59, v64
v_fmac_f32 v73, v59, v65
v_fmac_f32 v74, v59, v66
v_fmac_f32 v75, v59, v67
v_fmac_f32 v76, v59, v68
v_fmac_f32 v77, v59, v69
v_lshlrev_b32 v64, 16, v208
v_and_b32 v65, 0xffff0000, v208
v_lshlrev_b32 v66, 16, v209
v_and_b32 v67, 0xffff0000, v209
v_lshlrev_b32 v68, 16, v210
v_and_b32 v69, 0xffff0000, v210
v_fmac_f32 v72, v60, v64
v_fmac_f32 v73, v60, v65
v_fmac_f32 v74, v60, v66
v_fmac_f32 v75, v60, v67
v_fmac_f32 v76, v60, v68
v_fmac_f32 v77, v60, v69
v_lshlrev_b32 v64, 16, v212
v_and_b32 v65, 0xffff0000, v212
v_lshlrev_b32 v66, 16, v213
v_and_b32 v67, 0xffff0000, v213
v_lshlrev_b32 v68, 16, v214
v_and_b32 v69, 0xffff0000, v214
v_fmac_f32 v72, v61, v64
v_fmac_f32 v73, v61, v65
v_fmac_f32 v74, v61, v66
v_fmac_f32 v75, v61, v67
v_fmac_f32 v76, v61, v68
v_fmac_f32 v77, v61, v69
v_lshlrev_b32 v64, 16, v216
v_and_b32 v65, 0xffff0000, v216
v_lshlrev_b32 v66, 16, v217
v_and_b32 v67, 0xffff0000, v217
v_lshlrev_b32 v68, 16, v218
v_and_b32 v69, 0xffff0000, v218
v_fmac_f32 v72, v62, v64
v_fmac_f32 v73, v62, v65
v_fmac_f32 v74, v62, v66
v_fmac_f32 v75, v62, v67
v_fmac_f32 v76, v62, v68
v_fmac_f32 v77, v62, v69
v_lshlrev_b32 v64, 16, v220
v_and_b32 v65, 0xffff0000, v220
v_lshlrev_b32 v66, 16, v221
v_and_b32 v67, 0xffff0000, v221
v_lshlrev_b32 v68, 16, v222
v_and_b32 v69, 0xffff0000, v222
v_fmac_f32 v72, v63, v64
v_fmac_f32 v73, v63, v65
v_fmac_f32 v74, v63, v66
v_fmac_f32 v75, v63, v67
v_fmac_f32 v76, v63, v68
v_fmac_f32 v77, v63, v69
s_nop 1
v_permlane32_swap_b32 v72, v75
v_permlane32_swap_b32 v73, v76
v_permlane32_swap_b32 v74, v77
v_add_f32 v72, v72, v75
v_add_f32 v73, v73, v76
v_add_f32 v74, v74, v77
v_mov_b32 v75, v72
v_mov_b32 v76, v73
v_mov_b32 v77, v74
s_nop 1
v_permlane16_swap_b32 v72, v75
v_permlane16_swap_b32 v73, v76
v_permlane16_swap_b32 v74, v77
v_add_f32 v72, v72, v75
v_add_f32 v73, v73, v76
v_add_f32 v74, v74, v77
v_mul_u32_u24 v13, 24, v13
v_lshrrev_b32 v11, 5, v1
v_mul_u32_u24 v11, 12, v11
v_add_u32 v13, v13, v11
s_mul_i32 s95, s3, 384
v_add_u32 v13, s95, v13
v_lshlrev_b32 v12, 2, v1
v_mov_b32 v11, 1073741824
v_cmp_gt_u32 vcc, 24, v1
s_mul_i32 s95, s3, 96
s_mul_i32 s96, s92, 24576
v_cndmask_b32 v11, v11, v12, vcc
v_add_u32 v12, s95, v12
s_add_u32 s96, s96, s95
s_mul_i32 s95, s91, 384
s_add_u32 s96, s96, s95
v_mov_b32 v15, 0
ds_write2_b32 v13, v72, v73 offset0:0 offset1:1
ds_write_b32 v13, v74 offset:8
s_waitcnt lgkmcnt(0)
s_barrier
ds_read2_b32 v[64:65], v12 offset0:0 offset1:96
ds_read_b32 v66, v12 offset:768
ds_read_b32 v67, v12 offset:1152
s_waitcnt lgkmcnt(0)
v_add_f32 v64, v64, v65
v_add_f32 v66, v66, v67
v_add_f32 v64, v64, v66
buffer_store_dword v64, v11, s[60:63], s96 offen sc1
s_lshl_b32 s97, s2, 2
s_add_u32 s97, s97, s3
s_lshl_b32 s97, s97, 7
v_and_b32 v10, 7, v1
v_lshlrev_b32 v10, 2, v10
buffer_store_dword v15, v10, s[52:55], s97 offen sc1
s_waitcnt vmcnt(7)
v_lshlrev_b32 v96, 16, v224
v_and_b32 v97, 0xffff0000, v224
v_lshlrev_b32 v98, 16, v225
v_and_b32 v99, 0xffff0000, v225
v_lshlrev_b32 v100, 16, v226
v_and_b32 v101, 0xffff0000, v226
v_lshlrev_b32 v102, 16, v227
v_and_b32 v103, 0xffff0000, v227
v_lshlrev_b32 v104, 16, v228
v_and_b32 v105, 0xffff0000, v228
v_lshlrev_b32 v106, 16, v229
v_and_b32 v107, 0xffff0000, v229
v_lshlrev_b32 v108, 16, v230
v_and_b32 v109, 0xffff0000, v230
v_lshlrev_b32 v110, 16, v231
v_and_b32 v111, 0xffff0000, v231
v_lshlrev_b32 v112, 16, v232
v_and_b32 v113, 0xffff0000, v232
v_lshlrev_b32 v114, 16, v233
v_and_b32 v115, 0xffff0000, v233
v_lshlrev_b32 v116, 16, v234
v_and_b32 v117, 0xffff0000, v234
v_lshlrev_b32 v118, 16, v235
v_and_b32 v119, 0xffff0000, v235
v_lshlrev_b32 v120, 16, v236
v_and_b32 v121, 0xffff0000, v236
v_lshlrev_b32 v122, 16, v237
v_and_b32 v123, 0xffff0000, v237
v_lshlrev_b32 v124, 16, v238
v_and_b32 v125, 0xffff0000, v238
v_lshlrev_b32 v126, 16, v239
v_and_b32 v127, 0xffff0000, v239
v_lshlrev_b32 v128, 16, v240
v_and_b32 v129, 0xffff0000, v240
v_lshlrev_b32 v130, 16, v241
v_and_b32 v131, 0xffff0000, v241
v_lshlrev_b32 v132, 16, v242
v_and_b32 v133, 0xffff0000, v242
v_lshlrev_b32 v134, 16, v243
v_and_b32 v135, 0xffff0000, v243
v_lshlrev_b32 v136, 16, v244
v_and_b32 v137, 0xffff0000, v244
v_lshlrev_b32 v138, 16, v245
v_and_b32 v139, 0xffff0000, v245
v_lshlrev_b32 v140, 16, v246
v_and_b32 v141, 0xffff0000, v246
v_lshlrev_b32 v142, 16, v247
v_and_b32 v143, 0xffff0000, v247
v_lshlrev_b32 v144, 16, v248
v_and_b32 v145, 0xffff0000, v248
v_lshlrev_b32 v146, 16, v249
v_and_b32 v147, 0xffff0000, v249
v_lshlrev_b32 v148, 16, v250
v_and_b32 v149, 0xffff0000, v250
v_lshlrev_b32 v150, 16, v251
v_and_b32 v151, 0xffff0000, v251
v_lshlrev_b32 v152, 16, v252
v_and_b32 v153, 0xffff0000, v252
v_lshlrev_b32 v154, 16, v253
v_and_b32 v155, 0xffff0000, v253
v_lshlrev_b32 v156, 16, v254
v_and_b32 v157, 0xffff0000, v254
v_lshlrev_b32 v158, 16, v255
v_and_b32 v159, 0xffff0000, v255
v_pk_mul_f32 v[168:169], v[96:97], v[96:97]
v_pk_add_f32 v[176:177], v[96:97], v[98:99]
v_pk_fma_f32 v[168:169], v[98:99], v[98:99], v[168:169]
v_pk_fma_f32 v[168:169], v[100:101], v[100:101], v[168:169]
v_pk_fma_f32 v[168:169], v[102:103], v[102:103], v[168:169]
v_pk_fma_f32 v[168:169], v[104:105], v[104:105], v[168:169]
v_pk_fma_f32 v[168:169], v[106:107], v[106:107], v[168:169]
v_pk_fma_f32 v[168:169], v[108:109], v[108:109], v[168:169]
v_pk_fma_f32 v[168:169], v[110:111], v[110:111], v[168:169]
v_pk_add_f32 v[176:177], v[176:177], v[100:101]
v_pk_add_f32 v[176:177], v[176:177], v[102:103]
v_pk_add_f32 v[176:177], v[176:177], v[104:105]
v_pk_add_f32 v[176:177], v[176:177], v[106:107]
v_pk_add_f32 v[176:177], v[176:177], v[108:109]
v_pk_add_f32 v[176:177], v[176:177], v[110:111]
v_pk_mul_f32 v[170:171], v[112:113], v[112:113]
v_pk_add_f32 v[178:179], v[112:113], v[114:115]
v_pk_fma_f32 v[170:171], v[114:115], v[114:115], v[170:171]
v_pk_fma_f32 v[170:171], v[116:117], v[116:117], v[170:171]
v_pk_fma_f32 v[170:171], v[118:119], v[118:119], v[170:171]
v_pk_fma_f32 v[170:171], v[120:121], v[120:121], v[170:171]
v_pk_fma_f32 v[170:171], v[122:123], v[122:123], v[170:171]
v_pk_fma_f32 v[170:171], v[124:125], v[124:125], v[170:171]
v_pk_fma_f32 v[170:171], v[126:127], v[126:127], v[170:171]
v_pk_add_f32 v[178:179], v[178:179], v[116:117]
v_pk_add_f32 v[178:179], v[178:179], v[118:119]
v_pk_add_f32 v[178:179], v[178:179], v[120:121]
v_pk_add_f32 v[178:179], v[178:179], v[122:123]
v_pk_add_f32 v[178:179], v[178:179], v[124:125]
v_pk_add_f32 v[178:179], v[178:179], v[126:127]
v_pk_mul_f32 v[172:173], v[128:129], v[128:129]
v_pk_add_f32 v[180:181], v[128:129], v[130:131]
v_pk_fma_f32 v[172:173], v[130:131], v[130:131], v[172:173]
v_pk_fma_f32 v[172:173], v[132:133], v[132:133], v[172:173]
v_pk_fma_f32 v[172:173], v[134:135], v[134:135], v[172:173]
v_pk_fma_f32 v[172:173], v[136:137], v[136:137], v[172:173]
v_pk_fma_f32 v[172:173], v[138:139], v[138:139], v[172:173]
v_pk_fma_f32 v[172:173], v[140:141], v[140:141], v[172:173]
v_pk_fma_f32 v[172:173], v[142:143], v[142:143], v[172:173]
v_pk_add_f32 v[180:181], v[180:181], v[132:133]
v_pk_add_f32 v[180:181], v[180:181], v[134:135]
v_pk_add_f32 v[180:181], v[180:181], v[136:137]
v_pk_add_f32 v[180:181], v[180:181], v[138:139]
v_pk_add_f32 v[180:181], v[180:181], v[140:141]
v_pk_add_f32 v[180:181], v[180:181], v[142:143]
v_pk_mul_f32 v[174:175], v[144:145], v[144:145]
v_pk_add_f32 v[182:183], v[144:145], v[146:147]
v_pk_fma_f32 v[174:175], v[146:147], v[146:147], v[174:175]
v_pk_fma_f32 v[174:175], v[148:149], v[148:149], v[174:175]
v_pk_fma_f32 v[174:175], v[150:151], v[150:151], v[174:175]
v_pk_fma_f32 v[174:175], v[152:153], v[152:153], v[174:175]
v_pk_fma_f32 v[174:175], v[154:155], v[154:155], v[174:175]
v_pk_fma_f32 v[174:175], v[156:157], v[156:157], v[174:175]
v_pk_fma_f32 v[174:175], v[158:159], v[158:159], v[174:175]
v_pk_add_f32 v[182:183], v[182:183], v[148:149]
v_pk_add_f32 v[182:183], v[182:183], v[150:151]
v_pk_add_f32 v[182:183], v[182:183], v[152:153]
v_pk_add_f32 v[182:183], v[182:183], v[154:155]
v_pk_add_f32 v[182:183], v[182:183], v[156:157]
v_pk_add_f32 v[182:183], v[182:183], v[158:159]
v_add_f32 v160, v176, v177
v_add_f32 v164, v168, v169
v_add_f32 v161, v178, v179
v_add_f32 v165, v170, v171
v_add_f32 v162, v180, v181
v_add_f32 v166, v172, v173
v_add_f32 v163, v182, v183
v_add_f32 v167, v174, v175
s_nop 1
v_permlane32_swap_b32 v160, v164
v_permlane32_swap_b32 v161, v165
v_permlane32_swap_b32 v162, v166
v_permlane32_swap_b32 v163, v167
v_add_f32 v160, v160, v164
v_add_f32 v161, v161, v165
v_add_f32 v162, v162, v166
v_add_f32 v163, v163, v167
s_nop 1
v_permlane16_swap_b32 v160, v162
v_permlane16_swap_b32 v161, v163
v_add_f32 v160, v160, v162
v_add_f32 v161, v161, v163
s_nop 1
v_add_f32_dpp v160, v160, v160 row_ror:8 row_mask:0xf bank_mask:0xf
v_add_f32_dpp v161, v161, v161 row_ror:8 row_mask:0xf bank_mask:0xf
s_nop 1
v_add_f32_dpp v160, v160, v160 row_ror:4 row_mask:0xf bank_mask:0xf
v_add_f32_dpp v161, v161, v161 row_ror:4 row_mask:0xf bank_mask:0xf
s_nop 1
v_add_f32_dpp v160, v160, v160 row_ror:2 row_mask:0xf bank_mask:0xf
v_add_f32_dpp v161, v161, v161 row_ror:2 row_mask:0xf bank_mask:0xf
s_nop 1
v_add_f32_dpp v160, v160, v160 row_ror:1 row_mask:0xf bank_mask:0xf
v_add_f32_dpp v161, v161, v161 row_ror:1 row_mask:0xf bank_mask:0xf
v_mul_f32 v160, 0x3a800000, v160
v_mul_f32 v161, 0x3a800000, v161
v_mov_b32 v162, v160
v_mov_b32 v163, v161
s_nop 1
v_permlane32_swap_b32 v160, v162
v_permlane32_swap_b32 v161, v163
v_fma_f32 v162, -v160, v160, v162
v_fma_f32 v163, -v161, v161, v163
v_max_f32 v162, 0, v162
v_max_f32 v163, 0, v163
v_add_f32 v162, 0x3727c5ac, v162
v_add_f32 v163, 0x3727c5ac, v163
v_rsq_f32 v164, v162
v_rsq_f32 v166, v163
v_and_b32 v10, 47, v1
v_mov_b32 v11, 1073741824
v_mul_f32 v165, -v160, v164
v_mul_f32 v167, -v161, v166
v_cmp_eq_u32 vcc, 0, v10
s_add_u32 s90, s90, 196608
s_mov_b32 s62, 0x40000
v_cndmask_b32 v11, v11, v1, vcc
buffer_store_dwordx4 v[164:167], v11, s[60:63], s90 offen sc1
conv_kernel_end:
s_endpgm
.text
.globl mlp_kernel
.p2align 8
.type mlp_kernel,@function
mlp_kernel:
s_cmp_ge_u32 s2, 256
s_cbranch_scc1 mlp_kernel_end
s_load_dwordx2 s[4:5], s[0:1], 0
s_load_dwordx2 s[12:13], s[0:1], 104
s_load_dwordx4 s[8:11], s[0:1], 56
s_load_dwordx2 s[16:17], s[0:1], 88
s_and_b32 s20, s2, 7
s_lshr_b32 s21, s2, 3
s_lshr_b32 s22, s20, 2
s_lshl_b32 s22, s22, 3
s_lshr_b32 s23, s21, 2
s_add_u32 s22, s22, s23
s_and_b32 s23, s20, 3
s_lshl_b32 s23, s23, 2
s_and_b32 s24, s21, 3
s_add_u32 s23, s23, s24
s_lshl_b32 s28, s22, 4
s_add_u32 s28, s28, s23
s_lshl_b32 s29, s28, 14
v_lshlrev_b32 v10, 3, v0
v_lshlrev_b32 v11, 6, v0
v_lshlrev_b32 v12, 4, v0
s_mov_b32 s6, 4194304
s_mov_b32 s7, 0x00020000
s_mov_b32 s14, 41943040
s_mov_b32 s15, 0x00020000
s_waitcnt lgkmcnt(0)
s_and_b32 s5, s5, 0xffff
s_and_b32 s13, s13, 0xffff
s_lshl_b32 s36, s28, 6
s_add_u32 s36, s36, 196608
s_buffer_load_dwordx16 s[84:99], s[12:15], s36
s_add_u32 s36, s29, 0
buffer_load_dwordx2 v[32:33], v10, s[4:7], s36 offen offset:0
buffer_load_dwordx2 v[34:35], v10, s[4:7], s36 offen offset:2048
s_add_u32 s36, s29, 4096
buffer_load_dwordx2 v[36:37], v10, s[4:7], s36 offen offset:0
buffer_load_dwordx2 v[38:39], v10, s[4:7], s36 offen offset:2048
s_add_u32 s36, s29, 8192
buffer_load_dwordx2 v[40:41], v10, s[4:7], s36 offen offset:0
buffer_load_dwordx2 v[42:43], v10, s[4:7], s36 offen offset:2048
s_add_u32 s36, s29, 12288
buffer_load_dwordx2 v[44:45], v10, s[4:7], s36 offen offset:0
buffer_load_dwordx2 v[46:47], v10, s[4:7], s36 offen offset:2048
s_add_u32 s101, s29, 1048576
buffer_load_dwordx4 v[48:51], v11, s[12:15], s101 offen offset:0
buffer_load_dwordx4 v[52:55], v11, s[12:15], s101 offen offset:16
buffer_load_dwordx4 v[56:59], v11, s[12:15], s101 offen offset:32
buffer_load_dwordx4 v[60:63], v11, s[12:15], s101 offen offset:48
s_mov_b32 s101, 0
buffer_load_dwordx4 v[64:67], v12, s[12:15], s101 offen
s_mov_b32 s101, 4096
buffer_load_dwordx4 v[68:71], v12, s[12:15], s101 offen
s_mov_b32 s101, 8192
buffer_load_dwordx4 v[72:75], v12, s[12:15], s101 offen
s_mov_b32 s101, 24576
buffer_load_dwordx4 v[232:235], v12, s[12:15], s101 offen
s_mov_b32 s101, 28672
buffer_load_dwordx4 v[236:239], v12, s[12:15], s101 offen
s_mov_b32 s101, 32768
buffer_load_dwordx4 v[240:243], v12, s[12:15], s101 offen
v_lshrrev_b32 v9, 6, v0
v_and_b32 v1, 63, v0
v_readfirstlane_b32 s3, v9
v_lshrrev_b32 v9, 3, v1
s_mov_b32 s30, 7168
v_mul_lo_u32 v6, s30, v9
v_lshrrev_b32 v9, 4, v1
v_lshlrev_b32 v9, 1, v9
v_and_b32 v19, 7, v1
v_xor_b32 v9, v9, v19
v_lshl_add_u32 v6, v9, 4, v6
v_add_u32 v7, 56320, v6
v_add_u32 v8, 112640, v6
v_add_u32 v18, 168960, v6
s_mul_i32 s24, s23, 448
s_and_b32 s25, s23, 1
s_lshl_b32 s25, s25, 6
s_add_u32 s26, s24, s25
s_add_u32 s27, s26, 256
s_sub_u32 s56, s24, 64
s_add_u32 s57, s24, 384
s_cmp_eq_u32 s25, 0
s_cselect_b32 s56, s57, s56
s_mov_b32 s31, s22
s_and_b32 s59, s31, 3
s_lshl_b32 s31, s59, 1
s_lshl_b32 s30, s22, 3
s_lshl_b32 s33, s3, 1
s_add_u32 s30, s30, s33
s_mul_i32 s33, s30, 114688
s_add_u32 s33, s33, 13631488
s_lshl_b32 s58, s30, 15
s_add_u32 s30, s58, 9437184
s_lshl_b32 s32, s3, 12
s_lshr_b32 s34, s3, 1
s_mul_i32 s34, s34, 229376
s_and_b32 s35, s3, 1
s_lshl_b32 s35, s35, 7
s_add_u32 s34, s34, s35
s_add_u32 s34, s34, s26
s_mov_b32 s60, s10
s_and_b32 s61, s11, 0xffff
s_mov_b32 s62, 7340032
s_mov_b32 s63, 0x00020000
s_and_b32 s9, s9, 0xffff
s_mov_b32 s10, 7340032
s_mov_b32 s11, 0x00020000
s_and_b32 s17, s17, 0xffff
s_mov_b32 s18, 4194304
s_mov_b32 s19, 0x00020000
s_add_u32 s35, s31, 0
s_and_b32 s35, s35, 7
s_lshl_b32 s36, s35, 12
s_add_u32 s40, s30, s36
s_mul_i32 s36, s35, 917504
s_add_u32 s48, s34, s36
s_add_u32 s35, s31, 1
s_and_b32 s35, s35, 7
s_lshl_b32 s36, s35, 12
s_add_u32 s41, s30, s36
s_mul_i32 s36, s35, 917504
s_add_u32 s49, s34, s36
s_add_u32 s35, s31, 2
s_and_b32 s35, s35, 7
s_lshl_b32 s36, s35, 12
s_add_u32 s42, s30, s36
s_mul_i32 s36, s35, 917504
s_add_u32 s50, s34, s36
s_add_u32 s35, s31, 3
s_and_b32 s35, s35, 7
s_lshl_b32 s36, s35, 12
s_add_u32 s43, s30, s36
s_mul_i32 s36, s35, 917504
s_add_u32 s51, s34, s36
s_add_u32 s35, s31, 4
s_and_b32 s35, s35, 7
s_lshl_b32 s36, s35, 12
s_add_u32 s44, s30, s36
s_mul_i32 s36, s35, 917504
s_add_u32 s52, s34, s36
s_add_u32 s35, s31, 5
s_and_b32 s35, s35, 7
s_lshl_b32 s36, s35, 12
s_add_u32 s45, s30, s36
s_mul_i32 s36, s35, 917504
s_add_u32 s53, s34, s36
s_add_u32 s35, s31, 6
s_and_b32 s35, s35, 7
s_lshl_b32 s36, s35, 12
s_add_u32 s46, s30, s36
s_mul_i32 s36, s35, 917504
s_add_u32 s54, s34, s36
s_add_u32 s35, s31, 7
s_and_b32 s35, s35, 7
s_lshl_b32 s36, s35, 12
s_add_u32 s47, s30, s36
s_mul_i32 s36, s35, 917504
s_add_u32 s55, s34, s36
s_mul_i32 s35, s3, 229376
s_add_u32 s35, s35, s27
s_sub_u32 s35, s35, s34
s_sub_u32 s36, s56, s27
v_lshrrev_b32 v13, 4, v1
v_lshlrev_b32 v13, 4, v13
s_lshl_b32 s37, s3, 6
s_add_u32 s37, s37, 151552
v_add_u32 v13, s37, v13
v_and_b32 v14, 15, v1
v_lshlrev_b32 v14, 2, v14
v_add_u32 v14, 151552, v14
s_mul_i32 s37, s3, 4608
s_add_u32 s37, s37, 131072
v_lshrrev_b32 v15, 3, v1
v_lshlrev_b32 v16, 2, v15
v_and_b32 v17, 3, v1
v_add_u32 v16, v16, v17
v_mul_u32_u24 v16, 144, v16
v_bfe_u32 v17, v1, 2, 1
v_lshl_add_u32 v16, v17, 3, v16
v_add_u32 v16, s37, v16
v_mul_u32_u24 v17, 144, v15
v_and_b32 v22, 7, v1
v_lshl_add_u32 v17, v22, 4, v17
v_add_u32 v17, s37, v17
v_lshlrev_b32 v22, 4, v22
v_and_b32 v23, 3, v15
v_lshl_add_u32 v22, v23, 8, v22
v_lshrrev_b32 v23, 5, v1
v_lshl_add_u32 v22, v23, 10, v22
v_add_u32 v253, 0x1000, v22
v_mov_b32 v252, v22
s_lshr_b32 s38, s28, 1
s_lshl_b32 s38, s38, 15
s_and_b32 s39, s28, 1
s_lshl_b32 s39, s39, 7
s_add_u32 s38, s38, s39
s_lshl_b32 s39, s3, 13
s_add_u32 s38, s38, s39
s_add_u32 s39, s38, 9437184
s_add_u32 s100, s38, 5242880
s_waitcnt vmcnt(10)
v_lshlrev_b32 v88, 16, v32
v_and_b32 v89, 0xffff0000, v32
v_lshlrev_b32 v90, 16, v33
v_and_b32 v91, 0xffff0000, v33
v_lshlrev_b32 v92, 16, v34
v_and_b32 v93, 0xffff0000, v34
v_lshlrev_b32 v94, 16, v35
v_and_b32 v95, 0xffff0000, v35
v_lshlrev_b32 v96, 16, v36
v_and_b32 v97, 0xffff0000, v36
v_lshlrev_b32 v98, 16, v37
v_and_b32 v99, 0xffff0000, v37
v_lshlrev_b32 v100, 16, v38
v_and_b32 v101, 0xffff0000, v38
v_lshlrev_b32 v102, 16, v39
v_and_b32 v103, 0xffff0000, v39
v_lshlrev_b32 v104, 16, v40
v_and_b32 v105, 0xffff0000, v40
v_lshlrev_b32 v106, 16, v41
v_and_b32 v107, 0xffff0000, v41
v_lshlrev_b32 v108, 16, v42
v_and_b32 v109, 0xffff0000, v42
v_lshlrev_b32 v110, 16, v43
v_and_b32 v111, 0xffff0000, v43
v_lshlrev_b32 v112, 16, v44
v_and_b32 v113, 0xffff0000, v44
v_lshlrev_b32 v114, 16, v45
v_and_b32 v115, 0xffff0000, v45
v_lshlrev_b32 v116, 16, v46
v_and_b32 v117, 0xffff0000, v46
v_lshlrev_b32 v118, 16, v47
v_and_b32 v119, 0xffff0000, v47
s_waitcnt lgkmcnt(0)
v_mov_b32 v184, s84
v_mov_b32 v185, s85
v_mov_b32 v186, s86
v_mov_b32 v187, s87
v_mov_b32 v188, s88
v_mov_b32 v189, s89
v_mov_b32 v190, s90
v_mov_b32 v191, s91
v_mov_b32 v192, s92
v_mov_b32 v193, s93
v_mov_b32 v194, s94
v_mov_b32 v195, s95
v_mov_b32 v196, s96
v_mov_b32 v197, s97
v_mov_b32 v198, s98
v_mov_b32 v199, s99
s_mov_b32 s89, s59
v_pk_fma_f32 v[200:201], v[88:89], v[184:185], v[184:185] op_sel:[0,0,1] op_sel_hi:[1,0,1]
v_pk_fma_f32 v[202:203], v[90:91], v[184:185], v[184:185] op_sel:[0,0,1] op_sel_hi:[1,0,1]
v_pk_fma_f32 v[204:205], v[92:93], v[186:187], v[186:187] op_sel:[0,0,1] op_sel_hi:[1,0,1]
v_pk_fma_f32 v[206:207], v[94:95], v[186:187], v[186:187] op_sel:[0,0,1] op_sel_hi:[1,0,1]
v_pk_fma_f32 v[208:209], v[96:97], v[188:189], v[188:189] op_sel:[0,0,1] op_sel_hi:[1,0,1]
v_pk_fma_f32 v[210:211], v[98:99], v[188:189], v[188:189] op_sel:[0,0,1] op_sel_hi:[1,0,1]
v_pk_fma_f32 v[212:213], v[100:101], v[190:191], v[190:191] op_sel:[0,0,1] op_sel_hi:[1,0,1]
v_pk_fma_f32 v[214:215], v[102:103], v[190:191], v[190:191] op_sel:[0,0,1] op_sel_hi:[1,0,1]
v_pk_fma_f32 v[216:217], v[104:105], v[192:193], v[192:193] op_sel:[0,0,1] op_sel_hi:[1,0,1]
v_pk_fma_f32 v[218:219], v[106:107], v[192:193], v[192:193] op_sel:[0,0,1] op_sel_hi:[1,0,1]
v_pk_fma_f32 v[220:221], v[108:109], v[194:195], v[194:195] op_sel:[0,0,1] op_sel_hi:[1,0,1]
v_pk_fma_f32 v[222:223], v[110:111], v[194:195], v[194:195] op_sel:[0,0,1] op_sel_hi:[1,0,1]
v_pk_fma_f32 v[224:225], v[112:113], v[196:197], v[196:197] op_sel:[0,0,1] op_sel_hi:[1,0,1]
v_pk_fma_f32 v[226:227], v[114:115], v[196:197], v[196:197] op_sel:[0,0,1] op_sel_hi:[1,0,1]
v_pk_fma_f32 v[228:229], v[116:117], v[198:199], v[198:199] op_sel:[0,0,1] op_sel_hi:[1,0,1]
v_pk_fma_f32 v[230:231], v[118:119], v[198:199], v[198:199] op_sel:[0,0,1] op_sel_hi:[1,0,1]
s_mov_b32 s101, 12288
buffer_load_dwordx4 v[76:79], v12, s[12:15], s101 offen
s_mov_b32 s101, 16384
buffer_load_dwordx4 v[80:83], v12, s[12:15], s101 offen
s_mov_b32 s101, 36864
buffer_load_dwordx4 v[244:247], v12, s[12:15], s101 offen
s_mov_b32 s101, 40960
buffer_load_dwordx4 v[248:251], v12, s[12:15], s101 offen
s_add_u32 m0, s32, 0
s_nop 0
buffer_load_dwordx4 v6, s[8:11], s48 offen offset:0  lds
buffer_load_dwordx4 v7, s[8:11], s48 offen offset:1024  lds
buffer_load_dwordx4 v8, s[8:11], s48 offen offset:2048  lds
buffer_load_dwordx4 v18, s[8:11], s48 offen offset:3072  lds
s_add_u32 m0, s32, 16384
s_add_u32 s34, s48, 458752
buffer_load_dwordx4 v6, s[8:11], s34 offen offset:0  lds
buffer_load_dwordx4 v7, s[8:11], s34 offen offset:1024  lds
buffer_load_dwordx4 v8, s[8:11], s34 offen offset:2048  lds
buffer_load_dwordx4 v18, s[8:11], s34 offen offset:3072  lds
s_waitcnt vmcnt(12)
v_pk_add_f32 v[64:65], v[64:65], v[232:233]
v_pk_add_f32 v[66:67], v[66:67], v[234:235]
v_cvt_pk_bf16_f32 v172, v64, v65
v_cvt_pk_bf16_f32 v173, v66, v67
v_lshlrev_b32 v64, 16, v172
v_and_b32 v65, 0xffff0000, v172
v_lshlrev_b32 v66, 16, v173
v_and_b32 v67, 0xffff0000, v173
v_pk_add_f32 v[68:69], v[68:69], v[236:237]
v_pk_add_f32 v[70:71], v[70:71], v[238:239]
v_cvt_pk_bf16_f32 v172, v68, v69
v_cvt_pk_bf16_f32 v173, v70, v71
v_lshlrev_b32 v68, 16, v172
v_and_b32 v69, 0xffff0000, v172
v_lshlrev_b32 v70, 16, v173
v_and_b32 v71, 0xffff0000, v173
v_add_f32 v68, 1.0, v68
v_add_f32 v69, 1.0, v69
v_add_f32 v70, 1.0, v70
v_add_f32 v71, 1.0, v71
v_cvt_pk_bf16_f32 v172, v68, v69
v_cvt_pk_bf16_f32 v173, v70, v71
v_lshlrev_b32 v68, 16, v172
v_and_b32 v69, 0xffff0000, v172
v_lshlrev_b32 v70, 16, v173
v_and_b32 v71, 0xffff0000, v173
v_pk_add_f32 v[72:73], v[72:73], v[240:241]
v_pk_add_f32 v[74:75], v[74:75], v[242:243]
v_cvt_pk_bf16_f32 v172, v72, v73
v_cvt_pk_bf16_f32 v173, v74, v75
v_lshlrev_b32 v72, 16, v172
v_and_b32 v73, 0xffff0000, v172
v_lshlrev_b32 v74, 16, v173
v_and_b32 v75, 0xffff0000, v173
s_waitcnt vmcnt(8)
v_pk_add_f32 v[76:77], v[76:77], v[244:245]
v_pk_add_f32 v[78:79], v[78:79], v[246:247]
v_cvt_pk_bf16_f32 v172, v76, v77
v_cvt_pk_bf16_f32 v173, v78, v79
v_lshlrev_b32 v76, 16, v172
v_and_b32 v77, 0xffff0000, v172
v_lshlrev_b32 v78, 16, v173
v_and_b32 v79, 0xffff0000, v173
v_pk_add_f32 v[80:81], v[80:81], v[248:249]
v_pk_add_f32 v[82:83], v[82:83], v[250:251]
v_cvt_pk_bf16_f32 v172, v80, v81
v_cvt_pk_bf16_f32 v173, v82, v83
v_lshlrev_b32 v80, 16, v172
v_and_b32 v81, 0xffff0000, v172
v_lshlrev_b32 v82, 16, v173
v_and_b32 v83, 0xffff0000, v173
v_add_f32 v80, 1.0, v80
v_add_f32 v81, 1.0, v81
v_add_f32 v82, 1.0, v82
v_add_f32 v83, 1.0, v83
v_cvt_pk_bf16_f32 v172, v80, v81
v_cvt_pk_bf16_f32 v173, v82, v83
v_lshlrev_b32 v80, 16, v172
v_and_b32 v81, 0xffff0000, v172
v_lshlrev_b32 v82, 16, v173
v_and_b32 v83, 0xffff0000, v173
v_mul_f32 v76, 0xbfb8aa3b, v76
v_mul_f32 v77, 0xbfb8aa3b, v77
v_mul_f32 v78, 0xbfb8aa3b, v78
v_mul_f32 v79, 0xbfb8aa3b, v79
v_mul_f32 v80, 0xbfb8aa3b, v80
v_mul_f32 v81, 0xbfb8aa3b, v81
v_mul_f32 v82, 0xbfb8aa3b, v82
v_mul_f32 v83, 0xbfb8aa3b, v83
v_lshlrev_b32 v120, 16, v48
v_and_b32 v124, 0xffff0000, v48
v_lshlrev_b32 v128, 16, v49
v_and_b32 v132, 0xffff0000, v49
v_lshlrev_b32 v136, 16, v50
v_and_b32 v140, 0xffff0000, v50
v_lshlrev_b32 v144, 16, v51
v_and_b32 v148, 0xffff0000, v51
v_lshlrev_b32 v121, 16, v52
v_and_b32 v125, 0xffff0000, v52
v_lshlrev_b32 v129, 16, v53
v_and_b32 v133, 0xffff0000, v53
v_lshlrev_b32 v137, 16, v54
v_and_b32 v141, 0xffff0000, v54
v_lshlrev_b32 v145, 16, v55
v_and_b32 v149, 0xffff0000, v55
v_lshlrev_b32 v122, 16, v56
v_and_b32 v126, 0xffff0000, v56
v_lshlrev_b32 v130, 16, v57
v_and_b32 v134, 0xffff0000, v57
v_lshlrev_b32 v138, 16, v58
v_and_b32 v142, 0xffff0000, v58
v_lshlrev_b32 v146, 16, v59
v_and_b32 v150, 0xffff0000, v59
v_lshlrev_b32 v123, 16, v60
v_and_b32 v127, 0xffff0000, v60
v_lshlrev_b32 v131, 16, v61
v_and_b32 v135, 0xffff0000, v61
v_lshlrev_b32 v139, 16, v62
v_and_b32 v143, 0xffff0000, v62
v_lshlrev_b32 v147, 16, v63
v_and_b32 v151, 0xffff0000, v63
v_pk_fma_f32 v[200:201], v[200:201], v[68:69], v[64:65]
v_pk_fma_f32 v[202:203], v[202:203], v[70:71], v[66:67]
v_pk_fma_f32 v[204:205], v[204:205], v[68:69], v[64:65]
v_pk_fma_f32 v[206:207], v[206:207], v[70:71], v[66:67]
v_pk_fma_f32 v[208:209], v[208:209], v[68:69], v[64:65]
v_pk_fma_f32 v[210:211], v[210:211], v[70:71], v[66:67]
v_pk_fma_f32 v[212:213], v[212:213], v[68:69], v[64:65]
v_pk_fma_f32 v[214:215], v[214:215], v[70:71], v[66:67]
v_pk_fma_f32 v[216:217], v[216:217], v[68:69], v[64:65]
v_pk_fma_f32 v[218:219], v[218:219], v[70:71], v[66:67]
v_pk_fma_f32 v[220:221], v[220:221], v[68:69], v[64:65]
v_pk_fma_f32 v[222:223], v[222:223], v[70:71], v[66:67]
v_pk_fma_f32 v[224:225], v[224:225], v[68:69], v[64:65]
v_pk_fma_f32 v[226:227], v[226:227], v[70:71], v[66:67]
v_pk_fma_f32 v[228:229], v[228:229], v[68:69], v[64:65]
v_pk_fma_f32 v[230:231], v[230:231], v[70:71], v[66:67]
v_pk_mul_f32 v[200:201], v[200:201], v[120:121]
v_pk_mul_f32 v[202:203], v[202:203], v[122:123]
v_pk_mul_f32 v[204:205], v[204:205], v[124:125]
v_pk_mul_f32 v[206:207], v[206:207], v[126:127]
v_pk_mul_f32 v[208:209], v[208:209], v[128:129]
v_pk_mul_f32 v[210:211], v[210:211], v[130:131]
v_pk_mul_f32 v[212:213], v[212:213], v[132:133]
v_pk_mul_f32 v[214:215], v[214:215], v[134:135]
v_pk_mul_f32 v[216:217], v[216:217], v[136:137]
v_pk_mul_f32 v[218:219], v[218:219], v[138:139]
v_pk_mul_f32 v[220:221], v[220:221], v[140:141]
v_pk_mul_f32 v[222:223], v[222:223], v[142:143]
v_pk_mul_f32 v[224:225], v[224:225], v[144:145]
v_pk_mul_f32 v[226:227], v[226:227], v[146:147]
v_pk_mul_f32 v[228:229], v[228:229], v[148:149]
v_pk_mul_f32 v[230:231], v[230:231], v[150:151]
v_pk_fma_f32 v[88:89], v[200:201], v[72:73], v[88:89]
v_pk_fma_f32 v[90:91], v[202:203], v[74:75], v[90:91]
v_pk_fma_f32 v[92:93], v[204:205], v[72:73], v[92:93]
v_pk_fma_f32 v[94:95], v[206:207], v[74:75], v[94:95]
v_pk_fma_f32 v[96:97], v[208:209], v[72:73], v[96:97]
v_pk_fma_f32 v[98:99], v[210:211], v[74:75], v[98:99]
v_pk_fma_f32 v[100:101], v[212:213], v[72:73], v[100:101]
v_pk_fma_f32 v[102:103], v[214:215], v[74:75], v[102:103]
v_pk_fma_f32 v[104:105], v[216:217], v[72:73], v[104:105]
v_pk_fma_f32 v[106:107], v[218:219], v[74:75], v[106:107]
v_pk_fma_f32 v[108:109], v[220:221], v[72:73], v[108:109]
v_pk_fma_f32 v[110:111], v[222:223], v[74:75], v[110:111]
v_pk_fma_f32 v[112:113], v[224:225], v[72:73], v[112:113]
v_pk_fma_f32 v[114:115], v[226:227], v[74:75], v[114:115]
v_pk_fma_f32 v[116:117], v[228:229], v[72:73], v[116:117]
v_pk_fma_f32 v[118:119], v[230:231], v[74:75], v[118:119]
v_pk_add_f32 v[168:169], v[88:89], v[90:91]
v_pk_add_f32 v[170:171], v[92:93], v[94:95]
v_pk_add_f32 v[172:173], v[96:97], v[98:99]
v_pk_add_f32 v[174:175], v[100:101], v[102:103]
v_pk_add_f32 v[176:177], v[104:105], v[106:107]
v_pk_add_f32 v[178:179], v[108:109], v[110:111]
v_pk_add_f32 v[180:181], v[112:113], v[114:115]
v_pk_add_f32 v[182:183], v[116:117], v[118:119]
v_add_f32 v152, v168, v169
v_add_f32 v153, v170, v171
v_add_f32 v154, v172, v173
v_add_f32 v155, v174, v175
v_add_f32 v156, v176, v177
v_add_f32 v157, v178, v179
v_add_f32 v158, v180, v181
v_add_f32 v159, v182, v183
v_pk_mul_f32 v[168:169], v[88:89], v[88:89]
v_pk_mul_f32 v[170:171], v[92:93], v[92:93]
v_pk_mul_f32 v[172:173], v[96:97], v[96:97]
v_pk_mul_f32 v[174:175], v[100:101], v[100:101]
v_pk_mul_f32 v[176:177], v[104:105], v[104:105]
v_pk_mul_f32 v[178:179], v[108:109], v[108:109]
v_pk_mul_f32 v[180:181], v[112:113], v[112:113]
v_pk_mul_f32 v[182:183], v[116:117], v[116:117]
v_pk_fma_f32 v[168:169], v[90:91], v[90:91], v[168:169]
v_pk_fma_f32 v[170:171], v[94:95], v[94:95], v[170:171]
v_pk_fma_f32 v[172:173], v[98:99], v[98:99], v[172:173]
v_pk_fma_f32 v[174:175], v[102:103], v[102:103], v[174:175]
v_pk_fma_f32 v[176:177], v[106:107], v[106:107], v[176:177]
v_pk_fma_f32 v[178:179], v[110:111], v[110:111], v[178:179]
v_pk_fma_f32 v[180:181], v[114:115], v[114:115], v[180:181]
v_pk_fma_f32 v[182:183], v[118:119], v[118:119], v[182:183]
v_add_f32 v160, v168, v169
v_add_f32 v161, v170, v171
v_add_f32 v162, v172, v173
v_add_f32 v163, v174, v175
v_add_f32 v164, v176, v177
v_add_f32 v165, v178, v179
v_add_f32 v166, v180, v181
v_add_f32 v167, v182, v183
s_nop 1
v_permlane32_swap_b32 v152, v160
v_permlane32_swap_b32 v153, v161
v_permlane32_swap_b32 v154, v162
v_permlane32_swap_b32 v155, v163
v_permlane32_swap_b32 v156, v164
v_permlane32_swap_b32 v157, v165
v_permlane32_swap_b32 v158, v166
v_permlane32_swap_b32 v159, v167
v_add_f32 v152, v152, v160
v_add_f32 v153, v153, v161
v_add_f32 v154, v154, v162
v_add_f32 v155, v155, v163
v_add_f32 v156, v156, v164
v_add_f32 v157, v157, v165
v_add_f32 v158, v158, v166
v_add_f32 v159, v159, v167
s_nop 1
v_permlane16_swap_b32 v152, v156
v_permlane16_swap_b32 v153, v157
v_permlane16_swap_b32 v154, v158
v_permlane16_swap_b32 v155, v159
v_add_f32 v152, v152, v156
v_add_f32 v153, v153, v157
v_add_f32 v154, v154, v158
v_add_f32 v155, v155, v159
v_add_f32_dpp v152, v152, v152 row_ror:8 row_mask:0xf bank_mask:0xf
v_add_f32_dpp v153, v153, v153 row_ror:8 row_mask:0xf bank_mask:0xf
v_add_f32_dpp v154, v154, v154 row_ror:8 row_mask:0xf bank_mask:0xf
v_add_f32_dpp v155, v155, v155 row_ror:8 row_mask:0xf bank_mask:0xf
v_add_f32_dpp v152, v152, v152 row_ror:4 row_mask:0xf bank_mask:0xf
v_add_f32_dpp v153, v153, v153 row_ror:4 row_mask:0xf bank_mask:0xf
v_add_f32_dpp v154, v154, v154 row_ror:4 row_mask:0xf bank_mask:0xf
v_add_f32_dpp v155, v155, v155 row_ror:4 row_mask:0xf bank_mask:0xf
v_add_f32_dpp v152, v152, v152 row_ror:2 row_mask:0xf bank_mask:0xf
v_add_f32_dpp v153, v153, v153 row_ror:2 row_mask:0xf bank_mask:0xf
v_add_f32_dpp v154, v154, v154 row_ror:2 row_mask:0xf bank_mask:0xf
v_add_f32_dpp v155, v155, v155 row_ror:2 row_mask:0xf bank_mask:0xf
v_add_f32_dpp v152, v152, v152 row_ror:1 row_mask:0xf bank_mask:0xf
v_add_f32_dpp v153, v153, v153 row_ror:1 row_mask:0xf bank_mask:0xf
v_add_f32_dpp v154, v154, v154 row_ror:1 row_mask:0xf bank_mask:0xf
v_add_f32_dpp v155, v155, v155 row_ror:1 row_mask:0xf bank_mask:0xf
ds_write_b128 v13, v[152:155] offset:256
s_waitcnt lgkmcnt(0)
s_barrier
ds_read2_b32 v[168:169], v14 offset0:64 offset1:80
ds_read2_b32 v[170:171], v14 offset0:96 offset1:112
s_waitcnt lgkmcnt(0)
v_add_f32 v168, v168, v169
v_add_f32 v170, v170, v171
v_add_f32 v168, v168, v170
v_mul_f32 v168, 0x3a800000, v168
s_nop 1
v_mov_b32_dpp v169, v168 row_ror:8 row_mask:0xf bank_mask:0xf
v_fma_f32 v170, -v168, v168, v169
v_max_f32 v170, 0, v170
v_add_f32 v170, 0x3727c5ac, v170
v_rsq_f32 v170, v170
s_nop 0
v_mul_f32 v171, -v168, v170
s_nop 1
v_mov_b32_dpp v184, v170 row_newbcast:0 row_mask:0xf bank_mask:0xf
v_mov_b32_dpp v185, v171 row_newbcast:0 row_mask:0xf bank_mask:0xf
v_mov_b32_dpp v186, v170 row_newbcast:1 row_mask:0xf bank_mask:0xf
v_mov_b32_dpp v187, v171 row_newbcast:1 row_mask:0xf bank_mask:0xf
v_mov_b32_dpp v188, v170 row_newbcast:2 row_mask:0xf bank_mask:0xf
v_mov_b32_dpp v189, v171 row_newbcast:2 row_mask:0xf bank_mask:0xf
v_mov_b32_dpp v190, v170 row_newbcast:3 row_mask:0xf bank_mask:0xf
v_mov_b32_dpp v191, v171 row_newbcast:3 row_mask:0xf bank_mask:0xf
v_mov_b32_dpp v192, v170 row_newbcast:4 row_mask:0xf bank_mask:0xf
v_mov_b32_dpp v193, v171 row_newbcast:4 row_mask:0xf bank_mask:0xf
v_mov_b32_dpp v194, v170 row_newbcast:5 row_mask:0xf bank_mask:0xf
v_mov_b32_dpp v195, v171 row_newbcast:5 row_mask:0xf bank_mask:0xf
v_mov_b32_dpp v196, v170 row_newbcast:6 row_mask:0xf bank_mask:0xf
v_mov_b32_dpp v197, v171 row_newbcast:6 row_mask:0xf bank_mask:0xf
v_mov_b32_dpp v198, v170 row_newbcast:7 row_mask:0xf bank_mask:0xf
v_mov_b32_dpp v199, v171 row_newbcast:7 row_mask:0xf bank_mask:0xf
v_pk_fma_f32 v[120:121], v[88:89], v[184:185], v[184:185] op_sel:[0,0,1] op_sel_hi:[1,0,1]
v_pk_fma_f32 v[122:123], v[90:91], v[184:185], v[184:185] op_sel:[0,0,1] op_sel_hi:[1,0,1]
v_pk_fma_f32 v[124:125], v[92:93], v[186:187], v[186:187] op_sel:[0,0,1] op_sel_hi:[1,0,1]
v_pk_fma_f32 v[126:127], v[94:95], v[186:187], v[186:187] op_sel:[0,0,1] op_sel_hi:[1,0,1]
v_pk_fma_f32 v[128:129], v[96:97], v[188:189], v[188:189] op_sel:[0,0,1] op_sel_hi:[1,0,1]
v_pk_fma_f32 v[130:131], v[98:99], v[188:189], v[188:189] op_sel:[0,0,1] op_sel_hi:[1,0,1]
v_pk_fma_f32 v[132:133], v[100:101], v[190:191], v[190:191] op_sel:[0,0,1] op_sel_hi:[1,0,1]
v_pk_fma_f32 v[134:135], v[102:103], v[190:191], v[190:191] op_sel:[0,0,1] op_sel_hi:[1,0,1]
v_pk_fma_f32 v[136:137], v[104:105], v[192:193], v[192:193] op_sel:[0,0,1] op_sel_hi:[1,0,1]
v_pk_fma_f32 v[138:139], v[106:107], v[192:193], v[192:193] op_sel:[0,0,1] op_sel_hi:[1,0,1]
v_pk_fma_f32 v[140:141], v[108:109], v[194:195], v[194:195] op_sel:[0,0,1] op_sel_hi:[1,0,1]
v_pk_fma_f32 v[142:143], v[110:111], v[194:195], v[194:195] op_sel:[0,0,1] op_sel_hi:[1,0,1]
v_pk_fma_f32 v[144:145], v[112:113], v[196:197], v[196:197] op_sel:[0,0,1] op_sel_hi:[1,0,1]
v_pk_fma_f32 v[146:147], v[114:115], v[196:197], v[196:197] op_sel:[0,0,1] op_sel_hi:[1,0,1]
v_pk_fma_f32 v[148:149], v[116:117], v[198:199], v[198:199] op_sel:[0,0,1] op_sel_hi:[1,0,1]
v_pk_fma_f32 v[150:151], v[118:119], v[198:199], v[198:199] op_sel:[0,0,1] op_sel_hi:[1,0,1]
v_pk_fma_f32 v[120:121], v[120:121], v[80:81], v[76:77]
v_pk_fma_f32 v[122:123], v[122:123], v[82:83], v[78:79]
v_pk_fma_f32 v[124:125], v[124:125], v[80:81], v[76:77]
v_pk_fma_f32 v[126:127], v[126:127], v[82:83], v[78:79]
v_pk_fma_f32 v[128:129], v[128:129], v[80:81], v[76:77]
v_pk_fma_f32 v[130:131], v[130:131], v[82:83], v[78:79]
v_pk_fma_f32 v[132:133], v[132:133], v[80:81], v[76:77]
v_pk_fma_f32 v[134:135], v[134:135], v[82:83], v[78:79]
v_pk_fma_f32 v[136:137], v[136:137], v[80:81], v[76:77]
v_pk_fma_f32 v[138:139], v[138:139], v[82:83], v[78:79]
v_pk_fma_f32 v[140:141], v[140:141], v[80:81], v[76:77]
v_pk_fma_f32 v[142:143], v[142:143], v[82:83], v[78:79]
v_pk_fma_f32 v[144:145], v[144:145], v[80:81], v[76:77]
v_pk_fma_f32 v[146:147], v[146:147], v[82:83], v[78:79]
v_pk_fma_f32 v[148:149], v[148:149], v[80:81], v[76:77]
v_pk_fma_f32 v[150:151], v[150:151], v[82:83], v[78:79]
v_cvt_pk_bf16_f32 v236, v120, v121
v_cvt_pk_bf16_f32 v237, v122, v123
v_cvt_pk_bf16_f32 v238, v124, v125
v_cvt_pk_bf16_f32 v239, v126, v127
v_cvt_pk_bf16_f32 v240, v128, v129
v_cvt_pk_bf16_f32 v241, v130, v131
v_cvt_pk_bf16_f32 v242, v132, v133
v_cvt_pk_bf16_f32 v243, v134, v135
v_cvt_pk_bf16_f32 v244, v136, v137
v_cvt_pk_bf16_f32 v245, v138, v139
v_cvt_pk_bf16_f32 v246, v140, v141
v_cvt_pk_bf16_f32 v247, v142, v143
v_cvt_pk_bf16_f32 v248, v144, v145
v_cvt_pk_bf16_f32 v249, v146, v147
v_cvt_pk_bf16_f32 v250, v148, v149
v_cvt_pk_bf16_f32 v251, v150, v151
ds_write_b64 v16, v[236:237] offset:0
ds_write_b64 v16, v[238:239] offset:16
ds_write_b64 v16, v[240:241] offset:32
ds_write_b64 v16, v[242:243] offset:48
ds_write_b64 v16, v[244:245] offset:64
ds_write_b64 v16, v[246:247] offset:80
ds_write_b64 v16, v[248:249] offset:96
ds_write_b64 v16, v[250:251] offset:112
s_waitcnt lgkmcnt(0)
ds_read_b128 v[48:51], v17 offset:0
ds_read_b128 v[52:55], v17 offset:1152
ds_read_b128 v[56:59], v17 offset:2304
ds_read_b128 v[60:63], v17 offset:3456
s_waitcnt lgkmcnt(0)
buffer_store_dwordx4 v[48:51], v252, s[12:15], s39 offen offset:0 sc1
buffer_store_dwordx4 v[52:55], v252, s[12:15], s39 offen offset:2048 sc1
buffer_store_dwordx4 v[56:59], v253, s[12:15], s39 offen offset:0 sc1
buffer_store_dwordx4 v[60:63], v253, s[12:15], s39 offen offset:2048 sc1
v_cvt_pk_bf16_f32 v236, v88, v89
v_cvt_pk_bf16_f32 v237, v90, v91
v_cvt_pk_bf16_f32 v238, v92, v93
v_cvt_pk_bf16_f32 v239, v94, v95
v_cvt_pk_bf16_f32 v240, v96, v97
v_cvt_pk_bf16_f32 v241, v98, v99
v_cvt_pk_bf16_f32 v242, v100, v101
v_cvt_pk_bf16_f32 v243, v102, v103
v_cvt_pk_bf16_f32 v244, v104, v105
v_cvt_pk_bf16_f32 v245, v106, v107
v_cvt_pk_bf16_f32 v246, v108, v109
v_cvt_pk_bf16_f32 v247, v110, v111
v_cvt_pk_bf16_f32 v248, v112, v113
v_cvt_pk_bf16_f32 v249, v114, v115
v_cvt_pk_bf16_f32 v250, v116, v117
v_cvt_pk_bf16_f32 v251, v118, v119
ds_write_b64 v16, v[236:237] offset:0
ds_write_b64 v16, v[238:239] offset:16
ds_write_b64 v16, v[240:241] offset:32
ds_write_b64 v16, v[242:243] offset:48
ds_write_b64 v16, v[244:245] offset:64
ds_write_b64 v16, v[246:247] offset:80
ds_write_b64 v16, v[248:249] offset:96
ds_write_b64 v16, v[250:251] offset:112
s_waitcnt lgkmcnt(0)
ds_read_b128 v[216:219], v17 offset:0
ds_read_b128 v[220:223], v17 offset:1152
ds_read_b128 v[224:227], v17 offset:2304
ds_read_b128 v[228:231], v17 offset:3456
s_waitcnt lgkmcnt(0)
v_lshrrev_b32 v9, 2, v1
v_lshlrev_b32 v2, 7, v9
v_lshrrev_b32 v9, 3, v1
v_and_b32 v9, 3, v9
v_lshl_add_u32 v2, v9, 5, v2
v_and_b32 v9, 3, v1
v_lshl_add_u32 v2, v9, 3, v2
v_xor_b32 v3, 32, v2
v_xor_b32 v4, 64, v2
v_xor_b32 v5, 96, v2
v_add_u32 v10, 0x10000, v2
v_add_u32 v14, 0x20000, v2
v_add_u32 v11, 0x10000, v3
v_add_u32 v15, 0x20000, v3
v_add_u32 v12, 0x10000, v4
v_add_u32 v16, 0x20000, v4
v_add_u32 v13, 0x10000, v5
v_add_u32 v17, 0x20000, v5
v_xor_b32 v24, s25, v2
v_xor_b32 v25, s25, v3
v_xor_b32 v26, s25, v10
v_xor_b32 v27, s25, v11
v_xor_b32 v28, s25, v14
v_xor_b32 v29, s25, v15
v_lshrrev_b32 v9, 3, v1
s_mov_b32 s37, 2048
v_mul_lo_u32 v254, s37, v9
v_lshrrev_b32 v9, 4, v1
v_lshlrev_b32 v9, 1, v9
v_and_b32 v19, 7, v1
v_xor_b32 v9, v9, v19
v_lshl_add_u32 v254, v9, 4, v254
v_lshlrev_b32 v20, 4, v1
v_add_u32 v21, 0x8000, v20
s_lshl_b32 s37, s26, 4
s_add_u32 s37, s37, s33
s_lshl_b32 s38, s27, 4
s_add_u32 s38, s38, s33
s_add_u32 s39, s56, s25
s_lshl_b32 s39, s39, 4
s_add_u32 s39, s39, s33
s_lshl_b32 s57, s2, 2
s_add_u32 s57, s57, s3
s_lshl_b32 s59, s57, 7
s_add_u32 s59, s59, 262144
v_mov_b32 v30, 0
v_mov_b32 v31, 1
s_and_b32 s24, s2, 0xe4
s_add_u32 s26, s24, s3
v_bfe_u32 v9, v1, 2, 2
v_lshlrev_b32 v9, 3, v9
v_add_u32 v9, s26, v9
v_lshlrev_b32 v9, 2, v9
v_and_b32 v19, 3, v1
v_add_u32 v9, v9, v19
v_lshlrev_b32 v9, 7, v9
v_mov_b32 v234, v9
s_mov_b32 s26, 262144
s_waitcnt vmcnt(0)
buffer_store_dword v31, v30, s[12:15], s59 offen offset:0 sc1
s_and_b32 s101, s21, 3
s_lshl_b32 s101, s101, 2
s_and_b32 s27, s2, 3
s_add_u32 s101, s101, s27
s_lshl_b32 s101, s101, 8
s_add_u32 s101, s101, 20480
v_lshrrev_b32 v233, 4, v1
v_lshlrev_b32 v233, 4, v233
v_readfirstlane_b32 s84, v234
s_mov_b32 s27, s89
s_add_u32 s85, s27, 0
s_and_b32 s85, s85, 3
s_lshl_b32 s85, s85, 7
s_add_u32 s85, s85, s84
s_add_u32 s86, s27, 1
s_and_b32 s86, s86, 3
s_lshl_b32 s86, s86, 7
s_add_u32 s86, s86, s84
s_add_u32 s87, s27, 2
s_and_b32 s87, s87, 3
s_lshl_b32 s87, s87, 7
s_add_u32 s87, s87, s84
s_add_u32 s88, s27, 3
s_and_b32 s88, s88, 3
s_lshl_b32 s88, s88, 7
s_add_u32 s88, s88, s84
buffer_load_dwordx4 v[236:239], v233, s[12:15], s101 offen offset:0
buffer_load_dwordx4 v[240:243], v233, s[12:15], s101 offen offset:64
buffer_load_dwordx4 v[244:247], v233, s[12:15], s101 offen offset:128
buffer_load_dwordx4 v[248:251], v233, s[12:15], s101 offen offset:192
s_add_u32 s101, s101, 24576
buffer_load_dwordx4 v[96:99], v233, s[12:15], s101 offen offset:0
buffer_load_dwordx4 v[100:103], v233, s[12:15], s101 offen offset:64
buffer_load_dwordx4 v[104:107], v233, s[12:15], s101 offen offset:128
buffer_load_dwordx4 v[108:111], v233, s[12:15], s101 offen offset:192
s_add_u32 m0, s32, 32768
s_nop 0
buffer_load_dwordx4 v6, s[8:11], s49 offen offset:0  lds
buffer_load_dwordx4 v7, s[8:11], s49 offen offset:1024  lds
buffer_load_dwordx4 v8, s[8:11], s49 offen offset:2048  lds
buffer_load_dwordx4 v18, s[8:11], s49 offen offset:3072  lds
s_add_u32 m0, s32, 49152
s_add_u32 s34, s49, 458752
buffer_load_dwordx4 v6, s[8:11], s34 offen offset:0  lds
buffer_load_dwordx4 v7, s[8:11], s34 offen offset:1024  lds
buffer_load_dwordx4 v8, s[8:11], s34 offen offset:2048  lds
buffer_load_dwordx4 v18, s[8:11], s34 offen offset:3072  lds
s_add_u32 m0, s32, 65536
s_nop 0
buffer_load_dwordx4 v6, s[8:11], s50 offen offset:0  lds
buffer_load_dwordx4 v7, s[8:11], s50 offen offset:1024  lds
buffer_load_dwordx4 v8, s[8:11], s50 offen offset:2048  lds
buffer_load_dwordx4 v18, s[8:11], s50 offen offset:3072  lds
s_add_u32 m0, s32, 81920
s_add_u32 s34, s50, 458752
buffer_load_dwordx4 v6, s[8:11], s34 offen offset:0  lds
buffer_load_dwordx4 v7, s[8:11], s34 offen offset:1024  lds
buffer_load_dwordx4 v8, s[8:11], s34 offen offset:2048  lds
buffer_load_dwordx4 v18, s[8:11], s34 offen offset:3072  lds
s_buffer_load_dword s92, s[12:15], s85 offset:262144 glc
s_buffer_load_dword s93, s[12:15], s85 offset:266240 glc
s_buffer_load_dword s94, s[12:15], s85 offset:270336 glc
s_buffer_load_dword s95, s[12:15], s85 offset:274432 glc
s_waitcnt lgkmcnt(0)
s_and_b32 s92, s92, s93
s_and_b32 s92, s92, s94
s_and_b32 s92, s92, s95
s_cbranch_scc1 mlp_kernel_q1_ok
s_mov_b32 s27, 0x40000
mlp_kernel_q1:
s_sleep 4
s_buffer_load_dword s92, s[12:15], s85 offset:262144 glc
s_buffer_load_dword s93, s[12:15], s85 offset:266240 glc
s_buffer_load_dword s94, s[12:15], s85 offset:270336 glc
s_buffer_load_dword s95, s[12:15], s85 offset:274432 glc
s_waitcnt lgkmcnt(0)
s_sub_u32 s27, s27, 1
s_cbranch_scc1 mlp_kernel_q1_ok
s_and_b32 s92, s92, s93
s_and_b32 s92, s92, s94
s_and_b32 s92, s92, s95
s_cbranch_scc0 mlp_kernel_q1
mlp_kernel_q1_ok:
buffer_load_dwordx4 a[0:3], v20, s[12:15], s40 offen offset:0 sc1
buffer_load_dwordx4 a[4:7], v20, s[12:15], s40 offen offset:1024 sc1
buffer_load_dwordx4 a[8:11], v20, s[12:15], s40 offen offset:2048 sc1
buffer_load_dwordx4 a[12:15], v20, s[12:15], s40 offen offset:3072 sc1
buffer_load_dwordx4 a[128:131], v21, s[12:15], s40 offen offset:0 sc1
buffer_load_dwordx4 a[132:135], v21, s[12:15], s40 offen offset:1024 sc1
buffer_load_dwordx4 a[136:139], v21, s[12:15], s40 offen offset:2048 sc1
buffer_load_dwordx4 a[140:143], v21, s[12:15], s40 offen offset:3072 sc1
buffer_load_dwordx4 a[16:19], v20, s[12:15], s41 offen offset:0 sc1
buffer_load_dwordx4 a[20:23], v20, s[12:15], s41 offen offset:1024 sc1
buffer_load_dwordx4 a[24:27], v20, s[12:15], s41 offen offset:2048 sc1
buffer_load_dwordx4 a[28:31], v20, s[12:15], s41 offen offset:3072 sc1
buffer_load_dwordx4 a[144:147], v21, s[12:15], s41 offen offset:0 sc1
buffer_load_dwordx4 a[148:151], v21, s[12:15], s41 offen offset:1024 sc1
buffer_load_dwordx4 a[152:155], v21, s[12:15], s41 offen offset:2048 sc1
buffer_load_dwordx4 a[156:159], v21, s[12:15], s41 offen offset:3072 sc1
s_add_u32 m0, s32, 98304
s_nop 0
buffer_load_dwordx4 v6, s[8:11], s51 offen offset:0  lds
buffer_load_dwordx4 v7, s[8:11], s51 offen offset:1024  lds
buffer_load_dwordx4 v8, s[8:11], s51 offen offset:2048  lds
buffer_load_dwordx4 v18, s[8:11], s51 offen offset:3072  lds
s_add_u32 m0, s32, 114688
s_add_u32 s34, s51, 458752
buffer_load_dwordx4 v6, s[8:11], s34 offen offset:0  lds
buffer_load_dwordx4 v7, s[8:11], s34 offen offset:1024  lds
buffer_load_dwordx4 v8, s[8:11], s34 offen offset:2048  lds
buffer_load_dwordx4 v18, s[8:11], s34 offen offset:3072  lds
s_waitcnt vmcnt(40)
v_pk_add_f32 v[236:237], v[236:237], v[96:97]
v_pk_add_f32 v[238:239], v[238:239], v[98:99]
v_pk_add_f32 v[240:241], v[240:241], v[100:101]
v_pk_add_f32 v[242:243], v[242:243], v[102:103]
v_pk_add_f32 v[244:245], v[244:245], v[104:105]
v_pk_add_f32 v[246:247], v[246:247], v[106:107]
v_pk_add_f32 v[248:249], v[248:249], v[108:109]
v_pk_add_f32 v[250:251], v[250:251], v[110:111]
v_cvt_pk_bf16_f32 v96, v236, v237
v_cvt_pk_bf16_f32 v97, v238, v239
v_cvt_pk_bf16_f32 v98, v240, v241
v_cvt_pk_bf16_f32 v99, v242, v243
v_cvt_pk_bf16_f32 v100, v244, v245
v_cvt_pk_bf16_f32 v101, v246, v247
v_cvt_pk_bf16_f32 v102, v248, v249
v_cvt_pk_bf16_f32 v103, v250, v251
v_lshlrev_b32 v236, 16, v96
v_and_b32 v237, 0xffff0000, v96
v_lshlrev_b32 v238, 16, v97
v_and_b32 v239, 0xffff0000, v97
v_lshlrev_b32 v240, 16, v98
v_and_b32 v241, 0xffff0000, v98
v_lshlrev_b32 v242, 16, v99
v_and_b32 v243, 0xffff0000, v99
v_lshlrev_b32 v244, 16, v100
v_and_b32 v245, 0xffff0000, v100
v_lshlrev_b32 v246, 16, v101
v_and_b32 v247, 0xffff0000, v101
v_lshlrev_b32 v248, 16, v102
v_and_b32 v249, 0xffff0000, v102
v_lshlrev_b32 v250, 16, v103
v_and_b32 v251, 0xffff0000, v103
v_mul_f32 v236, 0xbf317218, v236
v_mul_f32 v237, 0xbf317218, v237
v_mul_f32 v238, 0xbf317218, v238
v_mul_f32 v239, 0xbf317218, v239
v_mul_f32 v240, 0xbf317218, v240
v_mul_f32 v241, 0xbf317218, v241
v_mul_f32 v242, 0xbf317218, v242
v_mul_f32 v243, 0xbf317218, v243
v_mul_f32 v244, 0xbf317218, v244
v_mul_f32 v245, 0xbf317218, v245
v_mul_f32 v246, 0xbf317218, v246
v_mul_f32 v247, 0xbf317218, v247
v_mul_f32 v248, 0xbf317218, v248
v_mul_f32 v249, 0xbf317218, v249
v_mul_f32 v250, 0xbf317218, v250
v_mul_f32 v251, 0xbf317218, v251
v_add_u32 v22, 114688, v20
s_and_b32 s24, s2, 0xe7
v_and_b32 v9, 3, v1
v_lshlrev_b32 v9, 3, v9
v_add_u32 v9, s24, v9
v_lshlrev_b32 v9, 2, v9
v_add_u32 v9, s3, v9
v_lshlrev_b32 v9, 7, v9
s_and_b32 s27, s2, 3
s_mul_i32 s30, s27, 28672
s_add_u32 s30, s30, s33
s_and_b32 s23, s21, 3
s_mul_i32 s28, s27, 1835008
s_lshl_b32 s29, s23, 9
s_add_u32 s28, s28, s29
s_and_b32 s29, s3, 1
s_lshl_b32 s29, s29, 16
s_add_u32 s28, s28, s29
s_lshr_b32 s29, s3, 1
s_mul_i32 s31, s29, 393216
s_lshl_b32 s29, s29, 19
s_add_u32 s28, s28, s29
s_lshl_b32 s23, s23, 2
s_add_u32 s23, s23, s27
s_lshl_b32 s24, s23, 7
s_add_u32 s24, s24, s58
s_lshl_b32 s25, s23, 11
s_add_u32 s25, s25, s58
s_add_u32 s25, s25, 5242880
s_add_u32 s29, s27, 1
s_and_b32 s29, s29, 3
s_lshl_b32 s29, s29, 7
s_add_u32 s20, s28, s29
s_add_u32 s29, s27, 2
s_and_b32 s29, s29, 3
s_lshl_b32 s29, s29, 7
s_add_u32 s21, s28, s29
s_add_u32 s29, s27, 3
s_and_b32 s29, s29, 3
s_lshl_b32 s29, s29, 7
s_add_u32 s22, s28, s29
s_add_u32 s29, s27, 4
s_and_b32 s29, s29, 3
s_lshl_b32 s29, s29, 7
s_add_u32 s33, s28, s29
s_sub_u32 s29, s27, 1
s_and_b32 s29, s29, 3
s_and_b32 s28, s2, 0xfc
s_add_u32 s28, s28, s29
s_lshl_b32 s28, s28, 2
s_add_u32 s28, s28, s3
s_lshl_b32 s29, s28, 7
v_mov_b32 v23, s29
s_mul_i32 s58, s28, 12288
s_add_u32 s58, s58, 29360128
s_sub_u32 s29, s27, 2
s_and_b32 s29, s29, 3
s_and_b32 s28, s2, 0xfc
s_add_u32 s28, s28, s29
s_lshl_b32 s28, s28, 2
s_add_u32 s28, s28, s3
s_lshl_b32 s29, s28, 7
v_mov_b32 v211, s29
s_mul_i32 s56, s28, 12288
s_add_u32 s56, s56, 29364224
s_sub_u32 s29, s27, 3
s_and_b32 s29, s29, 3
s_and_b32 s28, s2, 0xfc
s_add_u32 s28, s28, s29
s_lshl_b32 s28, s28, 2
s_add_u32 s28, s28, s3
s_lshl_b32 s29, s28, 7
v_mov_b32 v210, s29
s_mul_i32 s23, s28, 12288
s_add_u32 s23, s23, 29368320
v_cmp_gt_u32 vcc, 32, v1
s_mul_i32 s57, s57, 12288
s_add_u32 s57, s57, 29360128
v_cndmask_b32 v23, v211, v23, vcc
v_and_b32 v19, 15, v1
v_lshlrev_b32 v208, 11, v19
v_bfe_u32 v19, v1, 4, 1
v_lshl_add_u32 v208, v19, 5, v208
v_lshrrev_b32 v19, 5, v1
v_lshl_add_u32 v208, v19, 4, v208
v_add_u32 v209, 0x8000, v208
v_add_u32 v255, 0x1000, v20
v_add_u32 v232, 0x2000, v20
s_waitcnt vmcnt(16)
s_barrier
ds_read_b64_tr_b16 v[144:145], v2 offset:0
ds_read_b64_tr_b16 v[146:147], v2 offset:2048
ds_read_b64_tr_b16 v[148:149], v2 offset:8192
ds_read_b64_tr_b16 v[150:151], v2 offset:10240
ds_read_b64_tr_b16 v[152:153], v2 offset:16384
ds_read_b64_tr_b16 v[154:155], v2 offset:18432
ds_read_b64_tr_b16 v[156:157], v2 offset:24576
ds_read_b64_tr_b16 v[158:159], v2 offset:26624
ds_read_b64_tr_b16 v[160:161], v3 offset:0
ds_read_b64_tr_b16 v[162:163], v3 offset:2048
ds_read_b64_tr_b16 v[164:165], v3 offset:8192
ds_read_b64_tr_b16 v[166:167], v3 offset:10240
ds_read_b64_tr_b16 v[168:169], v3 offset:16384
ds_read_b64_tr_b16 v[170:171], v3 offset:18432
ds_read_b64_tr_b16 v[172:173], v3 offset:24576
ds_read_b64_tr_b16 v[174:175], v3 offset:26624
s_waitcnt lgkmcnt(8)
v_mfma_f32_16x16x32_bf16 v[32:35], v[144:147], a[0:3], 0
s_buffer_load_dword s92, s[12:15], s86 offset:262144 glc
s_buffer_load_dword s93, s[12:15], s86 offset:266240 glc
s_buffer_load_dword s94, s[12:15], s86 offset:270336 glc
s_buffer_load_dword s95, s[12:15], s86 offset:274432 glc
v_mfma_f32_16x16x32_bf16 v[32:35], v[148:151], a[4:7], v[32:35]
ds_read_b64_tr_b16 v[176:177], v4 offset:0
ds_read_b64_tr_b16 v[178:179], v4 offset:2048
v_mfma_f32_16x16x32_bf16 v[32:35], v[152:155], a[8:11], v[32:35]
ds_read_b64_tr_b16 v[180:181], v4 offset:8192
ds_read_b64_tr_b16 v[182:183], v4 offset:10240
v_mfma_f32_16x16x32_bf16 v[32:35], v[156:159], a[12:15], v[32:35]
ds_read_b64_tr_b16 v[184:185], v4 offset:16384
v_mfma_f32_16x16x32_bf16 v[64:67], v[144:147], a[128:131], 0
ds_read_b64_tr_b16 v[186:187], v4 offset:18432
v_mfma_f32_16x16x32_bf16 v[64:67], v[148:151], a[132:135], v[64:67]
ds_read_b64_tr_b16 v[188:189], v4 offset:24576
v_mfma_f32_16x16x32_bf16 v[64:67], v[152:155], a[136:139], v[64:67]
ds_read_b64_tr_b16 v[190:191], v4 offset:26624
v_mfma_f32_16x16x32_bf16 v[64:67], v[156:159], a[140:143], v[64:67]
s_waitcnt lgkmcnt(8)
v_mfma_f32_16x16x32_bf16 v[36:39], v[160:163], a[0:3], 0
ds_read_b64_tr_b16 v[144:145], v5 offset:0
ds_read_b64_tr_b16 v[146:147], v5 offset:2048
v_mfma_f32_16x16x32_bf16 v[36:39], v[164:167], a[4:7], v[36:39]
ds_read_b64_tr_b16 v[148:149], v5 offset:8192
v_mfma_f32_16x16x32_bf16 v[36:39], v[168:171], a[8:11], v[36:39]
ds_read_b64_tr_b16 v[150:151], v5 offset:10240
v_mfma_f32_16x16x32_bf16 v[36:39], v[172:175], a[12:15], v[36:39]
ds_read_b64_tr_b16 v[152:153], v5 offset:16384
v_mfma_f32_16x16x32_bf16 v[68:71], v[160:163], a[128:131], 0
ds_read_b64_tr_b16 v[154:155], v5 offset:18432
v_mfma_f32_16x16x32_bf16 v[68:71], v[164:167], a[132:135], v[68:71]
ds_read_b64_tr_b16 v[156:157], v5 offset:24576
v_mfma_f32_16x16x32_bf16 v[68:71], v[168:171], a[136:139], v[68:71]
ds_read_b64_tr_b16 v[158:159], v5 offset:26624
v_mfma_f32_16x16x32_bf16 v[68:71], v[172:175], a[140:143], v[68:71]
s_waitcnt lgkmcnt(8)
v_mfma_f32_16x16x32_bf16 v[40:43], v[176:179], a[0:3], 0
ds_read_b64_tr_b16 v[160:161], v2 offset:4096
ds_read_b64_tr_b16 v[162:163], v2 offset:6144
v_mfma_f32_16x16x32_bf16 v[40:43], v[180:183], a[4:7], v[40:43]
ds_read_b64_tr_b16 v[164:165], v2 offset:12288
v_mfma_f32_16x16x32_bf16 v[40:43], v[184:187], a[8:11], v[40:43]
ds_read_b64_tr_b16 v[166:167], v2 offset:14336
v_mfma_f32_16x16x32_bf16 v[40:43], v[188:191], a[12:15], v[40:43]
ds_read_b64_tr_b16 v[168:169], v2 offset:20480
v_mfma_f32_16x16x32_bf16 v[72:75], v[176:179], a[128:131], 0
ds_read_b64_tr_b16 v[170:171], v2 offset:22528
v_mfma_f32_16x16x32_bf16 v[72:75], v[180:183], a[132:135], v[72:75]
ds_read_b64_tr_b16 v[172:173], v2 offset:28672
v_mfma_f32_16x16x32_bf16 v[72:75], v[184:187], a[136:139], v[72:75]
ds_read_b64_tr_b16 v[174:175], v2 offset:30720
v_mfma_f32_16x16x32_bf16 v[72:75], v[188:191], a[140:143], v[72:75]
s_waitcnt lgkmcnt(8)
v_mfma_f32_16x16x32_bf16 v[44:47], v[144:147], a[0:3], 0
s_waitcnt lgkmcnt(0)
s_and_b32 s92, s92, s93
s_and_b32 s92, s92, s94
s_and_b32 s92, s92, s95
s_cbranch_scc1 mlp_kernel_q2_ok
s_mov_b32 s27, 0x40000
mlp_kernel_q2:
s_sleep 4
s_buffer_load_dword s92, s[12:15], s86 offset:262144 glc
s_buffer_load_dword s93, s[12:15], s86 offset:266240 glc
s_buffer_load_dword s94, s[12:15], s86 offset:270336 glc
s_buffer_load_dword s95, s[12:15], s86 offset:274432 glc
s_waitcnt lgkmcnt(0)
s_sub_u32 s27, s27, 1
s_cbranch_scc1 mlp_kernel_q2_ok
s_and_b32 s92, s92, s93
s_and_b32 s92, s92, s94
s_and_b32 s92, s92, s95
s_cbranch_scc0 mlp_kernel_q2
mlp_kernel_q2_ok:
ds_read_b64_tr_b16 v[176:177], v3 offset:4096
v_mfma_f32_16x16x32_bf16 v[44:47], v[148:151], a[4:7], v[44:47]
buffer_load_dwordx4 a[32:35], v20, s[12:15], s42 offen offset:0 sc1
v_mfma_f32_16x16x32_bf16 v[44:47], v[152:155], a[8:11], v[44:47]
ds_read_b64_tr_b16 v[178:179], v3 offset:6144
ds_read_b64_tr_b16 v[180:181], v3 offset:12288
v_mfma_f32_16x16x32_bf16 v[44:47], v[156:159], a[12:15], v[44:47]
buffer_load_dwordx4 a[36:39], v20, s[12:15], s42 offen offset:1024 sc1
v_mfma_f32_16x16x32_bf16 v[76:79], v[144:147], a[128:131], 0
ds_read_b64_tr_b16 v[182:183], v3 offset:14336
ds_read_b64_tr_b16 v[184:185], v3 offset:20480
v_mfma_f32_16x16x32_bf16 v[76:79], v[148:151], a[132:135], v[76:79]
s_buffer_load_dword s92, s[12:15], s87 offset:262144 glc
s_buffer_load_dword s93, s[12:15], s87 offset:266240 glc
s_buffer_load_dword s94, s[12:15], s87 offset:270336 glc
s_buffer_load_dword s95, s[12:15], s87 offset:274432 glc
v_mfma_f32_16x16x32_bf16 v[76:79], v[152:155], a[136:139], v[76:79]
buffer_load_dwordx4 a[40:43], v20, s[12:15], s42 offen offset:2048 sc1
v_mfma_f32_16x16x32_bf16 v[76:79], v[156:159], a[140:143], v[76:79]
ds_read_b64_tr_b16 v[186:187], v3 offset:22528
v_mfma_f32_16x16x32_bf16 v[48:51], v[160:163], a[0:3], 0
ds_read_b64_tr_b16 v[188:189], v3 offset:28672
ds_read_b64_tr_b16 v[190:191], v3 offset:30720
v_mfma_f32_16x16x32_bf16 v[48:51], v[164:167], a[4:7], v[48:51]
buffer_load_dwordx4 a[44:47], v20, s[12:15], s42 offen offset:3072 sc1
v_mfma_f32_16x16x32_bf16 v[48:51], v[168:171], a[8:11], v[48:51]
ds_read_b64_tr_b16 v[144:145], v4 offset:4096
ds_read_b64_tr_b16 v[146:147], v4 offset:6144
v_mfma_f32_16x16x32_bf16 v[48:51], v[172:175], a[12:15], v[48:51]
ds_read_b64_tr_b16 v[148:149], v4 offset:12288
ds_read_b64_tr_b16 v[150:151], v4 offset:14336
v_mfma_f32_16x16x32_bf16 v[80:83], v[160:163], a[128:131], 0
buffer_load_dwordx4 a[160:163], v21, s[12:15], s42 offen offset:0 sc1
v_mfma_f32_16x16x32_bf16 v[80:83], v[164:167], a[132:135], v[80:83]
ds_read_b64_tr_b16 v[152:153], v4 offset:20480
ds_read_b64_tr_b16 v[154:155], v4 offset:22528
v_mfma_f32_16x16x32_bf16 v[80:83], v[168:171], a[136:139], v[80:83]
ds_read_b64_tr_b16 v[156:157], v4 offset:28672
ds_read_b64_tr_b16 v[158:159], v4 offset:30720
v_mfma_f32_16x16x32_bf16 v[80:83], v[172:175], a[140:143], v[80:83]
s_waitcnt lgkmcnt(8)
v_mfma_f32_16x16x32_bf16 v[52:55], v[176:179], a[0:3], 0
buffer_load_dwordx4 a[164:167], v21, s[12:15], s42 offen offset:1024 sc1
v_mfma_f32_16x16x32_bf16 v[52:55], v[180:183], a[4:7], v[52:55]
ds_read_b64_tr_b16 v[160:161], v5 offset:4096
ds_read_b64_tr_b16 v[162:163], v5 offset:6144
v_mfma_f32_16x16x32_bf16 v[52:55], v[184:187], a[8:11], v[52:55]
buffer_load_dwordx4 a[168:171], v21, s[12:15], s42 offen offset:2048 sc1
v_mfma_f32_16x16x32_bf16 v[52:55], v[188:191], a[12:15], v[52:55]
ds_read_b64_tr_b16 v[164:165], v5 offset:12288
ds_read_b64_tr_b16 v[166:167], v5 offset:14336
v_mfma_f32_16x16x32_bf16 v[84:87], v[176:179], a[128:131], 0
ds_read_b64_tr_b16 v[168:169], v5 offset:20480
ds_read_b64_tr_b16 v[170:171], v5 offset:22528
v_mfma_f32_16x16x32_bf16 v[84:87], v[180:183], a[132:135], v[84:87]
buffer_load_dwordx4 a[172:175], v21, s[12:15], s42 offen offset:3072 sc1
v_mfma_f32_16x16x32_bf16 v[84:87], v[184:187], a[136:139], v[84:87]
ds_read_b64_tr_b16 v[172:173], v5 offset:28672
ds_read_b64_tr_b16 v[174:175], v5 offset:30720
v_mfma_f32_16x16x32_bf16 v[84:87], v[188:191], a[140:143], v[84:87]
s_waitcnt lgkmcnt(8)
s_waitcnt vmcnt(16)
s_barrier
v_mfma_f32_16x16x32_bf16 v[56:59], v[144:147], a[0:3], 0
buffer_load_dwordx4 a[48:51], v20, s[12:15], s43 offen offset:0 sc1
v_mfma_f32_16x16x32_bf16 v[56:59], v[148:151], a[4:7], v[56:59]
ds_read_b64_tr_b16 v[176:177], v2 offset:32768
ds_read_b64_tr_b16 v[178:179], v2 offset:34816
v_mfma_f32_16x16x32_bf16 v[56:59], v[152:155], a[8:11], v[56:59]
ds_read_b64_tr_b16 v[180:181], v2 offset:40960
ds_read_b64_tr_b16 v[182:183], v2 offset:43008
v_mfma_f32_16x16x32_bf16 v[56:59], v[156:159], a[12:15], v[56:59]
buffer_load_dwordx4 a[52:55], v20, s[12:15], s43 offen offset:1024 sc1
v_mfma_f32_16x16x32_bf16 v[88:91], v[144:147], a[128:131], 0
ds_read_b64_tr_b16 v[184:185], v2 offset:49152
ds_read_b64_tr_b16 v[186:187], v2 offset:51200
v_mfma_f32_16x16x32_bf16 v[88:91], v[148:151], a[132:135], v[88:91]
ds_read_b64_tr_b16 v[188:189], v2 offset:57344
v_mfma_f32_16x16x32_bf16 v[88:91], v[152:155], a[136:139], v[88:91]
buffer_load_dwordx4 a[56:59], v20, s[12:15], s43 offen offset:2048 sc1
v_mfma_f32_16x16x32_bf16 v[88:91], v[156:159], a[140:143], v[88:91]
ds_read_b64_tr_b16 v[190:191], v2 offset:59392
s_waitcnt lgkmcnt(8)
v_mfma_f32_16x16x32_bf16 v[60:63], v[160:163], a[0:3], 0
ds_read_b64_tr_b16 v[144:145], v3 offset:32768
ds_read_b64_tr_b16 v[146:147], v3 offset:34816
v_mfma_f32_16x16x32_bf16 v[60:63], v[164:167], a[4:7], v[60:63]
buffer_load_dwordx4 a[60:63], v20, s[12:15], s43 offen offset:3072 sc1
v_mfma_f32_16x16x32_bf16 v[60:63], v[168:171], a[8:11], v[60:63]
ds_read_b64_tr_b16 v[148:149], v3 offset:40960
ds_read_b64_tr_b16 v[150:151], v3 offset:43008
v_mfma_f32_16x16x32_bf16 v[60:63], v[172:175], a[12:15], v[60:63]
ds_read_b64_tr_b16 v[152:153], v3 offset:49152
v_mfma_f32_16x16x32_bf16 v[92:95], v[160:163], a[128:131], 0
buffer_load_dwordx4 a[176:179], v21, s[12:15], s43 offen offset:0 sc1
v_mfma_f32_16x16x32_bf16 v[92:95], v[164:167], a[132:135], v[92:95]
s_add_u32 m0, s32, 131072
ds_read_b64_tr_b16 v[154:155], v3 offset:51200
v_mfma_f32_16x16x32_bf16 v[92:95], v[168:171], a[136:139], v[92:95]
buffer_load_dwordx4 v6, s[8:11], s52 offen offset:0  lds
v_mfma_f32_16x16x32_bf16 v[92:95], v[172:175], a[140:143], v[92:95]
ds_read_b64_tr_b16 v[156:157], v3 offset:57344
s_waitcnt lgkmcnt(7)
v_mfma_f32_16x16x32_bf16 v[32:35], v[176:179], a[16:19], v[32:35]
buffer_load_dwordx4 a[180:183], v21, s[12:15], s43 offen offset:1024 sc1
v_mfma_f32_16x16x32_bf16 v[32:35], v[180:183], a[20:23], v[32:35]
ds_read_b64_tr_b16 v[158:159], v3 offset:59392
ds_read_b64_tr_b16 v[160:161], v4 offset:32768
v_mfma_f32_16x16x32_bf16 v[32:35], v[184:187], a[24:27], v[32:35]
buffer_load_dwordx4 a[184:187], v21, s[12:15], s43 offen offset:2048 sc1
v_mfma_f32_16x16x32_bf16 v[32:35], v[188:191], a[28:31], v[32:35]
ds_read_b64_tr_b16 v[162:163], v4 offset:34816
ds_read_b64_tr_b16 v[164:165], v4 offset:40960
v_mfma_f32_16x16x32_bf16 v[64:67], v[176:179], a[144:147], v[64:67]
buffer_load_dwordx4 v7, s[8:11], s52 offen offset:1024  lds
v_mfma_f32_16x16x32_bf16 v[64:67], v[180:183], a[148:151], v[64:67]
ds_read_b64_tr_b16 v[166:167], v4 offset:43008
ds_read_b64_tr_b16 v[168:169], v4 offset:49152
v_mfma_f32_16x16x32_bf16 v[64:67], v[184:187], a[152:155], v[64:67]
buffer_load_dwordx4 a[188:191], v21, s[12:15], s43 offen offset:3072 sc1
v_mfma_f32_16x16x32_bf16 v[64:67], v[188:191], a[156:159], v[64:67]
ds_read_b64_tr_b16 v[170:171], v4 offset:51200
s_waitcnt lgkmcnt(6)
v_mfma_f32_16x16x32_bf16 v[36:39], v[144:147], a[16:19], v[36:39]
ds_read_b64_tr_b16 v[172:173], v4 offset:57344
s_waitcnt lgkmcnt(0)
s_and_b32 s92, s92, s93
s_and_b32 s92, s92, s94
s_and_b32 s92, s92, s95
s_cbranch_scc1 mlp_kernel_q3_ok
s_mov_b32 s27, 0x40000
mlp_kernel_q3:
s_sleep 4
s_buffer_load_dword s92, s[12:15], s87 offset:262144 glc
s_buffer_load_dword s93, s[12:15], s87 offset:266240 glc
s_buffer_load_dword s94, s[12:15], s87 offset:270336 glc
s_buffer_load_dword s95, s[12:15], s87 offset:274432 glc
s_waitcnt lgkmcnt(0)
s_sub_u32 s27, s27, 1
s_cbranch_scc1 mlp_kernel_q3_ok
s_and_b32 s92, s92, s93
s_and_b32 s92, s92, s94
s_and_b32 s92, s92, s95
s_cbranch_scc0 mlp_kernel_q3
mlp_kernel_q3_ok:
v_mfma_f32_16x16x32_bf16 v[36:39], v[148:151], a[20:23], v[36:39]
ds_read_b64_tr_b16 v[174:175], v4 offset:59392
ds_read_b64_tr_b16 v[176:177], v5 offset:32768
v_mfma_f32_16x16x32_bf16 v[36:39], v[152:155], a[24:27], v[36:39]
buffer_load_dwordx4 a[64:67], v20, s[12:15], s44 offen offset:0 sc1
v_mfma_f32_16x16x32_bf16 v[36:39], v[156:159], a[28:31], v[36:39]
ds_read_b64_tr_b16 v[178:179], v5 offset:34816
ds_read_b64_tr_b16 v[180:181], v5 offset:40960
v_mfma_f32_16x16x32_bf16 v[68:71], v[144:147], a[144:147], v[68:71]
buffer_load_dwordx4 a[68:71], v20, s[12:15], s44 offen offset:1024 sc1
v_mfma_f32_16x16x32_bf16 v[68:71], v[148:151], a[148:151], v[68:71]
ds_read_b64_tr_b16 v[182:183], v5 offset:43008
ds_read_b64_tr_b16 v[184:185], v5 offset:49152
v_mfma_f32_16x16x32_bf16 v[68:71], v[152:155], a[152:155], v[68:71]
buffer_load_dwordx4 a[72:75], v20, s[12:15], s44 offen offset:2048 sc1
s_buffer_load_dword s92, s[12:15], s88 offset:262144 glc
s_buffer_load_dword s93, s[12:15], s88 offset:266240 glc
s_buffer_load_dword s94, s[12:15], s88 offset:270336 glc
s_buffer_load_dword s95, s[12:15], s88 offset:274432 glc
v_mfma_f32_16x16x32_bf16 v[68:71], v[156:159], a[156:159], v[68:71]
ds_read_b64_tr_b16 v[186:187], v5 offset:51200
s_waitcnt lgkmcnt(6)
v_mfma_f32_16x16x32_bf16 v[40:43], v[160:163], a[16:19], v[40:43]
ds_read_b64_tr_b16 v[188:189], v5 offset:57344
ds_read_b64_tr_b16 v[190:191], v5 offset:59392
v_mfma_f32_16x16x32_bf16 v[40:43], v[164:167], a[20:23], v[40:43]
buffer_load_dwordx4 a[76:79], v20, s[12:15], s44 offen offset:3072 sc1
v_mfma_f32_16x16x32_bf16 v[40:43], v[168:171], a[24:27], v[40:43]
buffer_load_dwordx4 v8, s[8:11], s52 offen offset:2048  lds
ds_read_b64_tr_b16 v[144:145], v2 offset:36864
v_mfma_f32_16x16x32_bf16 v[40:43], v[172:175], a[28:31], v[40:43]
ds_read_b64_tr_b16 v[146:147], v2 offset:38912
ds_read_b64_tr_b16 v[148:149], v2 offset:45056
v_mfma_f32_16x16x32_bf16 v[72:75], v[160:163], a[144:147], v[72:75]
buffer_load_dwordx4 a[192:195], v21, s[12:15], s44 offen offset:0 sc1
v_mfma_f32_16x16x32_bf16 v[72:75], v[164:167], a[148:151], v[72:75]
ds_read_b64_tr_b16 v[150:151], v2 offset:47104
ds_read_b64_tr_b16 v[152:153], v2 offset:53248
v_mfma_f32_16x16x32_bf16 v[72:75], v[168:171], a[152:155], v[72:75]
buffer_load_dwordx4 v18, s[8:11], s52 offen offset:3072  lds
v_mfma_f32_16x16x32_bf16 v[72:75], v[172:175], a[156:159], v[72:75]
ds_read_b64_tr_b16 v[154:155], v2 offset:55296
s_waitcnt lgkmcnt(6)
v_mfma_f32_16x16x32_bf16 v[44:47], v[176:179], a[16:19], v[44:47]
ds_read_b64_tr_b16 v[156:157], v2 offset:61440
ds_read_b64_tr_b16 v[158:159], v2 offset:63488
v_mfma_f32_16x16x32_bf16 v[44:47], v[180:183], a[20:23], v[44:47]
buffer_load_dwordx4 a[196:199], v21, s[12:15], s44 offen offset:1024 sc1
v_mfma_f32_16x16x32_bf16 v[44:47], v[184:187], a[24:27], v[44:47]
ds_read_b64_tr_b16 v[160:161], v3 offset:36864
ds_read_b64_tr_b16 v[162:163], v3 offset:38912
v_mfma_f32_16x16x32_bf16 v[44:47], v[188:191], a[28:31], v[44:47]
buffer_load_dwordx4 a[200:203], v21, s[12:15], s44 offen offset:2048 sc1
v_mfma_f32_16x16x32_bf16 v[76:79], v[176:179], a[144:147], v[76:79]
ds_read_b64_tr_b16 v[164:165], v3 offset:45056
s_add_u32 m0, s32, 147456
v_mfma_f32_16x16x32_bf16 v[76:79], v[180:183], a[148:151], v[76:79]
ds_read_b64_tr_b16 v[166:167], v3 offset:47104
s_add_u32 s34, s52, 458752
v_mfma_f32_16x16x32_bf16 v[76:79], v[184:187], a[152:155], v[76:79]
ds_read_b64_tr_b16 v[168:169], v3 offset:53248
ds_read_b64_tr_b16 v[170:171], v3 offset:55296
v_mfma_f32_16x16x32_bf16 v[76:79], v[188:191], a[156:159], v[76:79]
ds_read_b64_tr_b16 v[172:173], v3 offset:61440
s_waitcnt lgkmcnt(7)
v_mfma_f32_16x16x32_bf16 v[48:51], v[144:147], a[16:19], v[48:51]
buffer_load_dwordx4 a[204:207], v21, s[12:15], s44 offen offset:3072 sc1
v_mfma_f32_16x16x32_bf16 v[48:51], v[148:151], a[20:23], v[48:51]
ds_read_b64_tr_b16 v[174:175], v3 offset:63488
ds_read_b64_tr_b16 v[176:177], v4 offset:36864
v_mfma_f32_16x16x32_bf16 v[48:51], v[152:155], a[24:27], v[48:51]
buffer_load_dwordx4 v6, s[8:11], s34 offen offset:0  lds
v_mfma_f32_16x16x32_bf16 v[48:51], v[156:159], a[28:31], v[48:51]
ds_read_b64_tr_b16 v[178:179], v4 offset:38912
ds_read_b64_tr_b16 v[180:181], v4 offset:45056
v_mfma_f32_16x16x32_bf16 v[80:83], v[144:147], a[144:147], v[80:83]
buffer_load_dwordx4 a[80:83], v20, s[12:15], s45 offen offset:0 sc1
v_mfma_f32_16x16x32_bf16 v[80:83], v[148:151], a[148:151], v[80:83]
ds_read_b64_tr_b16 v[182:183], v4 offset:47104
ds_read_b64_tr_b16 v[184:185], v4 offset:53248
v_mfma_f32_16x16x32_bf16 v[80:83], v[152:155], a[152:155], v[80:83]
buffer_load_dwordx4 a[84:87], v20, s[12:15], s45 offen offset:1024 sc1
v_mfma_f32_16x16x32_bf16 v[80:83], v[156:159], a[156:159], v[80:83]
ds_read_b64_tr_b16 v[186:187], v4 offset:55296
s_waitcnt lgkmcnt(6)
v_mfma_f32_16x16x32_bf16 v[52:55], v[160:163], a[16:19], v[52:55]
ds_read_b64_tr_b16 v[188:189], v4 offset:61440
ds_read_b64_tr_b16 v[190:191], v4 offset:63488
v_mfma_f32_16x16x32_bf16 v[52:55], v[164:167], a[20:23], v[52:55]
buffer_load_dwordx4 a[88:91], v20, s[12:15], s45 offen offset:2048 sc1
v_mfma_f32_16x16x32_bf16 v[52:55], v[168:171], a[24:27], v[52:55]
buffer_load_dwordx4 v7, s[8:11], s34 offen offset:1024  lds
ds_read_b64_tr_b16 v[144:145], v5 offset:36864
v_mfma_f32_16x16x32_bf16 v[52:55], v[172:175], a[28:31], v[52:55]
ds_read_b64_tr_b16 v[146:147], v5 offset:38912
ds_read_b64_tr_b16 v[148:149], v5 offset:45056
v_mfma_f32_16x16x32_bf16 v[84:87], v[160:163], a[144:147], v[84:87]
buffer_load_dwordx4 a[92:95], v20, s[12:15], s45 offen offset:3072 sc1
v_mfma_f32_16x16x32_bf16 v[84:87], v[164:167], a[148:151], v[84:87]
ds_read_b64_tr_b16 v[150:151], v5 offset:47104
ds_read_b64_tr_b16 v[152:153], v5 offset:53248
v_mfma_f32_16x16x32_bf16 v[84:87], v[168:171], a[152:155], v[84:87]
buffer_load_dwordx4 a[208:211], v21, s[12:15], s45 offen offset:0 sc1
v_mfma_f32_16x16x32_bf16 v[84:87], v[172:175], a[156:159], v[84:87]
ds_read_b64_tr_b16 v[154:155], v5 offset:55296
s_waitcnt lgkmcnt(6)
s_waitcnt vmcnt(27)
s_barrier
v_mfma_f32_16x16x32_bf16 v[56:59], v[176:179], a[16:19], v[56:59]
ds_read_b64_tr_b16 v[156:157], v5 offset:61440
ds_read_b64_tr_b16 v[158:159], v5 offset:63488
v_mfma_f32_16x16x32_bf16 v[56:59], v[180:183], a[20:23], v[56:59]
buffer_load_dwordx4 a[212:215], v21, s[12:15], s45 offen offset:1024 sc1
v_mfma_f32_16x16x32_bf16 v[56:59], v[184:187], a[24:27], v[56:59]
buffer_load_dwordx4 v8, s[8:11], s34 offen offset:2048  lds
ds_read_b64_tr_b16 v[160:161], v10 offset:0
v_mfma_f32_16x16x32_bf16 v[56:59], v[188:191], a[28:31], v[56:59]
ds_read_b64_tr_b16 v[162:163], v10 offset:2048
ds_read_b64_tr_b16 v[164:165], v10 offset:8192
v_mfma_f32_16x16x32_bf16 v[88:91], v[176:179], a[144:147], v[88:91]
buffer_load_dwordx4 a[216:219], v21, s[12:15], s45 offen offset:2048 sc1
v_mfma_f32_16x16x32_bf16 v[88:91], v[180:183], a[148:151], v[88:91]
ds_read_b64_tr_b16 v[166:167], v10 offset:10240
ds_read_b64_tr_b16 v[168:169], v10 offset:16384
v_mfma_f32_16x16x32_bf16 v[88:91], v[184:187], a[152:155], v[88:91]
buffer_load_dwordx4 a[220:223], v21, s[12:15], s45 offen offset:3072 sc1
v_mfma_f32_16x16x32_bf16 v[88:91], v[188:191], a[156:159], v[88:91]
ds_read_b64_tr_b16 v[170:171], v10 offset:18432
s_waitcnt lgkmcnt(6)
v_mfma_f32_16x16x32_bf16 v[60:63], v[144:147], a[16:19], v[60:63]
ds_read_b64_tr_b16 v[172:173], v10 offset:24576
s_waitcnt lgkmcnt(0)
s_and_b32 s92, s92, s93
s_and_b32 s92, s92, s94
s_and_b32 s92, s92, s95
s_cbranch_scc1 mlp_kernel_q4_ok
s_mov_b32 s27, 0x40000
mlp_kernel_q4:
s_sleep 4
s_buffer_load_dword s92, s[12:15], s88 offset:262144 glc
s_buffer_load_dword s93, s[12:15], s88 offset:266240 glc
s_buffer_load_dword s94, s[12:15], s88 offset:270336 glc
s_buffer_load_dword s95, s[12:15], s88 offset:274432 glc
s_waitcnt lgkmcnt(0)
s_sub_u32 s27, s27, 1
s_cbranch_scc1 mlp_kernel_q4_ok
s_and_b32 s92, s92, s93
s_and_b32 s92, s92, s94
s_and_b32 s92, s92, s95
s_cbranch_scc0 mlp_kernel_q4
mlp_kernel_q4_ok:
v_mfma_f32_16x16x32_bf16 v[60:63], v[148:151], a[20:23], v[60:63]
ds_read_b64_tr_b16 v[174:175], v10 offset:26624
ds_read_b64_tr_b16 v[176:177], v11 offset:0
v_mfma_f32_16x16x32_bf16 v[60:63], v[152:155], a[24:27], v[60:63]
buffer_load_dwordx4 v18, s[8:11], s34 offen offset:3072  lds
v_mfma_f32_16x16x32_bf16 v[60:63], v[156:159], a[28:31], v[60:63]
ds_read_b64_tr_b16 v[178:179], v11 offset:2048
ds_read_b64_tr_b16 v[180:181], v11 offset:8192
v_mfma_f32_16x16x32_bf16 v[92:95], v[144:147], a[144:147], v[92:95]
buffer_load_dwordx4 a[96:99], v20, s[12:15], s46 offen offset:0 sc1
v_mfma_f32_16x16x32_bf16 v[92:95], v[148:151], a[148:151], v[92:95]
ds_read_b64_tr_b16 v[182:183], v11 offset:10240
s_add_u32 m0, s32, 0
v_mfma_f32_16x16x32_bf16 v[92:95], v[152:155], a[152:155], v[92:95]
ds_read_b64_tr_b16 v[184:185], v11 offset:16384
ds_read_b64_tr_b16 v[186:187], v11 offset:18432
v_mfma_f32_16x16x32_bf16 v[92:95], v[156:159], a[156:159], v[92:95]
ds_read_b64_tr_b16 v[188:189], v11 offset:24576
s_waitcnt lgkmcnt(7)
v_mfma_f32_16x16x32_bf16 v[32:35], v[160:163], a[32:35], v[32:35]
buffer_load_dwordx4 a[100:103], v20, s[12:15], s46 offen offset:1024 sc1
v_mfma_f32_16x16x32_bf16 v[32:35], v[164:167], a[36:39], v[32:35]
ds_read_b64_tr_b16 v[190:191], v11 offset:26624
ds_read_b64_tr_b16 v[144:145], v12 offset:0
v_mfma_f32_16x16x32_bf16 v[32:35], v[168:171], a[40:43], v[32:35]
buffer_load_dwordx4 v6, s[8:11], s53 offen offset:0  lds
v_mfma_f32_16x16x32_bf16 v[32:35], v[172:175], a[44:47], v[32:35]
ds_read_b64_tr_b16 v[146:147], v12 offset:2048
ds_read_b64_tr_b16 v[148:149], v12 offset:8192
v_mfma_f32_16x16x32_bf16 v[64:67], v[160:163], a[160:163], v[64:67]
buffer_load_dwordx4 a[104:107], v20, s[12:15], s46 offen offset:2048 sc1
v_mfma_f32_16x16x32_bf16 v[64:67], v[164:167], a[164:167], v[64:67]
ds_read_b64_tr_b16 v[150:151], v12 offset:10240
ds_read_b64_tr_b16 v[152:153], v12 offset:16384
v_mfma_f32_16x16x32_bf16 v[64:67], v[168:171], a[168:171], v[64:67]
buffer_load_dwordx4 a[108:111], v20, s[12:15], s46 offen offset:3072 sc1
v_mfma_f32_16x16x32_bf16 v[64:67], v[172:175], a[172:175], v[64:67]
ds_read_b64_tr_b16 v[154:155], v12 offset:18432
s_waitcnt lgkmcnt(6)
v_mfma_f32_16x16x32_bf16 v[36:39], v[176:179], a[32:35], v[36:39]
ds_read_b64_tr_b16 v[156:157], v12 offset:24576
ds_read_b64_tr_b16 v[158:159], v12 offset:26624
v_mfma_f32_16x16x32_bf16 v[36:39], v[180:183], a[36:39], v[36:39]
buffer_load_dwordx4 v7, s[8:11], s53 offen offset:1024  lds
v_mfma_f32_16x16x32_bf16 v[36:39], v[184:187], a[40:43], v[36:39]
ds_read_b64_tr_b16 v[160:161], v13 offset:0
ds_read_b64_tr_b16 v[162:163], v13 offset:2048
v_mfma_f32_16x16x32_bf16 v[36:39], v[188:191], a[44:47], v[36:39]
buffer_load_dwordx4 a[224:227], v21, s[12:15], s46 offen offset:0 sc1
v_mfma_f32_16x16x32_bf16 v[68:71], v[176:179], a[160:163], v[68:71]
ds_read_b64_tr_b16 v[164:165], v13 offset:8192
ds_read_b64_tr_b16 v[166:167], v13 offset:10240
v_mfma_f32_16x16x32_bf16 v[68:71], v[180:183], a[164:167], v[68:71]
buffer_load_dwordx4 v8, s[8:11], s53 offen offset:2048  lds
v_mfma_f32_16x16x32_bf16 v[68:71], v[184:187], a[168:171], v[68:71]
ds_read_b64_tr_b16 v[168:169], v13 offset:16384
ds_read_b64_tr_b16 v[170:171], v13 offset:18432
v_mfma_f32_16x16x32_bf16 v[68:71], v[188:191], a[172:175], v[68:71]
ds_read_b64_tr_b16 v[172:173], v13 offset:24576
s_waitcnt lgkmcnt(7)
v_mfma_f32_16x16x32_bf16 v[40:43], v[144:147], a[32:35], v[40:43]
buffer_load_dwordx4 a[228:231], v21, s[12:15], s46 offen offset:1024 sc1
v_mfma_f32_16x16x32_bf16 v[40:43], v[148:151], a[36:39], v[40:43]
ds_read_b64_tr_b16 v[174:175], v13 offset:26624
ds_read_b64_tr_b16 v[176:177], v10 offset:4096
v_mfma_f32_16x16x32_bf16 v[40:43], v[152:155], a[40:43], v[40:43]
ds_read_b64_tr_b16 v[178:179], v10 offset:6144
ds_read_b64_tr_b16 v[180:181], v10 offset:12288
v_mfma_f32_16x16x32_bf16 v[40:43], v[156:159], a[44:47], v[40:43]
ds_read_b64_tr_b16 v[182:183], v10 offset:14336
ds_read_b64_tr_b16 v[184:185], v10 offset:20480
v_mfma_f32_16x16x32_bf16 v[72:75], v[144:147], a[160:163], v[72:75]
buffer_load_dwordx4 a[232:235], v21, s[12:15], s46 offen offset:2048 sc1
v_mfma_f32_16x16x32_bf16 v[72:75], v[148:151], a[164:167], v[72:75]
buffer_load_dwordx4 v18, s[8:11], s53 offen offset:3072  lds
v_mfma_f32_16x16x32_bf16 v[72:75], v[152:155], a[168:171], v[72:75]
ds_read_b64_tr_b16 v[186:187], v10 offset:22528
ds_read_b64_tr_b16 v[188:189], v10 offset:28672
v_mfma_f32_16x16x32_bf16 v[72:75], v[156:159], a[172:175], v[72:75]
ds_read_b64_tr_b16 v[190:191], v10 offset:30720
s_waitcnt lgkmcnt(8)
v_mfma_f32_16x16x32_bf16 v[44:47], v[160:163], a[32:35], v[44:47]
ds_read_b64_tr_b16 v[144:145], v11 offset:4096
ds_read_b64_tr_b16 v[146:147], v11 offset:6144
v_mfma_f32_16x16x32_bf16 v[44:47], v[164:167], a[36:39], v[44:47]
buffer_load_dwordx4 a[236:239], v21, s[12:15], s46 offen offset:3072 sc1
v_mfma_f32_16x16x32_bf16 v[44:47], v[168:171], a[40:43], v[44:47]
ds_read_b64_tr_b16 v[148:149], v11 offset:12288
ds_read_b64_tr_b16 v[150:151], v11 offset:14336
v_mfma_f32_16x16x32_bf16 v[44:47], v[172:175], a[44:47], v[44:47]
ds_read_b64_tr_b16 v[152:153], v11 offset:20480
v_mfma_f32_16x16x32_bf16 v[76:79], v[160:163], a[160:163], v[76:79]
s_add_u32 m0, s32, 16384
s_add_u32 s34, s53, 458752
v_mfma_f32_16x16x32_bf16 v[76:79], v[164:167], a[164:167], v[76:79]
buffer_load_dwordx4 v6, s[8:11], s34 offen offset:0  lds
v_mfma_f32_16x16x32_bf16 v[76:79], v[168:171], a[168:171], v[76:79]
ds_read_b64_tr_b16 v[154:155], v11 offset:22528
ds_read_b64_tr_b16 v[156:157], v11 offset:28672
v_mfma_f32_16x16x32_bf16 v[76:79], v[172:175], a[172:175], v[76:79]
ds_read_b64_tr_b16 v[158:159], v11 offset:30720
s_waitcnt lgkmcnt(8)
v_mfma_f32_16x16x32_bf16 v[48:51], v[176:179], a[32:35], v[48:51]
ds_read_b64_tr_b16 v[160:161], v12 offset:4096
ds_read_b64_tr_b16 v[162:163], v12 offset:6144
v_mfma_f32_16x16x32_bf16 v[48:51], v[180:183], a[36:39], v[48:51]
ds_read_b64_tr_b16 v[164:165], v12 offset:12288
v_mfma_f32_16x16x32_bf16 v[48:51], v[184:187], a[40:43], v[48:51]
ds_read_b64_tr_b16 v[166:167], v12 offset:14336
v_mfma_f32_16x16x32_bf16 v[48:51], v[188:191], a[44:47], v[48:51]
ds_read_b64_tr_b16 v[168:169], v12 offset:20480
v_mfma_f32_16x16x32_bf16 v[80:83], v[176:179], a[160:163], v[80:83]
buffer_load_dwordx4 v7, s[8:11], s34 offen offset:1024  lds
v_mfma_f32_16x16x32_bf16 v[80:83], v[180:183], a[164:167], v[80:83]
ds_read_b64_tr_b16 v[170:171], v12 offset:22528
ds_read_b64_tr_b16 v[172:173], v12 offset:28672
v_mfma_f32_16x16x32_bf16 v[80:83], v[184:187], a[168:171], v[80:83]
ds_read_b64_tr_b16 v[174:175], v12 offset:30720
v_mfma_f32_16x16x32_bf16 v[80:83], v[188:191], a[172:175], v[80:83]
s_waitcnt lgkmcnt(8)
v_mfma_f32_16x16x32_bf16 v[52:55], v[144:147], a[32:35], v[52:55]
ds_read_b64_tr_b16 v[176:177], v13 offset:4096
ds_read_b64_tr_b16 v[178:179], v13 offset:6144
v_mfma_f32_16x16x32_bf16 v[52:55], v[148:151], a[36:39], v[52:55]
ds_read_b64_tr_b16 v[180:181], v13 offset:12288
v_mfma_f32_16x16x32_bf16 v[52:55], v[152:155], a[40:43], v[52:55]
ds_read_b64_tr_b16 v[182:183], v13 offset:14336
v_mfma_f32_16x16x32_bf16 v[52:55], v[156:159], a[44:47], v[52:55]
ds_read_b64_tr_b16 v[184:185], v13 offset:20480
v_mfma_f32_16x16x32_bf16 v[84:87], v[144:147], a[160:163], v[84:87]
buffer_load_dwordx4 v8, s[8:11], s34 offen offset:2048  lds
v_mfma_f32_16x16x32_bf16 v[84:87], v[148:151], a[164:167], v[84:87]
ds_read_b64_tr_b16 v[186:187], v13 offset:22528
ds_read_b64_tr_b16 v[188:189], v13 offset:28672
v_mfma_f32_16x16x32_bf16 v[84:87], v[152:155], a[168:171], v[84:87]
ds_read_b64_tr_b16 v[190:191], v13 offset:30720
v_mfma_f32_16x16x32_bf16 v[84:87], v[156:159], a[172:175], v[84:87]
s_waitcnt lgkmcnt(8)
s_waitcnt vmcnt(37)
s_barrier
v_mfma_f32_16x16x32_bf16 v[56:59], v[160:163], a[32:35], v[56:59]
ds_read_b64_tr_b16 v[144:145], v10 offset:32768
ds_read_b64_tr_b16 v[146:147], v10 offset:34816
v_mfma_f32_16x16x32_bf16 v[56:59], v[164:167], a[36:39], v[56:59]
ds_read_b64_tr_b16 v[148:149], v10 offset:40960
v_mfma_f32_16x16x32_bf16 v[56:59], v[168:171], a[40:43], v[56:59]
ds_read_b64_tr_b16 v[150:151], v10 offset:43008
v_mfma_f32_16x16x32_bf16 v[56:59], v[172:175], a[44:47], v[56:59]
ds_read_b64_tr_b16 v[152:153], v10 offset:49152
v_mfma_f32_16x16x32_bf16 v[88:91], v[160:163], a[160:163], v[88:91]
buffer_load_dwordx4 v18, s[8:11], s34 offen offset:3072  lds
v_mfma_f32_16x16x32_bf16 v[88:91], v[164:167], a[164:167], v[88:91]
ds_read_b64_tr_b16 v[154:155], v10 offset:51200
ds_read_b64_tr_b16 v[156:157], v10 offset:57344
v_mfma_f32_16x16x32_bf16 v[88:91], v[168:171], a[168:171], v[88:91]
buffer_load_dwordx4 a[112:115], v20, s[12:15], s47 offen offset:0 sc1
v_mfma_f32_16x16x32_bf16 v[88:91], v[172:175], a[172:175], v[88:91]
ds_read_b64_tr_b16 v[158:159], v10 offset:59392
s_waitcnt lgkmcnt(8)
v_mfma_f32_16x16x32_bf16 v[60:63], v[176:179], a[32:35], v[60:63]
ds_read_b64_tr_b16 v[160:161], v11 offset:32768
ds_read_b64_tr_b16 v[162:163], v11 offset:34816
v_mfma_f32_16x16x32_bf16 v[60:63], v[180:183], a[36:39], v[60:63]
ds_read_b64_tr_b16 v[164:165], v11 offset:40960
v_mfma_f32_16x16x32_bf16 v[60:63], v[184:187], a[40:43], v[60:63]
ds_read_b64_tr_b16 v[166:167], v11 offset:43008
v_mfma_f32_16x16x32_bf16 v[60:63], v[188:191], a[44:47], v[60:63]
buffer_load_dwordx4 a[116:119], v20, s[12:15], s47 offen offset:1024 sc1
v_mfma_f32_16x16x32_bf16 v[92:95], v[176:179], a[160:163], v[92:95]
s_add_u32 m0, s32, 32768
ds_read_b64_tr_b16 v[168:169], v11 offset:49152
v_mfma_f32_16x16x32_bf16 v[92:95], v[180:183], a[164:167], v[92:95]
buffer_load_dwordx4 v6, s[8:11], s54 offen offset:0  lds
v_mfma_f32_16x16x32_bf16 v[92:95], v[184:187], a[168:171], v[92:95]
ds_read_b64_tr_b16 v[170:171], v11 offset:51200
ds_read_b64_tr_b16 v[172:173], v11 offset:57344
v_mfma_f32_16x16x32_bf16 v[92:95], v[188:191], a[172:175], v[92:95]
ds_read_b64_tr_b16 v[174:175], v11 offset:59392
s_waitcnt lgkmcnt(8)
v_mfma_f32_16x16x32_bf16 v[32:35], v[144:147], a[48:51], v[32:35]
buffer_load_dwordx4 a[120:123], v20, s[12:15], s47 offen offset:2048 sc1
v_mfma_f32_16x16x32_bf16 v[32:35], v[148:151], a[52:55], v[32:35]
ds_read_b64_tr_b16 v[176:177], v12 offset:32768
ds_read_b64_tr_b16 v[178:179], v12 offset:34816
v_mfma_f32_16x16x32_bf16 v[32:35], v[152:155], a[56:59], v[32:35]
ds_read_b64_tr_b16 v[180:181], v12 offset:40960
ds_read_b64_tr_b16 v[182:183], v12 offset:43008
v_mfma_f32_16x16x32_bf16 v[32:35], v[156:159], a[60:63], v[32:35]
ds_read_b64_tr_b16 v[184:185], v12 offset:49152
v_mfma_f32_16x16x32_bf16 v[64:67], v[144:147], a[176:179], v[64:67]
buffer_load_dwordx4 v7, s[8:11], s54 offen offset:1024  lds
v_mfma_f32_16x16x32_bf16 v[64:67], v[148:151], a[180:183], v[64:67]
buffer_load_dwordx4 a[124:127], v20, s[12:15], s47 offen offset:3072 sc1
v_mfma_f32_16x16x32_bf16 v[64:67], v[152:155], a[184:187], v[64:67]
ds_read_b64_tr_b16 v[186:187], v12 offset:51200
ds_read_b64_tr_b16 v[188:189], v12 offset:57344
v_mfma_f32_16x16x32_bf16 v[64:67], v[156:159], a[188:191], v[64:67]
ds_read_b64_tr_b16 v[190:191], v12 offset:59392
s_waitcnt lgkmcnt(8)
v_mfma_f32_16x16x32_bf16 v[36:39], v[160:163], a[48:51], v[36:39]
ds_read_b64_tr_b16 v[144:145], v13 offset:32768
ds_read_b64_tr_b16 v[146:147], v13 offset:34816
v_mfma_f32_16x16x32_bf16 v[36:39], v[164:167], a[52:55], v[36:39]
ds_read_b64_tr_b16 v[148:149], v13 offset:40960
v_mfma_f32_16x16x32_bf16 v[36:39], v[168:171], a[56:59], v[36:39]
buffer_load_dwordx4 a[240:243], v21, s[12:15], s47 offen offset:0 sc1
v_mfma_f32_16x16x32_bf16 v[36:39], v[172:175], a[60:63], v[36:39]
ds_read_b64_tr_b16 v[150:151], v13 offset:43008
ds_read_b64_tr_b16 v[152:153], v13 offset:49152
v_mfma_f32_16x16x32_bf16 v[68:71], v[160:163], a[176:179], v[68:71]
buffer_load_dwordx4 v8, s[8:11], s54 offen offset:2048  lds
v_mfma_f32_16x16x32_bf16 v[68:71], v[164:167], a[180:183], v[68:71]
ds_read_b64_tr_b16 v[154:155], v13 offset:51200
ds_read_b64_tr_b16 v[156:157], v13 offset:57344
v_mfma_f32_16x16x32_bf16 v[68:71], v[168:171], a[184:187], v[68:71]
ds_read_b64_tr_b16 v[158:159], v13 offset:59392
v_mfma_f32_16x16x32_bf16 v[68:71], v[172:175], a[188:191], v[68:71]
s_waitcnt lgkmcnt(8)
v_mfma_f32_16x16x32_bf16 v[40:43], v[176:179], a[48:51], v[40:43]
buffer_load_dwordx4 a[244:247], v21, s[12:15], s47 offen offset:1024 sc1
v_mfma_f32_16x16x32_bf16 v[40:43], v[180:183], a[52:55], v[40:43]
ds_read_b64_tr_b16 v[160:161], v10 offset:36864
ds_read_b64_tr_b16 v[162:163], v10 offset:38912
v_mfma_f32_16x16x32_bf16 v[40:43], v[184:187], a[56:59], v[40:43]
ds_read_b64_tr_b16 v[164:165], v10 offset:45056
ds_read_b64_tr_b16 v[166:167], v10 offset:47104
v_mfma_f32_16x16x32_bf16 v[40:43], v[188:191], a[60:63], v[40:43]
ds_read_b64_tr_b16 v[168:169], v10 offset:53248
v_mfma_f32_16x16x32_bf16 v[72:75], v[176:179], a[176:179], v[72:75]
buffer_load_dwordx4 a[248:251], v21, s[12:15], s47 offen offset:2048 sc1
v_mfma_f32_16x16x32_bf16 v[72:75], v[180:183], a[180:183], v[72:75]
buffer_load_dwordx4 v18, s[8:11], s54 offen offset:3072  lds
v_mfma_f32_16x16x32_bf16 v[72:75], v[184:187], a[184:187], v[72:75]
ds_read_b64_tr_b16 v[170:171], v10 offset:55296
ds_read_b64_tr_b16 v[172:173], v10 offset:61440
v_mfma_f32_16x16x32_bf16 v[72:75], v[188:191], a[188:191], v[72:75]
ds_read_b64_tr_b16 v[174:175], v10 offset:63488
s_waitcnt lgkmcnt(8)
v_mfma_f32_16x16x32_bf16 v[44:47], v[144:147], a[48:51], v[44:47]
ds_read_b64_tr_b16 v[176:177], v11 offset:36864
ds_read_b64_tr_b16 v[178:179], v11 offset:38912
v_mfma_f32_16x16x32_bf16 v[44:47], v[148:151], a[52:55], v[44:47]
buffer_load_dwordx4 a[252:255], v21, s[12:15], s47 offen offset:3072 sc1
v_mfma_f32_16x16x32_bf16 v[44:47], v[152:155], a[56:59], v[44:47]
ds_read_b64_tr_b16 v[180:181], v11 offset:45056
ds_read_b64_tr_b16 v[182:183], v11 offset:47104
v_mfma_f32_16x16x32_bf16 v[44:47], v[156:159], a[60:63], v[44:47]
ds_read_b64_tr_b16 v[184:185], v11 offset:53248
v_mfma_f32_16x16x32_bf16 v[76:79], v[144:147], a[176:179], v[76:79]
s_add_u32 m0, s32, 49152
s_add_u32 s34, s54, 458752
v_mfma_f32_16x16x32_bf16 v[76:79], v[148:151], a[180:183], v[76:79]
buffer_load_dwordx4 v6, s[8:11], s34 offen offset:0  lds
v_mfma_f32_16x16x32_bf16 v[76:79], v[152:155], a[184:187], v[76:79]
ds_read_b64_tr_b16 v[186:187], v11 offset:55296
ds_read_b64_tr_b16 v[188:189], v11 offset:61440
v_mfma_f32_16x16x32_bf16 v[76:79], v[156:159], a[188:191], v[76:79]
ds_read_b64_tr_b16 v[190:191], v11 offset:63488
s_waitcnt lgkmcnt(8)
v_mfma_f32_16x16x32_bf16 v[48:51], v[160:163], a[48:51], v[48:51]
ds_read_b64_tr_b16 v[144:145], v12 offset:36864
ds_read_b64_tr_b16 v[146:147], v12 offset:38912
v_mfma_f32_16x16x32_bf16 v[48:51], v[164:167], a[52:55], v[48:51]
v_readfirstlane_b32 s40, v9
v_readlane_b32 s41, v23, 0
v_mfma_f32_16x16x32_bf16 v[48:51], v[168:171], a[56:59], v[48:51]
v_readlane_b32 s42, v23, 32
v_readfirstlane_b32 s43, v210
v_mfma_f32_16x16x32_bf16 v[48:51], v[172:175], a[60:63], v[48:51]
ds_read_b64_tr_b16 v[148:149], v12 offset:45056
ds_read_b64_tr_b16 v[150:151], v12 offset:47104
v_mfma_f32_16x16x32_bf16 v[80:83], v[160:163], a[176:179], v[80:83]
buffer_load_dwordx4 v7, s[8:11], s34 offen offset:1024  lds
v_mfma_f32_16x16x32_bf16 v[80:83], v[164:167], a[180:183], v[80:83]
ds_read_b64_tr_b16 v[152:153], v12 offset:53248
ds_read_b64_tr_b16 v[154:155], v12 offset:55296
v_mfma_f32_16x16x32_bf16 v[80:83], v[168:171], a[184:187], v[80:83]
ds_read_b64_tr_b16 v[156:157], v12 offset:61440
ds_read_b64_tr_b16 v[158:159], v12 offset:63488
v_mfma_f32_16x16x32_bf16 v[80:83], v[172:175], a[188:191], v[80:83]
s_waitcnt lgkmcnt(8)
v_mfma_f32_16x16x32_bf16 v[52:55], v[176:179], a[48:51], v[52:55]
ds_read_b64_tr_b16 v[160:161], v13 offset:36864
ds_read_b64_tr_b16 v[162:163], v13 offset:38912
v_mfma_f32_16x16x32_bf16 v[52:55], v[180:183], a[52:55], v[52:55]
ds_read_b64_tr_b16 v[164:165], v13 offset:45056
v_mfma_f32_16x16x32_bf16 v[52:55], v[184:187], a[56:59], v[52:55]
ds_read_b64_tr_b16 v[166:167], v13 offset:47104
v_mfma_f32_16x16x32_bf16 v[52:55], v[188:191], a[60:63], v[52:55]
ds_read_b64_tr_b16 v[168:169], v13 offset:53248
v_mfma_f32_16x16x32_bf16 v[84:87], v[176:179], a[176:179], v[84:87]
buffer_load_dwordx4 v8, s[8:11], s34 offen offset:2048  lds
v_mfma_f32_16x16x32_bf16 v[84:87], v[180:183], a[180:183], v[84:87]
ds_read_b64_tr_b16 v[170:171], v13 offset:55296
ds_read_b64_tr_b16 v[172:173], v13 offset:61440
v_mfma_f32_16x16x32_bf16 v[84:87], v[184:187], a[184:187], v[84:87]
ds_read_b64_tr_b16 v[174:175], v13 offset:63488
v_mfma_f32_16x16x32_bf16 v[84:87], v[188:191], a[188:191], v[84:87]
s_waitcnt lgkmcnt(8)
s_waitcnt vmcnt(31)
s_barrier
v_mfma_f32_16x16x32_bf16 v[56:59], v[144:147], a[48:51], v[56:59]
ds_read_b64_tr_b16 v[176:177], v14 offset:0
ds_read_b64_tr_b16 v[178:179], v14 offset:2048
v_mfma_f32_16x16x32_bf16 v[56:59], v[148:151], a[52:55], v[56:59]
ds_read_b64_tr_b16 v[180:181], v14 offset:8192
v_mfma_f32_16x16x32_bf16 v[56:59], v[152:155], a[56:59], v[56:59]
ds_read_b64_tr_b16 v[182:183], v14 offset:10240
v_mfma_f32_16x16x32_bf16 v[56:59], v[156:159], a[60:63], v[56:59]
ds_read_b64_tr_b16 v[184:185], v14 offset:16384
v_mfma_f32_16x16x32_bf16 v[88:91], v[144:147], a[176:179], v[88:91]
buffer_load_dwordx4 v18, s[8:11], s34 offen offset:3072  lds
v_mfma_f32_16x16x32_bf16 v[88:91], v[148:151], a[180:183], v[88:91]
ds_read_b64_tr_b16 v[186:187], v14 offset:18432
ds_read_b64_tr_b16 v[188:189], v14 offset:24576
v_mfma_f32_16x16x32_bf16 v[88:91], v[152:155], a[184:187], v[88:91]
ds_read_b64_tr_b16 v[190:191], v14 offset:26624
v_mfma_f32_16x16x32_bf16 v[88:91], v[156:159], a[188:191], v[88:91]
s_waitcnt lgkmcnt(8)
v_mfma_f32_16x16x32_bf16 v[60:63], v[160:163], a[48:51], v[60:63]
ds_read_b64_tr_b16 v[144:145], v15 offset:0
ds_read_b64_tr_b16 v[146:147], v15 offset:2048
v_mfma_f32_16x16x32_bf16 v[60:63], v[164:167], a[52:55], v[60:63]
ds_read_b64_tr_b16 v[148:149], v15 offset:8192
v_mfma_f32_16x16x32_bf16 v[60:63], v[168:171], a[56:59], v[60:63]
ds_read_b64_tr_b16 v[150:151], v15 offset:10240
v_mfma_f32_16x16x32_bf16 v[60:63], v[172:175], a[60:63], v[60:63]
ds_read_b64_tr_b16 v[152:153], v15 offset:16384
v_mfma_f32_16x16x32_bf16 v[92:95], v[160:163], a[176:179], v[92:95]
s_add_u32 m0, s32, 65536
ds_read_b64_tr_b16 v[154:155], v15 offset:18432
v_mfma_f32_16x16x32_bf16 v[92:95], v[164:167], a[180:183], v[92:95]
buffer_load_dwordx4 v6, s[8:11], s55 offen offset:0  lds
v_mfma_f32_16x16x32_bf16 v[92:95], v[168:171], a[184:187], v[92:95]
ds_read_b64_tr_b16 v[156:157], v15 offset:24576
ds_read_b64_tr_b16 v[158:159], v15 offset:26624
v_mfma_f32_16x16x32_bf16 v[92:95], v[172:175], a[188:191], v[92:95]
s_waitcnt lgkmcnt(8)
v_mfma_f32_16x16x32_bf16 v[32:35], v[176:179], a[64:67], v[32:35]
ds_read_b64_tr_b16 v[160:161], v16 offset:0
ds_read_b64_tr_b16 v[162:163], v16 offset:2048
v_mfma_f32_16x16x32_bf16 v[32:35], v[180:183], a[68:71], v[32:35]
ds_read_b64_tr_b16 v[164:165], v16 offset:8192
v_mfma_f32_16x16x32_bf16 v[32:35], v[184:187], a[72:75], v[32:35]
ds_read_b64_tr_b16 v[166:167], v16 offset:10240
v_mfma_f32_16x16x32_bf16 v[32:35], v[188:191], a[76:79], v[32:35]
ds_read_b64_tr_b16 v[168:169], v16 offset:16384
v_mfma_f32_16x16x32_bf16 v[64:67], v[176:179], a[192:195], v[64:67]
buffer_load_dwordx4 v7, s[8:11], s55 offen offset:1024  lds
v_mfma_f32_16x16x32_bf16 v[64:67], v[180:183], a[196:199], v[64:67]
ds_read_b64_tr_b16 v[170:171], v16 offset:18432
ds_read_b64_tr_b16 v[172:173], v16 offset:24576
v_mfma_f32_16x16x32_bf16 v[64:67], v[184:187], a[200:203], v[64:67]
ds_read_b64_tr_b16 v[174:175], v16 offset:26624
v_mfma_f32_16x16x32_bf16 v[64:67], v[188:191], a[204:207], v[64:67]
s_waitcnt lgkmcnt(8)
v_mfma_f32_16x16x32_bf16 v[36:39], v[144:147], a[64:67], v[36:39]
ds_read_b64_tr_b16 v[176:177], v17 offset:0
ds_read_b64_tr_b16 v[178:179], v17 offset:2048
v_mfma_f32_16x16x32_bf16 v[36:39], v[148:151], a[68:71], v[36:39]
ds_read_b64_tr_b16 v[180:181], v17 offset:8192
v_mfma_f32_16x16x32_bf16 v[36:39], v[152:155], a[72:75], v[36:39]
ds_read_b64_tr_b16 v[182:183], v17 offset:10240
v_mfma_f32_16x16x32_bf16 v[36:39], v[156:159], a[76:79], v[36:39]
ds_read_b64_tr_b16 v[184:185], v17 offset:16384
v_mfma_f32_16x16x32_bf16 v[68:71], v[144:147], a[192:195], v[68:71]
buffer_load_dwordx4 v8, s[8:11], s55 offen offset:2048  lds
v_mfma_f32_16x16x32_bf16 v[68:71], v[148:151], a[196:199], v[68:71]
ds_read_b64_tr_b16 v[186:187], v17 offset:18432
ds_read_b64_tr_b16 v[188:189], v17 offset:24576
v_mfma_f32_16x16x32_bf16 v[68:71], v[152:155], a[200:203], v[68:71]
ds_read_b64_tr_b16 v[190:191], v17 offset:26624
v_mfma_f32_16x16x32_bf16 v[68:71], v[156:159], a[204:207], v[68:71]
s_waitcnt lgkmcnt(8)
v_mfma_f32_16x16x32_bf16 v[40:43], v[160:163], a[64:67], v[40:43]
ds_read_b64_tr_b16 v[144:145], v14 offset:4096
ds_read_b64_tr_b16 v[146:147], v14 offset:6144
v_mfma_f32_16x16x32_bf16 v[40:43], v[164:167], a[68:71], v[40:43]
ds_read_b64_tr_b16 v[148:149], v14 offset:12288
v_mfma_f32_16x16x32_bf16 v[40:43], v[168:171], a[72:75], v[40:43]
ds_read_b64_tr_b16 v[150:151], v14 offset:14336
v_mfma_f32_16x16x32_bf16 v[40:43], v[172:175], a[76:79], v[40:43]
ds_read_b64_tr_b16 v[152:153], v14 offset:20480
v_mfma_f32_16x16x32_bf16 v[72:75], v[160:163], a[192:195], v[72:75]
buffer_load_dwordx4 v18, s[8:11], s55 offen offset:3072  lds
v_mfma_f32_16x16x32_bf16 v[72:75], v[164:167], a[196:199], v[72:75]
ds_read_b64_tr_b16 v[154:155], v14 offset:22528
ds_read_b64_tr_b16 v[156:157], v14 offset:28672
v_mfma_f32_16x16x32_bf16 v[72:75], v[168:171], a[200:203], v[72:75]
ds_read_b64_tr_b16 v[158:159], v14 offset:30720
v_mfma_f32_16x16x32_bf16 v[72:75], v[172:175], a[204:207], v[72:75]
s_waitcnt lgkmcnt(8)
v_mfma_f32_16x16x32_bf16 v[44:47], v[176:179], a[64:67], v[44:47]
ds_read_b64_tr_b16 v[160:161], v15 offset:4096
ds_read_b64_tr_b16 v[162:163], v15 offset:6144
v_mfma_f32_16x16x32_bf16 v[44:47], v[180:183], a[68:71], v[44:47]
ds_read_b64_tr_b16 v[164:165], v15 offset:12288
v_mfma_f32_16x16x32_bf16 v[44:47], v[184:187], a[72:75], v[44:47]
ds_read_b64_tr_b16 v[166:167], v15 offset:14336
v_mfma_f32_16x16x32_bf16 v[44:47], v[188:191], a[76:79], v[44:47]
ds_read_b64_tr_b16 v[168:169], v15 offset:20480
v_mfma_f32_16x16x32_bf16 v[76:79], v[176:179], a[192:195], v[76:79]
s_add_u32 m0, s32, 81920
s_add_u32 s34, s55, 458752
v_mfma_f32_16x16x32_bf16 v[76:79], v[180:183], a[196:199], v[76:79]
buffer_load_dwordx4 v6, s[8:11], s34 offen offset:0  lds
v_mfma_f32_16x16x32_bf16 v[76:79], v[184:187], a[200:203], v[76:79]
ds_read_b64_tr_b16 v[170:171], v15 offset:22528
ds_read_b64_tr_b16 v[172:173], v15 offset:28672
v_mfma_f32_16x16x32_bf16 v[76:79], v[188:191], a[204:207], v[76:79]
ds_read_b64_tr_b16 v[174:175], v15 offset:30720
s_waitcnt lgkmcnt(8)
v_mfma_f32_16x16x32_bf16 v[48:51], v[144:147], a[64:67], v[48:51]
ds_read_b64_tr_b16 v[176:177], v16 offset:4096
ds_read_b64_tr_b16 v[178:179], v16 offset:6144
v_mfma_f32_16x16x32_bf16 v[48:51], v[148:151], a[68:71], v[48:51]
ds_read_b64_tr_b16 v[180:181], v16 offset:12288
v_mfma_f32_16x16x32_bf16 v[48:51], v[152:155], a[72:75], v[48:51]
ds_read_b64_tr_b16 v[182:183], v16 offset:14336
v_mfma_f32_16x16x32_bf16 v[48:51], v[156:159], a[76:79], v[48:51]
ds_read_b64_tr_b16 v[184:185], v16 offset:20480
v_mfma_f32_16x16x32_bf16 v[80:83], v[144:147], a[192:195], v[80:83]
buffer_load_dwordx4 v7, s[8:11], s34 offen offset:1024  lds
v_mfma_f32_16x16x32_bf16 v[80:83], v[148:151], a[196:199], v[80:83]
ds_read_b64_tr_b16 v[186:187], v16 offset:22528
ds_read_b64_tr_b16 v[188:189], v16 offset:28672
v_mfma_f32_16x16x32_bf16 v[80:83], v[152:155], a[200:203], v[80:83]
ds_read_b64_tr_b16 v[190:191], v16 offset:30720
v_mfma_f32_16x16x32_bf16 v[80:83], v[156:159], a[204:207], v[80:83]
s_waitcnt lgkmcnt(8)
v_mfma_f32_16x16x32_bf16 v[52:55], v[160:163], a[64:67], v[52:55]
ds_read_b64_tr_b16 v[144:145], v17 offset:4096
ds_read_b64_tr_b16 v[146:147], v17 offset:6144
v_mfma_f32_16x16x32_bf16 v[52:55], v[164:167], a[68:71], v[52:55]
ds_read_b64_tr_b16 v[148:149], v17 offset:12288
v_mfma_f32_16x16x32_bf16 v[52:55], v[168:171], a[72:75], v[52:55]
ds_read_b64_tr_b16 v[150:151], v17 offset:14336
v_mfma_f32_16x16x32_bf16 v[52:55], v[172:175], a[76:79], v[52:55]
ds_read_b64_tr_b16 v[152:153], v17 offset:20480
v_mfma_f32_16x16x32_bf16 v[84:87], v[160:163], a[192:195], v[84:87]
buffer_load_dwordx4 v8, s[8:11], s34 offen offset:2048  lds
v_mfma_f32_16x16x32_bf16 v[84:87], v[164:167], a[196:199], v[84:87]
ds_read_b64_tr_b16 v[154:155], v17 offset:22528
ds_read_b64_tr_b16 v[156:157], v17 offset:28672
v_mfma_f32_16x16x32_bf16 v[84:87], v[168:171], a[200:203], v[84:87]
ds_read_b64_tr_b16 v[158:159], v17 offset:30720
v_mfma_f32_16x16x32_bf16 v[84:87], v[172:175], a[204:207], v[84:87]
s_waitcnt lgkmcnt(8)
s_waitcnt vmcnt(23)
s_barrier
v_mfma_f32_16x16x32_bf16 v[56:59], v[176:179], a[64:67], v[56:59]
ds_read_b64_tr_b16 v[160:161], v2 offset:0
ds_read_b64_tr_b16 v[162:163], v2 offset:2048
v_mfma_f32_16x16x32_bf16 v[56:59], v[180:183], a[68:71], v[56:59]
ds_read_b64_tr_b16 v[164:165], v2 offset:8192
v_mfma_f32_16x16x32_bf16 v[56:59], v[184:187], a[72:75], v[56:59]
ds_read_b64_tr_b16 v[166:167], v2 offset:10240
v_mfma_f32_16x16x32_bf16 v[56:59], v[188:191], a[76:79], v[56:59]
ds_read_b64_tr_b16 v[168:169], v2 offset:16384
v_mfma_f32_16x16x32_bf16 v[88:91], v[176:179], a[192:195], v[88:91]
buffer_load_dwordx4 v18, s[8:11], s34 offen offset:3072  lds
v_mfma_f32_16x16x32_bf16 v[88:91], v[180:183], a[196:199], v[88:91]
ds_read_b64_tr_b16 v[170:171], v2 offset:18432
ds_read_b64_tr_b16 v[172:173], v2 offset:24576
v_mfma_f32_16x16x32_bf16 v[88:91], v[184:187], a[200:203], v[88:91]
ds_read_b64_tr_b16 v[174:175], v2 offset:26624
v_mfma_f32_16x16x32_bf16 v[88:91], v[188:191], a[204:207], v[88:91]
s_waitcnt lgkmcnt(8)
v_mfma_f32_16x16x32_bf16 v[60:63], v[144:147], a[64:67], v[60:63]
ds_read_b64_tr_b16 v[176:177], v3 offset:0
ds_read_b64_tr_b16 v[178:179], v3 offset:2048
v_mfma_f32_16x16x32_bf16 v[60:63], v[148:151], a[68:71], v[60:63]
ds_read_b64_tr_b16 v[180:181], v3 offset:8192
v_mfma_f32_16x16x32_bf16 v[60:63], v[152:155], a[72:75], v[60:63]
ds_read_b64_tr_b16 v[182:183], v3 offset:10240
v_mfma_f32_16x16x32_bf16 v[60:63], v[156:159], a[76:79], v[60:63]
ds_read_b64_tr_b16 v[184:185], v3 offset:16384
v_mfma_f32_16x16x32_bf16 v[92:95], v[144:147], a[192:195], v[92:95]
s_add_u32 s48, s48, s35
s_add_u32 s49, s49, s35
v_mfma_f32_16x16x32_bf16 v[92:95], v[148:151], a[196:199], v[92:95]
s_add_u32 s50, s50, s35
s_add_u32 s51, s51, s35
v_mfma_f32_16x16x32_bf16 v[92:95], v[152:155], a[200:203], v[92:95]
s_add_u32 s52, s52, s35
s_add_u32 s53, s53, s35
v_mfma_f32_16x16x32_bf16 v[92:95], v[156:159], a[204:207], v[92:95]
ds_read_b64_tr_b16 v[186:187], v3 offset:18432
s_waitcnt lgkmcnt(6)
v_mfma_f32_16x16x32_bf16 v[32:35], v[160:163], a[80:83], v[32:35]
ds_read_b64_tr_b16 v[188:189], v3 offset:24576
s_add_u32 s54, s54, s35
v_mfma_f32_16x16x32_bf16 v[32:35], v[164:167], a[84:87], v[32:35]
ds_read_b64_tr_b16 v[190:191], v3 offset:26624
s_add_u32 s55, s55, s35
v_mfma_f32_16x16x32_bf16 v[32:35], v[168:171], a[88:91], v[32:35]
s_add_u32 m0, s32, 98304
s_nop 0
buffer_load_dwordx4 v6, s[8:11], s48 offen offset:0  lds
ds_read_b64_tr_b16 v[144:145], v4 offset:0
v_mfma_f32_16x16x32_bf16 v[32:35], v[172:175], a[92:95], v[32:35]
ds_read_b64_tr_b16 v[146:147], v4 offset:2048
ds_read_b64_tr_b16 v[148:149], v4 offset:8192
v_mfma_f32_16x16x32_bf16 v[64:67], v[160:163], a[208:211], v[64:67]
buffer_load_dwordx4 v7, s[8:11], s48 offen offset:1024  lds
v_mfma_f32_16x16x32_bf16 v[64:67], v[164:167], a[212:215], v[64:67]
ds_read_b64_tr_b16 v[150:151], v4 offset:10240
ds_read_b64_tr_b16 v[152:153], v4 offset:16384
v_mfma_f32_16x16x32_bf16 v[64:67], v[168:171], a[216:219], v[64:67]
ds_read_b64_tr_b16 v[154:155], v4 offset:18432
ds_read_b64_tr_b16 v[156:157], v4 offset:24576
v_mfma_f32_16x16x32_bf16 v[64:67], v[172:175], a[220:223], v[64:67]
ds_read_b64_tr_b16 v[158:159], v4 offset:26624
s_waitcnt lgkmcnt(8)
v_mfma_f32_16x16x32_bf16 v[36:39], v[176:179], a[80:83], v[36:39]
ds_read_b64_tr_b16 v[160:161], v5 offset:0
ds_read_b64_tr_b16 v[162:163], v5 offset:2048
v_mfma_f32_16x16x32_bf16 v[36:39], v[180:183], a[84:87], v[36:39]
ds_read_b64_tr_b16 v[164:165], v5 offset:8192
v_mfma_f32_16x16x32_bf16 v[36:39], v[184:187], a[88:91], v[36:39]
ds_read_b64_tr_b16 v[166:167], v5 offset:10240
v_mfma_f32_16x16x32_bf16 v[36:39], v[188:191], a[92:95], v[36:39]
ds_read_b64_tr_b16 v[168:169], v5 offset:16384
v_mfma_f32_16x16x32_bf16 v[68:71], v[176:179], a[208:211], v[68:71]
buffer_load_dwordx4 v8, s[8:11], s48 offen offset:2048  lds
v_mfma_f32_16x16x32_bf16 v[68:71], v[180:183], a[212:215], v[68:71]
ds_read_b64_tr_b16 v[170:171], v5 offset:18432
ds_read_b64_tr_b16 v[172:173], v5 offset:24576
v_mfma_f32_16x16x32_bf16 v[68:71], v[184:187], a[216:219], v[68:71]
ds_read_b64_tr_b16 v[174:175], v5 offset:26624
v_mfma_f32_16x16x32_bf16 v[68:71], v[188:191], a[220:223], v[68:71]
s_waitcnt lgkmcnt(8)
v_mfma_f32_16x16x32_bf16 v[40:43], v[144:147], a[80:83], v[40:43]
ds_read_b64_tr_b16 v[176:177], v2 offset:4096
ds_read_b64_tr_b16 v[178:179], v2 offset:6144
v_mfma_f32_16x16x32_bf16 v[40:43], v[148:151], a[84:87], v[40:43]
ds_read_b64_tr_b16 v[180:181], v2 offset:12288
v_mfma_f32_16x16x32_bf16 v[40:43], v[152:155], a[88:91], v[40:43]
ds_read_b64_tr_b16 v[182:183], v2 offset:14336
v_mfma_f32_16x16x32_bf16 v[40:43], v[156:159], a[92:95], v[40:43]
ds_read_b64_tr_b16 v[184:185], v2 offset:20480
v_mfma_f32_16x16x32_bf16 v[72:75], v[144:147], a[208:211], v[72:75]
buffer_load_dwordx4 v18, s[8:11], s48 offen offset:3072  lds
v_mfma_f32_16x16x32_bf16 v[72:75], v[148:151], a[212:215], v[72:75]
ds_read_b64_tr_b16 v[186:187], v2 offset:22528
ds_read_b64_tr_b16 v[188:189], v2 offset:28672
v_mfma_f32_16x16x32_bf16 v[72:75], v[152:155], a[216:219], v[72:75]
ds_read_b64_tr_b16 v[190:191], v2 offset:30720
v_mfma_f32_16x16x32_bf16 v[72:75], v[156:159], a[220:223], v[72:75]
s_waitcnt lgkmcnt(8)
v_mfma_f32_16x16x32_bf16 v[44:47], v[160:163], a[80:83], v[44:47]
ds_read_b64_tr_b16 v[144:145], v3 offset:4096
ds_read_b64_tr_b16 v[146:147], v3 offset:6144
v_mfma_f32_16x16x32_bf16 v[44:47], v[164:167], a[84:87], v[44:47]
ds_read_b64_tr_b16 v[148:149], v3 offset:12288
v_mfma_f32_16x16x32_bf16 v[44:47], v[168:171], a[88:91], v[44:47]
ds_read_b64_tr_b16 v[150:151], v3 offset:14336
v_mfma_f32_16x16x32_bf16 v[44:47], v[172:175], a[92:95], v[44:47]
ds_read_b64_tr_b16 v[152:153], v3 offset:20480
v_mfma_f32_16x16x32_bf16 v[76:79], v[160:163], a[208:211], v[76:79]
s_add_u32 m0, s32, 114688
ds_read_b64_tr_b16 v[154:155], v3 offset:22528
v_mfma_f32_16x16x32_bf16 v[76:79], v[164:167], a[212:215], v[76:79]
buffer_load_dwordx4 v6, s[8:11], s49 offen offset:0  lds
v_mfma_f32_16x16x32_bf16 v[76:79], v[168:171], a[216:219], v[76:79]
ds_read_b64_tr_b16 v[156:157], v3 offset:28672
ds_read_b64_tr_b16 v[158:159], v3 offset:30720
v_mfma_f32_16x16x32_bf16 v[76:79], v[172:175], a[220:223], v[76:79]
s_waitcnt lgkmcnt(8)
v_mfma_f32_16x16x32_bf16 v[48:51], v[176:179], a[80:83], v[48:51]
ds_read_b64_tr_b16 v[160:161], v4 offset:4096
ds_read_b64_tr_b16 v[162:163], v4 offset:6144
v_mfma_f32_16x16x32_bf16 v[48:51], v[180:183], a[84:87], v[48:51]
ds_read_b64_tr_b16 v[164:165], v4 offset:12288
v_mfma_f32_16x16x32_bf16 v[48:51], v[184:187], a[88:91], v[48:51]
ds_read_b64_tr_b16 v[166:167], v4 offset:14336
v_mfma_f32_16x16x32_bf16 v[48:51], v[188:191], a[92:95], v[48:51]
ds_read_b64_tr_b16 v[168:169], v4 offset:20480
v_mfma_f32_16x16x32_bf16 v[80:83], v[176:179], a[208:211], v[80:83]
buffer_load_dwordx4 v7, s[8:11], s49 offen offset:1024  lds
v_mfma_f32_16x16x32_bf16 v[80:83], v[180:183], a[212:215], v[80:83]
ds_read_b64_tr_b16 v[170:171], v4 offset:22528
ds_read_b64_tr_b16 v[172:173], v4 offset:28672
v_mfma_f32_16x16x32_bf16 v[80:83], v[184:187], a[216:219], v[80:83]
ds_read_b64_tr_b16 v[174:175], v4 offset:30720
v_mfma_f32_16x16x32_bf16 v[80:83], v[188:191], a[220:223], v[80:83]
s_waitcnt lgkmcnt(8)
v_mfma_f32_16x16x32_bf16 v[52:55], v[144:147], a[80:83], v[52:55]
ds_read_b64_tr_b16 v[176:177], v5 offset:4096
ds_read_b64_tr_b16 v[178:179], v5 offset:6144
v_mfma_f32_16x16x32_bf16 v[52:55], v[148:151], a[84:87], v[52:55]
ds_read_b64_tr_b16 v[180:181], v5 offset:12288
v_mfma_f32_16x16x32_bf16 v[52:55], v[152:155], a[88:91], v[52:55]
ds_read_b64_tr_b16 v[182:183], v5 offset:14336
v_mfma_f32_16x16x32_bf16 v[52:55], v[156:159], a[92:95], v[52:55]
ds_read_b64_tr_b16 v[184:185], v5 offset:20480
v_mfma_f32_16x16x32_bf16 v[84:87], v[144:147], a[208:211], v[84:87]
buffer_load_dwordx4 v8, s[8:11], s49 offen offset:2048  lds
v_mfma_f32_16x16x32_bf16 v[84:87], v[148:151], a[212:215], v[84:87]
ds_read_b64_tr_b16 v[186:187], v5 offset:22528
ds_read_b64_tr_b16 v[188:189], v5 offset:28672
v_mfma_f32_16x16x32_bf16 v[84:87], v[152:155], a[216:219], v[84:87]
ds_read_b64_tr_b16 v[190:191], v5 offset:30720
v_mfma_f32_16x16x32_bf16 v[84:87], v[156:159], a[220:223], v[84:87]
s_waitcnt lgkmcnt(8)
s_waitcnt vmcnt(15)
s_barrier
v_mfma_f32_16x16x32_bf16 v[56:59], v[160:163], a[80:83], v[56:59]
ds_read_b64_tr_b16 v[144:145], v2 offset:32768
ds_read_b64_tr_b16 v[146:147], v2 offset:34816
v_mfma_f32_16x16x32_bf16 v[56:59], v[164:167], a[84:87], v[56:59]
ds_read_b64_tr_b16 v[148:149], v2 offset:40960
v_mfma_f32_16x16x32_bf16 v[56:59], v[168:171], a[88:91], v[56:59]
ds_read_b64_tr_b16 v[150:151], v2 offset:43008
v_mfma_f32_16x16x32_bf16 v[56:59], v[172:175], a[92:95], v[56:59]
ds_read_b64_tr_b16 v[152:153], v2 offset:49152
v_mfma_f32_16x16x32_bf16 v[88:91], v[160:163], a[208:211], v[88:91]
buffer_load_dwordx4 v18, s[8:11], s49 offen offset:3072  lds
v_mfma_f32_16x16x32_bf16 v[88:91], v[164:167], a[212:215], v[88:91]
ds_read_b64_tr_b16 v[154:155], v2 offset:51200
ds_read_b64_tr_b16 v[156:157], v2 offset:57344
v_mfma_f32_16x16x32_bf16 v[88:91], v[168:171], a[216:219], v[88:91]
ds_read_b64_tr_b16 v[158:159], v2 offset:59392
v_mfma_f32_16x16x32_bf16 v[88:91], v[172:175], a[220:223], v[88:91]
s_waitcnt lgkmcnt(8)
v_mfma_f32_16x16x32_bf16 v[60:63], v[176:179], a[80:83], v[60:63]
ds_read_b64_tr_b16 v[160:161], v3 offset:32768
ds_read_b64_tr_b16 v[162:163], v3 offset:34816
v_mfma_f32_16x16x32_bf16 v[60:63], v[180:183], a[84:87], v[60:63]
ds_read_b64_tr_b16 v[164:165], v3 offset:40960
v_mfma_f32_16x16x32_bf16 v[60:63], v[184:187], a[88:91], v[60:63]
ds_read_b64_tr_b16 v[166:167], v3 offset:43008
v_mfma_f32_16x16x32_bf16 v[60:63], v[188:191], a[92:95], v[60:63]
ds_read_b64_tr_b16 v[168:169], v3 offset:49152
v_mfma_f32_16x16x32_bf16 v[92:95], v[176:179], a[208:211], v[92:95]
s_add_u32 m0, s32, 131072
ds_read_b64_tr_b16 v[170:171], v3 offset:51200
v_mfma_f32_16x16x32_bf16 v[92:95], v[180:183], a[212:215], v[92:95]
buffer_load_dwordx4 v6, s[8:11], s50 offen offset:0  lds
v_mfma_f32_16x16x32_bf16 v[92:95], v[184:187], a[216:219], v[92:95]
ds_read_b64_tr_b16 v[172:173], v3 offset:57344
ds_read_b64_tr_b16 v[174:175], v3 offset:59392
v_mfma_f32_16x16x32_bf16 v[92:95], v[188:191], a[220:223], v[92:95]
s_waitcnt lgkmcnt(8)
v_mfma_f32_16x16x32_bf16 v[32:35], v[144:147], a[96:99], v[32:35]
ds_read_b64_tr_b16 v[176:177], v4 offset:32768
ds_read_b64_tr_b16 v[178:179], v4 offset:34816
v_mfma_f32_16x16x32_bf16 v[32:35], v[148:151], a[100:103], v[32:35]
ds_read_b64_tr_b16 v[180:181], v4 offset:40960
v_mfma_f32_16x16x32_bf16 v[32:35], v[152:155], a[104:107], v[32:35]
ds_read_b64_tr_b16 v[182:183], v4 offset:43008
v_mfma_f32_16x16x32_bf16 v[32:35], v[156:159], a[108:111], v[32:35]
ds_read_b64_tr_b16 v[184:185], v4 offset:49152
v_mfma_f32_16x16x32_bf16 v[64:67], v[144:147], a[224:227], v[64:67]
buffer_load_dwordx4 v7, s[8:11], s50 offen offset:1024  lds
v_mfma_f32_16x16x32_bf16 v[64:67], v[148:151], a[228:231], v[64:67]
ds_read_b64_tr_b16 v[186:187], v4 offset:51200
ds_read_b64_tr_b16 v[188:189], v4 offset:57344
v_mfma_f32_16x16x32_bf16 v[64:67], v[152:155], a[232:235], v[64:67]
ds_read_b64_tr_b16 v[190:191], v4 offset:59392
v_mfma_f32_16x16x32_bf16 v[64:67], v[156:159], a[236:239], v[64:67]
s_waitcnt lgkmcnt(8)
v_mfma_f32_16x16x32_bf16 v[36:39], v[160:163], a[96:99], v[36:39]
ds_read_b64_tr_b16 v[144:145], v5 offset:32768
ds_read_b64_tr_b16 v[146:147], v5 offset:34816
v_mfma_f32_16x16x32_bf16 v[36:39], v[164:167], a[100:103], v[36:39]
ds_read_b64_tr_b16 v[148:149], v5 offset:40960
v_mfma_f32_16x16x32_bf16 v[36:39], v[168:171], a[104:107], v[36:39]
ds_read_b64_tr_b16 v[150:151], v5 offset:43008
v_mfma_f32_16x16x32_bf16 v[36:39], v[172:175], a[108:111], v[36:39]
ds_read_b64_tr_b16 v[152:153], v5 offset:49152
v_mfma_f32_16x16x32_bf16 v[68:71], v[160:163], a[224:227], v[68:71]
buffer_load_dwordx4 v8, s[8:11], s50 offen offset:2048  lds
v_mfma_f32_16x16x32_bf16 v[68:71], v[164:167], a[228:231], v[68:71]
ds_read_b64_tr_b16 v[154:155], v5 offset:51200
ds_read_b64_tr_b16 v[156:157], v5 offset:57344
v_mfma_f32_16x16x32_bf16 v[68:71], v[168:171], a[232:235], v[68:71]
ds_read_b64_tr_b16 v[158:159], v5 offset:59392
v_mfma_f32_16x16x32_bf16 v[68:71], v[172:175], a[236:239], v[68:71]
s_waitcnt lgkmcnt(8)
v_mfma_f32_16x16x32_bf16 v[40:43], v[176:179], a[96:99], v[40:43]
ds_read_b64_tr_b16 v[160:161], v2 offset:36864
ds_read_b64_tr_b16 v[162:163], v2 offset:38912
v_mfma_f32_16x16x32_bf16 v[40:43], v[180:183], a[100:103], v[40:43]
ds_read_b64_tr_b16 v[164:165], v2 offset:45056
v_mfma_f32_16x16x32_bf16 v[40:43], v[184:187], a[104:107], v[40:43]
ds_read_b64_tr_b16 v[166:167], v2 offset:47104
v_mfma_f32_16x16x32_bf16 v[40:43], v[188:191], a[108:111], v[40:43]
ds_read_b64_tr_b16 v[168:169], v2 offset:53248
v_mfma_f32_16x16x32_bf16 v[72:75], v[176:179], a[224:227], v[72:75]
buffer_load_dwordx4 v18, s[8:11], s50 offen offset:3072  lds
v_mfma_f32_16x16x32_bf16 v[72:75], v[180:183], a[228:231], v[72:75]
ds_read_b64_tr_b16 v[170:171], v2 offset:55296
ds_read_b64_tr_b16 v[172:173], v2 offset:61440
v_mfma_f32_16x16x32_bf16 v[72:75], v[184:187], a[232:235], v[72:75]
ds_read_b64_tr_b16 v[174:175], v2 offset:63488
v_mfma_f32_16x16x32_bf16 v[72:75], v[188:191], a[236:239], v[72:75]
s_waitcnt lgkmcnt(8)
v_mfma_f32_16x16x32_bf16 v[44:47], v[144:147], a[96:99], v[44:47]
ds_read_b64_tr_b16 v[176:177], v3 offset:36864
ds_read_b64_tr_b16 v[178:179], v3 offset:38912
v_mfma_f32_16x16x32_bf16 v[44:47], v[148:151], a[100:103], v[44:47]
ds_read_b64_tr_b16 v[180:181], v3 offset:45056
v_mfma_f32_16x16x32_bf16 v[44:47], v[152:155], a[104:107], v[44:47]
ds_read_b64_tr_b16 v[182:183], v3 offset:47104
v_mfma_f32_16x16x32_bf16 v[44:47], v[156:159], a[108:111], v[44:47]
ds_read_b64_tr_b16 v[184:185], v3 offset:53248
v_mfma_f32_16x16x32_bf16 v[76:79], v[144:147], a[224:227], v[76:79]
s_add_u32 m0, s32, 147456
ds_read_b64_tr_b16 v[186:187], v3 offset:55296
v_mfma_f32_16x16x32_bf16 v[76:79], v[148:151], a[228:231], v[76:79]
buffer_load_dwordx4 v6, s[8:11], s51 offen offset:0  lds
v_mfma_f32_16x16x32_bf16 v[76:79], v[152:155], a[232:235], v[76:79]
ds_read_b64_tr_b16 v[188:189], v3 offset:61440
ds_read_b64_tr_b16 v[190:191], v3 offset:63488
v_mfma_f32_16x16x32_bf16 v[76:79], v[156:159], a[236:239], v[76:79]
s_waitcnt lgkmcnt(8)
v_mfma_f32_16x16x32_bf16 v[48:51], v[160:163], a[96:99], v[48:51]
ds_read_b64_tr_b16 v[144:145], v4 offset:36864
ds_read_b64_tr_b16 v[146:147], v4 offset:38912
v_mfma_f32_16x16x32_bf16 v[48:51], v[164:167], a[100:103], v[48:51]
ds_read_b64_tr_b16 v[148:149], v4 offset:45056
v_mfma_f32_16x16x32_bf16 v[48:51], v[168:171], a[104:107], v[48:51]
ds_read_b64_tr_b16 v[150:151], v4 offset:47104
v_mfma_f32_16x16x32_bf16 v[48:51], v[172:175], a[108:111], v[48:51]
ds_read_b64_tr_b16 v[152:153], v4 offset:53248
v_mfma_f32_16x16x32_bf16 v[80:83], v[160:163], a[224:227], v[80:83]
buffer_load_dwordx4 v7, s[8:11], s51 offen offset:1024  lds
v_mfma_f32_16x16x32_bf16 v[80:83], v[164:167], a[228:231], v[80:83]
ds_read_b64_tr_b16 v[154:155], v4 offset:55296
ds_read_b64_tr_b16 v[156:157], v4 offset:61440
v_mfma_f32_16x16x32_bf16 v[80:83], v[168:171], a[232:235], v[80:83]
ds_read_b64_tr_b16 v[158:159], v4 offset:63488
v_mfma_f32_16x16x32_bf16 v[80:83], v[172:175], a[236:239], v[80:83]
s_waitcnt lgkmcnt(8)
v_mfma_f32_16x16x32_bf16 v[52:55], v[176:179], a[96:99], v[52:55]
ds_read_b64_tr_b16 v[160:161], v5 offset:36864
ds_read_b64_tr_b16 v[162:163], v5 offset:38912
v_mfma_f32_16x16x32_bf16 v[52:55], v[180:183], a[100:103], v[52:55]
ds_read_b64_tr_b16 v[164:165], v5 offset:45056
v_mfma_f32_16x16x32_bf16 v[52:55], v[184:187], a[104:107], v[52:55]
ds_read_b64_tr_b16 v[166:167], v5 offset:47104
v_mfma_f32_16x16x32_bf16 v[52:55], v[188:191], a[108:111], v[52:55]
ds_read_b64_tr_b16 v[168:169], v5 offset:53248
v_mfma_f32_16x16x32_bf16 v[84:87], v[176:179], a[224:227], v[84:87]
buffer_load_dwordx4 v8, s[8:11], s51 offen offset:2048  lds
v_mfma_f32_16x16x32_bf16 v[84:87], v[180:183], a[228:231], v[84:87]
ds_read_b64_tr_b16 v[170:171], v5 offset:55296
ds_read_b64_tr_b16 v[172:173], v5 offset:61440
v_mfma_f32_16x16x32_bf16 v[84:87], v[184:187], a[232:235], v[84:87]
ds_read_b64_tr_b16 v[174:175], v5 offset:63488
v_mfma_f32_16x16x32_bf16 v[84:87], v[188:191], a[236:239], v[84:87]
s_waitcnt lgkmcnt(8)
s_waitcnt vmcnt(15)
s_barrier
v_mfma_f32_16x16x32_bf16 v[56:59], v[144:147], a[96:99], v[56:59]
ds_read_b64_tr_b16 v[176:177], v10 offset:0
ds_read_b64_tr_b16 v[178:179], v10 offset:2048
v_mfma_f32_16x16x32_bf16 v[56:59], v[148:151], a[100:103], v[56:59]
ds_read_b64_tr_b16 v[180:181], v10 offset:8192
v_mfma_f32_16x16x32_bf16 v[56:59], v[152:155], a[104:107], v[56:59]
ds_read_b64_tr_b16 v[182:183], v10 offset:10240
v_mfma_f32_16x16x32_bf16 v[56:59], v[156:159], a[108:111], v[56:59]
ds_read_b64_tr_b16 v[184:185], v10 offset:16384
v_mfma_f32_16x16x32_bf16 v[88:91], v[144:147], a[224:227], v[88:91]
buffer_load_dwordx4 v18, s[8:11], s51 offen offset:3072  lds
v_mfma_f32_16x16x32_bf16 v[88:91], v[148:151], a[228:231], v[88:91]
ds_read_b64_tr_b16 v[186:187], v10 offset:18432
ds_read_b64_tr_b16 v[188:189], v10 offset:24576
v_mfma_f32_16x16x32_bf16 v[88:91], v[152:155], a[232:235], v[88:91]
ds_read_b64_tr_b16 v[190:191], v10 offset:26624
v_mfma_f32_16x16x32_bf16 v[88:91], v[156:159], a[236:239], v[88:91]
s_waitcnt lgkmcnt(8)
v_mfma_f32_16x16x32_bf16 v[60:63], v[160:163], a[96:99], v[60:63]
ds_read_b64_tr_b16 v[144:145], v11 offset:0
ds_read_b64_tr_b16 v[146:147], v11 offset:2048
v_mfma_f32_16x16x32_bf16 v[60:63], v[164:167], a[100:103], v[60:63]
ds_read_b64_tr_b16 v[148:149], v11 offset:8192
v_mfma_f32_16x16x32_bf16 v[60:63], v[168:171], a[104:107], v[60:63]
ds_read_b64_tr_b16 v[150:151], v11 offset:10240
v_mfma_f32_16x16x32_bf16 v[60:63], v[172:175], a[108:111], v[60:63]
ds_read_b64_tr_b16 v[152:153], v11 offset:16384
v_mfma_f32_16x16x32_bf16 v[92:95], v[160:163], a[224:227], v[92:95]
s_add_u32 m0, s32, 0
ds_read_b64_tr_b16 v[154:155], v11 offset:18432
v_mfma_f32_16x16x32_bf16 v[92:95], v[164:167], a[228:231], v[92:95]
buffer_load_dwordx4 v6, s[8:11], s52 offen offset:0  lds
v_mfma_f32_16x16x32_bf16 v[92:95], v[168:171], a[232:235], v[92:95]
ds_read_b64_tr_b16 v[156:157], v11 offset:24576
ds_read_b64_tr_b16 v[158:159], v11 offset:26624
v_mfma_f32_16x16x32_bf16 v[92:95], v[172:175], a[236:239], v[92:95]
s_waitcnt lgkmcnt(8)
v_mfma_f32_16x16x32_bf16 v[32:35], v[176:179], a[112:115], v[32:35]
ds_read_b64_tr_b16 v[160:161], v12 offset:0
ds_read_b64_tr_b16 v[162:163], v12 offset:2048
v_mfma_f32_16x16x32_bf16 v[32:35], v[180:183], a[116:119], v[32:35]
ds_read_b64_tr_b16 v[164:165], v12 offset:8192
v_mfma_f32_16x16x32_bf16 v[32:35], v[184:187], a[120:123], v[32:35]
ds_read_b64_tr_b16 v[166:167], v12 offset:10240
v_mfma_f32_16x16x32_bf16 v[32:35], v[188:191], a[124:127], v[32:35]
ds_read_b64_tr_b16 v[168:169], v12 offset:16384
v_mfma_f32_16x16x32_bf16 v[64:67], v[176:179], a[240:243], v[64:67]
buffer_load_dwordx4 v7, s[8:11], s52 offen offset:1024  lds
v_mfma_f32_16x16x32_bf16 v[64:67], v[180:183], a[244:247], v[64:67]
ds_read_b64_tr_b16 v[170:171], v12 offset:18432
ds_read_b64_tr_b16 v[172:173], v12 offset:24576
v_mfma_f32_16x16x32_bf16 v[64:67], v[184:187], a[248:251], v[64:67]
ds_read_b64_tr_b16 v[174:175], v12 offset:26624
v_mfma_f32_16x16x32_bf16 v[64:67], v[188:191], a[252:255], v[64:67]
s_waitcnt lgkmcnt(8)
v_mfma_f32_16x16x32_bf16 v[36:39], v[144:147], a[112:115], v[36:39]
ds_read_b64_tr_b16 v[176:177], v13 offset:0
ds_read_b64_tr_b16 v[178:179], v13 offset:2048
v_mfma_f32_16x16x32_bf16 v[36:39], v[148:151], a[116:119], v[36:39]
ds_read_b64_tr_b16 v[180:181], v13 offset:8192
v_mfma_f32_16x16x32_bf16 v[36:39], v[152:155], a[120:123], v[36:39]
ds_read_b64_tr_b16 v[182:183], v13 offset:10240
v_mfma_f32_16x16x32_bf16 v[36:39], v[156:159], a[124:127], v[36:39]
ds_read_b64_tr_b16 v[184:185], v13 offset:16384
v_mfma_f32_16x16x32_bf16 v[68:71], v[144:147], a[240:243], v[68:71]
buffer_load_dwordx4 v8, s[8:11], s52 offen offset:2048  lds
v_mfma_f32_16x16x32_bf16 v[68:71], v[148:151], a[244:247], v[68:71]
ds_read_b64_tr_b16 v[186:187], v13 offset:18432
ds_read_b64_tr_b16 v[188:189], v13 offset:24576
v_mfma_f32_16x16x32_bf16 v[68:71], v[152:155], a[248:251], v[68:71]
ds_read_b64_tr_b16 v[190:191], v13 offset:26624
v_mfma_f32_16x16x32_bf16 v[68:71], v[156:159], a[252:255], v[68:71]
s_waitcnt lgkmcnt(8)
v_mfma_f32_16x16x32_bf16 v[40:43], v[160:163], a[112:115], v[40:43]
ds_read_b64_tr_b16 v[144:145], v10 offset:4096
ds_read_b64_tr_b16 v[146:147], v10 offset:6144
v_mfma_f32_16x16x32_bf16 v[40:43], v[164:167], a[116:119], v[40:43]
ds_read_b64_tr_b16 v[148:149], v10 offset:12288
v_mfma_f32_16x16x32_bf16 v[40:43], v[168:171], a[120:123], v[40:43]
ds_read_b64_tr_b16 v[150:151], v10 offset:14336
v_mfma_f32_16x16x32_bf16 v[40:43], v[172:175], a[124:127], v[40:43]
ds_read_b64_tr_b16 v[152:153], v10 offset:20480
v_mfma_f32_16x16x32_bf16 v[72:75], v[160:163], a[240:243], v[72:75]
buffer_load_dwordx4 v18, s[8:11], s52 offen offset:3072  lds
v_mfma_f32_16x16x32_bf16 v[72:75], v[164:167], a[244:247], v[72:75]
ds_read_b64_tr_b16 v[154:155], v10 offset:22528
ds_read_b64_tr_b16 v[156:157], v10 offset:28672
v_mfma_f32_16x16x32_bf16 v[72:75], v[168:171], a[248:251], v[72:75]
ds_read_b64_tr_b16 v[158:159], v10 offset:30720
v_mfma_f32_16x16x32_bf16 v[72:75], v[172:175], a[252:255], v[72:75]
s_waitcnt lgkmcnt(8)
v_mfma_f32_16x16x32_bf16 v[44:47], v[176:179], a[112:115], v[44:47]
ds_read_b64_tr_b16 v[160:161], v11 offset:4096
ds_read_b64_tr_b16 v[162:163], v11 offset:6144
v_mfma_f32_16x16x32_bf16 v[44:47], v[180:183], a[116:119], v[44:47]
ds_read_b64_tr_b16 v[164:165], v11 offset:12288
v_mfma_f32_16x16x32_bf16 v[44:47], v[184:187], a[120:123], v[44:47]
ds_read_b64_tr_b16 v[166:167], v11 offset:14336
v_mfma_f32_16x16x32_bf16 v[44:47], v[188:191], a[124:127], v[44:47]
ds_read_b64_tr_b16 v[168:169], v11 offset:20480
v_mfma_f32_16x16x32_bf16 v[76:79], v[176:179], a[240:243], v[76:79]
s_add_u32 m0, s32, 16384
ds_read_b64_tr_b16 v[170:171], v11 offset:22528
v_mfma_f32_16x16x32_bf16 v[76:79], v[180:183], a[244:247], v[76:79]
buffer_load_dwordx4 v6, s[8:11], s53 offen offset:0  lds
v_mfma_f32_16x16x32_bf16 v[76:79], v[184:187], a[248:251], v[76:79]
ds_read_b64_tr_b16 v[172:173], v11 offset:28672
ds_read_b64_tr_b16 v[174:175], v11 offset:30720
v_mfma_f32_16x16x32_bf16 v[76:79], v[188:191], a[252:255], v[76:79]
s_waitcnt lgkmcnt(8)
v_mfma_f32_16x16x32_bf16 v[48:51], v[144:147], a[112:115], v[48:51]
ds_read_b64_tr_b16 v[176:177], v12 offset:4096
ds_read_b64_tr_b16 v[178:179], v12 offset:6144
v_mfma_f32_16x16x32_bf16 v[48:51], v[148:151], a[116:119], v[48:51]
ds_read_b64_tr_b16 v[180:181], v12 offset:12288
v_mfma_f32_16x16x32_bf16 v[48:51], v[152:155], a[120:123], v[48:51]
ds_read_b64_tr_b16 v[182:183], v12 offset:14336
v_mfma_f32_16x16x32_bf16 v[48:51], v[156:159], a[124:127], v[48:51]
ds_read_b64_tr_b16 v[184:185], v12 offset:20480
v_mfma_f32_16x16x32_bf16 v[80:83], v[144:147], a[240:243], v[80:83]
buffer_load_dwordx4 v7, s[8:11], s53 offen offset:1024  lds
v_mfma_f32_16x16x32_bf16 v[80:83], v[148:151], a[244:247], v[80:83]
ds_read_b64_tr_b16 v[186:187], v12 offset:22528
ds_read_b64_tr_b16 v[188:189], v12 offset:28672
v_mfma_f32_16x16x32_bf16 v[80:83], v[152:155], a[248:251], v[80:83]
ds_read_b64_tr_b16 v[190:191], v12 offset:30720
v_mfma_f32_16x16x32_bf16 v[80:83], v[156:159], a[252:255], v[80:83]
s_waitcnt lgkmcnt(8)
v_mfma_f32_16x16x32_bf16 v[52:55], v[160:163], a[112:115], v[52:55]
ds_read_b64_tr_b16 v[144:145], v13 offset:4096
ds_read_b64_tr_b16 v[146:147], v13 offset:6144
v_mfma_f32_16x16x32_bf16 v[52:55], v[164:167], a[116:119], v[52:55]
ds_read_b64_tr_b16 v[148:149], v13 offset:12288
v_mfma_f32_16x16x32_bf16 v[52:55], v[168:171], a[120:123], v[52:55]
ds_read_b64_tr_b16 v[150:151], v13 offset:14336
v_mfma_f32_16x16x32_bf16 v[52:55], v[172:175], a[124:127], v[52:55]
ds_read_b64_tr_b16 v[152:153], v13 offset:20480
v_mfma_f32_16x16x32_bf16 v[84:87], v[160:163], a[240:243], v[84:87]
buffer_load_dwordx4 v8, s[8:11], s53 offen offset:2048  lds
v_mfma_f32_16x16x32_bf16 v[84:87], v[164:167], a[244:247], v[84:87]
ds_read_b64_tr_b16 v[154:155], v13 offset:22528
ds_read_b64_tr_b16 v[156:157], v13 offset:28672
v_mfma_f32_16x16x32_bf16 v[84:87], v[168:171], a[248:251], v[84:87]
ds_read_b64_tr_b16 v[158:159], v13 offset:30720
v_mfma_f32_16x16x32_bf16 v[84:87], v[172:175], a[252:255], v[84:87]
s_waitcnt lgkmcnt(8)
s_waitcnt vmcnt(15)
s_barrier
v_mfma_f32_16x16x32_bf16 v[56:59], v[176:179], a[112:115], v[56:59]
ds_read_b64_tr_b16 v[160:161], v10 offset:32768
ds_read_b64_tr_b16 v[162:163], v10 offset:34816
v_mfma_f32_16x16x32_bf16 v[56:59], v[180:183], a[116:119], v[56:59]
ds_read_b64_tr_b16 v[164:165], v10 offset:36864
v_mfma_f32_16x16x32_bf16 v[56:59], v[184:187], a[120:123], v[56:59]
ds_read_b64_tr_b16 v[166:167], v10 offset:38912
v_mfma_f32_16x16x32_bf16 v[56:59], v[188:191], a[124:127], v[56:59]
ds_read_b64_tr_b16 v[168:169], v10 offset:40960
v_mfma_f32_16x16x32_bf16 v[88:91], v[176:179], a[240:243], v[88:91]
buffer_load_dwordx4 v18, s[8:11], s53 offen offset:3072  lds
v_mfma_f32_16x16x32_bf16 v[88:91], v[180:183], a[244:247], v[88:91]
ds_read_b64_tr_b16 v[170:171], v10 offset:43008
ds_read_b64_tr_b16 v[172:173], v10 offset:45056
v_mfma_f32_16x16x32_bf16 v[88:91], v[184:187], a[248:251], v[88:91]
ds_read_b64_tr_b16 v[174:175], v10 offset:47104
v_mfma_f32_16x16x32_bf16 v[88:91], v[188:191], a[252:255], v[88:91]
s_waitcnt lgkmcnt(8)
v_mfma_f32_16x16x32_bf16 v[60:63], v[144:147], a[112:115], v[60:63]
ds_read_b64_tr_b16 v[176:177], v11 offset:32768
ds_read_b64_tr_b16 v[178:179], v11 offset:34816
v_mfma_f32_16x16x32_bf16 v[60:63], v[148:151], a[116:119], v[60:63]
ds_read_b64_tr_b16 v[180:181], v11 offset:36864
v_mfma_f32_16x16x32_bf16 v[60:63], v[152:155], a[120:123], v[60:63]
ds_read_b64_tr_b16 v[182:183], v11 offset:38912
v_mfma_f32_16x16x32_bf16 v[60:63], v[156:159], a[124:127], v[60:63]
ds_read_b64_tr_b16 v[184:185], v11 offset:40960
v_mfma_f32_16x16x32_bf16 v[92:95], v[144:147], a[240:243], v[92:95]
s_add_u32 m0, s32, 32768
ds_read_b64_tr_b16 v[186:187], v11 offset:43008
v_mfma_f32_16x16x32_bf16 v[92:95], v[148:151], a[244:247], v[92:95]
buffer_load_dwordx4 v6, s[8:11], s54 offen offset:0  lds
v_mfma_f32_16x16x32_bf16 v[92:95], v[152:155], a[248:251], v[92:95]
ds_read_b64_tr_b16 v[188:189], v11 offset:45056
ds_read_b64_tr_b16 v[190:191], v11 offset:47104
v_mfma_f32_16x16x32_bf16 v[92:95], v[156:159], a[252:255], v[92:95]
s_waitcnt lgkmcnt(8)
v_mfma_f32_16x16x32_bf16 v[96:99], v[160:163], a[0:3], 0
ds_read_b64_tr_b16 v[144:145], v12 offset:32768
ds_read_b64_tr_b16 v[146:147], v12 offset:34816
v_mfma_f32_16x16x32_bf16 v[96:99], v[164:167], a[4:7], v[96:99]
buffer_store_dwordx4 v[216:219], v252, s[12:15], s100 offen offset:0 sc1
v_mfma_f32_16x16x32_bf16 v[96:99], v[168:171], a[8:11], v[96:99]
v_exp_f32 v192, v32
v_mfma_f32_16x16x32_bf16 v[96:99], v[172:175], a[12:15], v[96:99]
v_exp_f32 v193, v33
v_exp_f32 v194, v34
v_mfma_f32_16x16x32_bf16 v[112:115], v[160:163], a[128:131], 0
ds_read_b64_tr_b16 v[148:149], v12 offset:36864
v_exp_f32 v195, v35
v_exp_f32 v196, v36
v_mfma_f32_16x16x32_bf16 v[112:115], v[164:167], a[132:135], v[112:115]
ds_read_b64_tr_b16 v[150:151], v12 offset:38912
v_exp_f32 v197, v37
v_exp_f32 v198, v38
v_mfma_f32_16x16x32_bf16 v[112:115], v[168:171], a[136:139], v[112:115]
ds_read_b64_tr_b16 v[152:153], v12 offset:40960
v_exp_f32 v199, v39
v_add_f32 v192, 1.0, v192
v_mfma_f32_16x16x32_bf16 v[112:115], v[172:175], a[140:143], v[112:115]
ds_read_b64_tr_b16 v[154:155], v12 offset:43008
v_add_f32 v193, 1.0, v193
v_add_f32 v194, 1.0, v194
s_waitcnt lgkmcnt(6)
v_mfma_f32_16x16x32_bf16 v[100:103], v[176:179], a[0:3], 0
ds_read_b64_tr_b16 v[156:157], v12 offset:45056
v_add_f32 v195, 1.0, v195
v_mfma_f32_16x16x32_bf16 v[100:103], v[180:183], a[4:7], v[100:103]
ds_read_b64_tr_b16 v[158:159], v12 offset:47104
v_add_f32 v196, 1.0, v196
v_add_f32 v197, 1.0, v197
v_mfma_f32_16x16x32_bf16 v[100:103], v[184:187], a[8:11], v[100:103]
buffer_load_dwordx4 v7, s[8:11], s54 offen offset:1024  lds
ds_read_b64_tr_b16 v[160:161], v13 offset:32768
v_add_f32 v198, 1.0, v198
v_add_f32 v199, 1.0, v199
v_mfma_f32_16x16x32_bf16 v[100:103], v[188:191], a[12:15], v[100:103]
ds_read_b64_tr_b16 v[162:163], v13 offset:34816
v_rcp_f32 v192, v192
v_rcp_f32 v193, v193
v_mfma_f32_16x16x32_bf16 v[116:119], v[176:179], a[128:131], 0
ds_read_b64_tr_b16 v[164:165], v13 offset:36864
v_rcp_f32 v194, v194
v_rcp_f32 v195, v195
v_mfma_f32_16x16x32_bf16 v[116:119], v[180:183], a[132:135], v[116:119]
buffer_store_dwordx4 v[220:223], v252, s[12:15], s100 offen offset:2048 sc1
ds_read_b64_tr_b16 v[166:167], v13 offset:38912
v_rcp_f32 v196, v196
v_rcp_f32 v197, v197
v_mfma_f32_16x16x32_bf16 v[116:119], v[184:187], a[136:139], v[116:119]
ds_read_b64_tr_b16 v[168:169], v13 offset:40960
v_rcp_f32 v198, v198
v_mfma_f32_16x16x32_bf16 v[116:119], v[188:191], a[140:143], v[116:119]
ds_read_b64_tr_b16 v[170:171], v13 offset:43008
v_rcp_f32 v199, v199
v_mul_f32 v192, v32, v192
s_waitcnt lgkmcnt(6)
v_mfma_f32_16x16x32_bf16 v[104:107], v[144:147], a[0:3], 0
ds_read_b64_tr_b16 v[172:173], v13 offset:45056
v_mul_f32 v193, v33, v193
v_mul_f32 v194, v34, v194
v_mfma_f32_16x16x32_bf16 v[104:107], v[148:151], a[4:7], v[104:107]
ds_read_b64_tr_b16 v[174:175], v13 offset:47104
v_mul_f32 v195, v35, v195
v_mul_f32 v196, v36, v196
v_mfma_f32_16x16x32_bf16 v[104:107], v[152:155], a[8:11], v[104:107]
buffer_load_dwordx4 v8, s[8:11], s54 offen offset:2048  lds
ds_read_b64_tr_b16 v[176:177], v10 offset:49152
v_mul_f32 v197, v37, v197
v_mul_f32 v198, v38, v198
v_mfma_f32_16x16x32_bf16 v[104:107], v[156:159], a[12:15], v[104:107]
ds_read_b64_tr_b16 v[178:179], v10 offset:51200
v_mul_f32 v199, v39, v199
v_cvt_pk_bf16_f32 v32, v192, v193
v_mfma_f32_16x16x32_bf16 v[120:123], v[144:147], a[128:131], 0
ds_read_b64_tr_b16 v[180:181], v10 offset:53248
v_cvt_pk_bf16_f32 v33, v194, v195
v_cvt_pk_bf16_f32 v34, v196, v197
v_mfma_f32_16x16x32_bf16 v[120:123], v[148:151], a[132:135], v[120:123]
ds_read_b64_tr_b16 v[182:183], v10 offset:55296
v_cvt_pk_bf16_f32 v35, v198, v199
v_mfma_f32_16x16x32_bf16 v[120:123], v[152:155], a[136:139], v[120:123]
ds_read_b64_tr_b16 v[184:185], v10 offset:57344
v_exp_f32 v200, v64
v_exp_f32 v201, v65
v_mfma_f32_16x16x32_bf16 v[120:123], v[156:159], a[140:143], v[120:123]
ds_read_b64_tr_b16 v[186:187], v10 offset:59392
v_exp_f32 v202, v66
v_exp_f32 v203, v67
s_waitcnt lgkmcnt(6)
v_mfma_f32_16x16x32_bf16 v[108:111], v[160:163], a[0:3], 0
ds_read_b64_tr_b16 v[188:189], v10 offset:61440
v_exp_f32 v204, v68
v_exp_f32 v205, v69
v_mfma_f32_16x16x32_bf16 v[108:111], v[164:167], a[4:7], v[108:111]
buffer_store_dwordx4 v[224:227], v253, s[12:15], s100 offen offset:0 sc1
ds_read_b64_tr_b16 v[190:191], v10 offset:63488
v_exp_f32 v206, v70
v_exp_f32 v207, v71
v_mfma_f32_16x16x32_bf16 v[108:111], v[168:171], a[8:11], v[108:111]
buffer_load_dwordx4 v18, s[8:11], s54 offen offset:3072  lds
ds_read_b64_tr_b16 v[144:145], v11 offset:49152
v_add_f32 v200, 1.0, v200
v_add_f32 v201, 1.0, v201
v_mfma_f32_16x16x32_bf16 v[108:111], v[172:175], a[12:15], v[108:111]
ds_read_b64_tr_b16 v[146:147], v11 offset:51200
v_add_f32 v202, 1.0, v202
v_mfma_f32_16x16x32_bf16 v[124:127], v[160:163], a[128:131], 0
ds_read_b64_tr_b16 v[148:149], v11 offset:53248
v_add_f32 v203, 1.0, v203
v_add_f32 v204, 1.0, v204
v_mfma_f32_16x16x32_bf16 v[124:127], v[164:167], a[132:135], v[124:127]
ds_read_b64_tr_b16 v[150:151], v11 offset:55296
v_add_f32 v205, 1.0, v205
v_add_f32 v206, 1.0, v206
v_mfma_f32_16x16x32_bf16 v[124:127], v[168:171], a[136:139], v[124:127]
ds_read_b64_tr_b16 v[152:153], v11 offset:57344
v_add_f32 v207, 1.0, v207
v_rcp_f32 v200, v200
v_mfma_f32_16x16x32_bf16 v[124:127], v[172:175], a[140:143], v[124:127]
ds_read_b64_tr_b16 v[154:155], v11 offset:59392
v_rcp_f32 v201, v201
v_rcp_f32 v202, v202
s_waitcnt lgkmcnt(6)
v_mfma_f32_16x16x32_bf16 v[96:99], v[176:179], a[16:19], v[96:99]
ds_read_b64_tr_b16 v[156:157], v11 offset:61440
v_rcp_f32 v203, v203
v_rcp_f32 v204, v204
v_mfma_f32_16x16x32_bf16 v[96:99], v[180:183], a[20:23], v[96:99]
ds_read_b64_tr_b16 v[158:159], v11 offset:63488
v_rcp_f32 v205, v205
v_rcp_f32 v206, v206
v_mfma_f32_16x16x32_bf16 v[96:99], v[184:187], a[24:27], v[96:99]
s_add_u32 m0, s32, 49152
s_nop 0
buffer_load_dwordx4 v6, s[8:11], s55 offen offset:0  lds
ds_read_b64_tr_b16 v[160:161], v12 offset:49152
v_rcp_f32 v207, v207
v_mfma_f32_16x16x32_bf16 v[96:99], v[188:191], a[28:31], v[96:99]
ds_read_b64_tr_b16 v[162:163], v12 offset:51200
v_mul_f32 v200, v64, v200
v_mul_f32 v201, v65, v201
v_mfma_f32_16x16x32_bf16 v[112:115], v[176:179], a[144:147], v[112:115]
ds_read_b64_tr_b16 v[164:165], v12 offset:53248
v_mul_f32 v202, v66, v202
v_mul_f32 v203, v67, v203
v_mfma_f32_16x16x32_bf16 v[112:115], v[180:183], a[148:151], v[112:115]
buffer_store_dwordx4 v[228:231], v253, s[12:15], s100 offen offset:2048 sc1
ds_read_b64_tr_b16 v[166:167], v12 offset:55296
v_mul_f32 v204, v68, v204
v_mul_f32 v205, v69, v205
v_mfma_f32_16x16x32_bf16 v[112:115], v[184:187], a[152:155], v[112:115]
ds_read_b64_tr_b16 v[168:169], v12 offset:57344
v_mul_f32 v206, v70, v206
v_mul_f32 v207, v71, v207
v_mfma_f32_16x16x32_bf16 v[112:115], v[188:191], a[156:159], v[112:115]
ds_read_b64_tr_b16 v[170:171], v12 offset:59392
v_cvt_pk_bf16_f32 v64, v200, v201
v_cvt_pk_bf16_f32 v65, v202, v203
s_waitcnt lgkmcnt(6)
v_mfma_f32_16x16x32_bf16 v[100:103], v[144:147], a[16:19], v[100:103]
ds_read_b64_tr_b16 v[172:173], v12 offset:61440
v_cvt_pk_bf16_f32 v66, v204, v205
v_mfma_f32_16x16x32_bf16 v[100:103], v[148:151], a[20:23], v[100:103]
ds_read_b64_tr_b16 v[174:175], v12 offset:63488
v_cvt_pk_bf16_f32 v67, v206, v207
v_exp_f32 v192, v40
v_mfma_f32_16x16x32_bf16 v[100:103], v[152:155], a[24:27], v[100:103]
buffer_load_dwordx4 v7, s[8:11], s55 offen offset:1024  lds
ds_read_b64_tr_b16 v[176:177], v13 offset:49152
v_exp_f32 v193, v41
v_exp_f32 v194, v42
v_mfma_f32_16x16x32_bf16 v[100:103], v[156:159], a[28:31], v[100:103]
ds_read_b64_tr_b16 v[178:179], v13 offset:51200
v_exp_f32 v195, v43
v_exp_f32 v196, v44
v_mfma_f32_16x16x32_bf16 v[116:119], v[144:147], a[144:147], v[116:119]
ds_read_b64_tr_b16 v[180:181], v13 offset:53248
v_exp_f32 v197, v45
v_exp_f32 v198, v46
v_mfma_f32_16x16x32_bf16 v[116:119], v[148:151], a[148:151], v[116:119]
ds_read_b64_tr_b16 v[182:183], v13 offset:55296
v_exp_f32 v199, v47
v_add_f32 v192, 1.0, v192
v_mfma_f32_16x16x32_bf16 v[116:119], v[152:155], a[152:155], v[116:119]
ds_read_b64_tr_b16 v[184:185], v13 offset:57344
v_add_f32 v193, 1.0, v193
v_add_f32 v194, 1.0, v194
v_mfma_f32_16x16x32_bf16 v[116:119], v[156:159], a[156:159], v[116:119]
ds_read_b64_tr_b16 v[186:187], v13 offset:59392
v_add_f32 v195, 1.0, v195
s_waitcnt lgkmcnt(6)
s_waitcnt vmcnt(18)
s_barrier
v_mfma_f32_16x16x32_bf16 v[104:107], v[160:163], a[16:19], v[104:107]
ds_read_b64_tr_b16 v[188:189], v13 offset:61440
v_add_f32 v196, 1.0, v196
v_add_f32 v197, 1.0, v197
v_mfma_f32_16x16x32_bf16 v[104:107], v[164:167], a[20:23], v[104:107]
ds_read_b64_tr_b16 v[190:191], v13 offset:63488
v_add_f32 v198, 1.0, v198
v_add_f32 v199, 1.0, v199
v_mfma_f32_16x16x32_bf16 v[104:107], v[168:171], a[24:27], v[104:107]
buffer_load_dwordx4 v8, s[8:11], s55 offen offset:2048  lds
ds_read_b64_tr_b16 v[144:145], v14 offset:0
v_rcp_f32 v192, v192
v_rcp_f32 v193, v193
v_mfma_f32_16x16x32_bf16 v[104:107], v[172:175], a[28:31], v[104:107]
ds_read_b64_tr_b16 v[146:147], v14 offset:2048
v_rcp_f32 v194, v194
v_rcp_f32 v195, v195
v_mfma_f32_16x16x32_bf16 v[120:123], v[160:163], a[144:147], v[120:123]
ds_read_b64_tr_b16 v[148:149], v14 offset:4096
v_rcp_f32 v196, v196
v_rcp_f32 v197, v197
v_mfma_f32_16x16x32_bf16 v[120:123], v[164:167], a[148:151], v[120:123]
ds_read_b64_tr_b16 v[150:151], v14 offset:6144
v_rcp_f32 v198, v198
v_mfma_f32_16x16x32_bf16 v[120:123], v[168:171], a[152:155], v[120:123]
ds_read_b64_tr_b16 v[152:153], v14 offset:8192
v_rcp_f32 v199, v199
v_mul_f32 v192, v40, v192
v_mfma_f32_16x16x32_bf16 v[120:123], v[172:175], a[156:159], v[120:123]
ds_read_b64_tr_b16 v[154:155], v14 offset:10240
v_mul_f32 v193, v41, v193
v_mul_f32 v194, v42, v194
s_waitcnt lgkmcnt(6)
v_mfma_f32_16x16x32_bf16 v[108:111], v[176:179], a[16:19], v[108:111]
ds_read_b64_tr_b16 v[156:157], v14 offset:12288
v_mul_f32 v195, v43, v195
v_mul_f32 v196, v44, v196
v_mfma_f32_16x16x32_bf16 v[108:111], v[180:183], a[20:23], v[108:111]
ds_read_b64_tr_b16 v[158:159], v14 offset:14336
v_mul_f32 v197, v45, v197
v_mul_f32 v198, v46, v198
v_mfma_f32_16x16x32_bf16 v[108:111], v[184:187], a[24:27], v[108:111]
buffer_load_dwordx4 v18, s[8:11], s55 offen offset:3072  lds
ds_read_b64_tr_b16 v[160:161], v15 offset:0
v_mul_f32 v199, v47, v199
v_cvt_pk_bf16_f32 v40, v192, v193
v_mfma_f32_16x16x32_bf16 v[108:111], v[188:191], a[28:31], v[108:111]
ds_read_b64_tr_b16 v[162:163], v15 offset:2048
v_cvt_pk_bf16_f32 v41, v194, v195
v_cvt_pk_bf16_f32 v42, v196, v197
v_mfma_f32_16x16x32_bf16 v[124:127], v[176:179], a[144:147], v[124:127]
ds_read_b64_tr_b16 v[164:165], v15 offset:4096
v_cvt_pk_bf16_f32 v43, v198, v199
v_mfma_f32_16x16x32_bf16 v[124:127], v[180:183], a[148:151], v[124:127]
ds_read_b64_tr_b16 v[166:167], v15 offset:6144
v_exp_f32 v200, v72
v_exp_f32 v201, v73
v_mfma_f32_16x16x32_bf16 v[124:127], v[184:187], a[152:155], v[124:127]
ds_read_b64_tr_b16 v[168:169], v15 offset:8192
v_exp_f32 v202, v74
v_exp_f32 v203, v75
v_mfma_f32_16x16x32_bf16 v[124:127], v[188:191], a[156:159], v[124:127]
ds_read_b64_tr_b16 v[170:171], v15 offset:10240
v_exp_f32 v204, v76
v_exp_f32 v205, v77
s_waitcnt lgkmcnt(6)
v_mfma_f32_16x16x32_bf16 v[96:99], v[144:147], a[32:35], v[96:99]
ds_read_b64_tr_b16 v[172:173], v15 offset:12288
v_exp_f32 v206, v78
v_exp_f32 v207, v79
v_mfma_f32_16x16x32_bf16 v[96:99], v[148:151], a[36:39], v[96:99]
ds_read_b64_tr_b16 v[174:175], v15 offset:14336
v_add_f32 v200, 1.0, v200
v_add_f32 v201, 1.0, v201
v_mfma_f32_16x16x32_bf16 v[96:99], v[152:155], a[40:43], v[96:99]
s_add_u32 s48, s48, s36
s_add_u32 s49, s49, s36
s_add_u32 s50, s50, s36
s_add_u32 s51, s51, s36
s_add_u32 s52, s52, s36
s_add_u32 s53, s53, s36
s_add_u32 s54, s54, s36
s_add_u32 s55, s55, s36
s_add_u32 m0, s32, 65536
s_nop 0
buffer_load_dwordx4 v6, s[8:11], s48 offen offset:0  lds
ds_read_b64_tr_b16 v[176:177], v16 offset:0
v_add_f32 v202, 1.0, v202
v_mfma_f32_16x16x32_bf16 v[96:99], v[156:159], a[44:47], v[96:99]
ds_read_b64_tr_b16 v[178:179], v16 offset:2048
v_add_f32 v203, 1.0, v203
v_add_f32 v204, 1.0, v204
v_mfma_f32_16x16x32_bf16 v[112:115], v[144:147], a[160:163], v[112:115]
ds_read_b64_tr_b16 v[180:181], v16 offset:4096
v_add_f32 v205, 1.0, v205
v_add_f32 v206, 1.0, v206
v_mfma_f32_16x16x32_bf16 v[112:115], v[148:151], a[164:167], v[112:115]
ds_read_b64_tr_b16 v[182:183], v16 offset:6144
v_add_f32 v207, 1.0, v207
v_rcp_f32 v200, v200
v_mfma_f32_16x16x32_bf16 v[112:115], v[152:155], a[168:171], v[112:115]
ds_read_b64_tr_b16 v[184:185], v16 offset:8192
v_rcp_f32 v201, v201
v_rcp_f32 v202, v202
v_mfma_f32_16x16x32_bf16 v[112:115], v[156:159], a[172:175], v[112:115]
ds_read_b64_tr_b16 v[186:187], v16 offset:10240
v_rcp_f32 v203, v203
v_rcp_f32 v204, v204
s_waitcnt lgkmcnt(6)
v_mfma_f32_16x16x32_bf16 v[100:103], v[160:163], a[32:35], v[100:103]
buffer_load_dwordx4 v7, s[8:11], s48 offen offset:1024  lds
ds_read_b64_tr_b16 v[188:189], v16 offset:12288
v_rcp_f32 v205, v205
v_rcp_f32 v206, v206
v_mfma_f32_16x16x32_bf16 v[100:103], v[164:167], a[36:39], v[100:103]
ds_read_b64_tr_b16 v[190:191], v16 offset:14336
v_rcp_f32 v207, v207
v_mfma_f32_16x16x32_bf16 v[100:103], v[168:171], a[40:43], v[100:103]
ds_read_b64_tr_b16 v[144:145], v17 offset:0
v_mul_f32 v200, v72, v200
v_mul_f32 v201, v73, v201
v_mfma_f32_16x16x32_bf16 v[100:103], v[172:175], a[44:47], v[100:103]
ds_read_b64_tr_b16 v[146:147], v17 offset:2048
v_mul_f32 v202, v74, v202
v_mul_f32 v203, v75, v203
v_mfma_f32_16x16x32_bf16 v[116:119], v[160:163], a[160:163], v[116:119]
ds_read_b64_tr_b16 v[148:149], v17 offset:4096
v_mul_f32 v204, v76, v204
v_mul_f32 v205, v77, v205
v_mfma_f32_16x16x32_bf16 v[116:119], v[164:167], a[164:167], v[116:119]
ds_read_b64_tr_b16 v[150:151], v17 offset:6144
v_mul_f32 v206, v78, v206
v_mul_f32 v207, v79, v207
v_mfma_f32_16x16x32_bf16 v[116:119], v[168:171], a[168:171], v[116:119]
buffer_load_dwordx4 v8, s[8:11], s48 offen offset:2048  lds
ds_read_b64_tr_b16 v[152:153], v17 offset:8192
v_cvt_pk_bf16_f32 v72, v200, v201
v_cvt_pk_bf16_f32 v73, v202, v203
v_mfma_f32_16x16x32_bf16 v[116:119], v[172:175], a[172:175], v[116:119]
ds_read_b64_tr_b16 v[154:155], v17 offset:10240
v_cvt_pk_bf16_f32 v74, v204, v205
s_waitcnt lgkmcnt(6)
v_mfma_f32_16x16x32_bf16 v[104:107], v[176:179], a[32:35], v[104:107]
ds_read_b64_tr_b16 v[156:157], v17 offset:12288
v_cvt_pk_bf16_f32 v75, v206, v207
v_exp_f32 v192, v48
v_mfma_f32_16x16x32_bf16 v[104:107], v[180:183], a[36:39], v[104:107]
ds_read_b64_tr_b16 v[158:159], v17 offset:14336
v_exp_f32 v193, v49
v_mfma_f32_16x16x32_bf16 v[104:107], v[184:187], a[40:43], v[104:107]
buffer_store_dwordx4 v[32:35], v20, s[12:15], s37 offen offset:0 sc1
ds_read_b64_tr_b16 v[160:161], v14 offset:16384
v_exp_f32 v194, v50
v_mfma_f32_16x16x32_bf16 v[104:107], v[188:191], a[44:47], v[104:107]
ds_read_b64_tr_b16 v[162:163], v14 offset:18432
v_exp_f32 v195, v51
v_mfma_f32_16x16x32_bf16 v[120:123], v[176:179], a[160:163], v[120:123]
buffer_load_dwordx4 v18, s[8:11], s48 offen offset:3072  lds
ds_read_b64_tr_b16 v[164:165], v14 offset:20480
v_exp_f32 v196, v52
v_mfma_f32_16x16x32_bf16 v[120:123], v[180:183], a[164:167], v[120:123]
ds_read_b64_tr_b16 v[166:167], v14 offset:22528
v_exp_f32 v197, v53
v_exp_f32 v198, v54
v_mfma_f32_16x16x32_bf16 v[120:123], v[184:187], a[168:171], v[120:123]
ds_read_b64_tr_b16 v[168:169], v14 offset:24576
v_exp_f32 v199, v55
v_mfma_f32_16x16x32_bf16 v[120:123], v[188:191], a[172:175], v[120:123]
ds_read_b64_tr_b16 v[170:171], v14 offset:26624
v_add_f32 v192, 1.0, v192
s_waitcnt lgkmcnt(6)
v_mfma_f32_16x16x32_bf16 v[108:111], v[144:147], a[32:35], v[108:111]
ds_read_b64_tr_b16 v[172:173], v14 offset:28672
v_add_f32 v193, 1.0, v193
v_mfma_f32_16x16x32_bf16 v[108:111], v[148:151], a[36:39], v[108:111]
ds_read_b64_tr_b16 v[174:175], v14 offset:30720
v_add_f32 v194, 1.0, v194
v_mfma_f32_16x16x32_bf16 v[108:111], v[152:155], a[40:43], v[108:111]
s_add_u32 m0, s32, 81920
s_nop 0
buffer_load_dwordx4 v6, s[8:11], s49 offen offset:0  lds
ds_read_b64_tr_b16 v[176:177], v15 offset:16384
v_add_f32 v195, 1.0, v195
v_add_f32 v196, 1.0, v196
v_mfma_f32_16x16x32_bf16 v[108:111], v[156:159], a[44:47], v[108:111]
ds_read_b64_tr_b16 v[178:179], v15 offset:18432
v_add_f32 v197, 1.0, v197
v_mfma_f32_16x16x32_bf16 v[124:127], v[144:147], a[160:163], v[124:127]
ds_read_b64_tr_b16 v[180:181], v15 offset:20480
v_add_f32 v198, 1.0, v198
v_mfma_f32_16x16x32_bf16 v[124:127], v[148:151], a[164:167], v[124:127]
ds_read_b64_tr_b16 v[182:183], v15 offset:22528
v_add_f32 v199, 1.0, v199
v_mfma_f32_16x16x32_bf16 v[124:127], v[152:155], a[168:171], v[124:127]
buffer_store_dwordx4 v[64:67], v22, s[12:15], s37 offen offset:0 sc1
ds_read_b64_tr_b16 v[184:185], v15 offset:24576
v_rcp_f32 v192, v192
v_mfma_f32_16x16x32_bf16 v[124:127], v[156:159], a[172:175], v[124:127]
ds_read_b64_tr_b16 v[186:187], v15 offset:26624
v_rcp_f32 v193, v193
v_rcp_f32 v194, v194
s_waitcnt lgkmcnt(6)
v_mfma_f32_16x16x32_bf16 v[96:99], v[160:163], a[48:51], v[96:99]
buffer_load_dwordx4 v7, s[8:11], s49 offen offset:1024  lds
ds_read_b64_tr_b16 v[188:189], v15 offset:28672
v_rcp_f32 v195, v195
v_mfma_f32_16x16x32_bf16 v[96:99], v[164:167], a[52:55], v[96:99]
ds_read_b64_tr_b16 v[190:191], v15 offset:30720
v_rcp_f32 v196, v196
v_mfma_f32_16x16x32_bf16 v[96:99], v[168:171], a[56:59], v[96:99]
ds_read_b64_tr_b16 v[144:145], v16 offset:16384
v_rcp_f32 v197, v197
v_mfma_f32_16x16x32_bf16 v[96:99], v[172:175], a[60:63], v[96:99]
ds_read_b64_tr_b16 v[146:147], v16 offset:18432
v_rcp_f32 v198, v198
v_mfma_f32_16x16x32_bf16 v[112:115], v[160:163], a[176:179], v[112:115]
ds_read_b64_tr_b16 v[148:149], v16 offset:20480
v_rcp_f32 v199, v199
v_mul_f32 v192, v48, v192
v_mfma_f32_16x16x32_bf16 v[112:115], v[164:167], a[180:183], v[112:115]
ds_read_b64_tr_b16 v[150:151], v16 offset:22528
v_mul_f32 v193, v49, v193
v_mfma_f32_16x16x32_bf16 v[112:115], v[168:171], a[184:187], v[112:115]
buffer_load_dwordx4 v8, s[8:11], s49 offen offset:2048  lds
ds_read_b64_tr_b16 v[152:153], v16 offset:24576
v_mul_f32 v194, v50, v194
v_mfma_f32_16x16x32_bf16 v[112:115], v[172:175], a[188:191], v[112:115]
ds_read_b64_tr_b16 v[154:155], v16 offset:26624
v_mul_f32 v195, v51, v195
s_waitcnt lgkmcnt(6)
v_mfma_f32_16x16x32_bf16 v[100:103], v[176:179], a[48:51], v[100:103]
ds_read_b64_tr_b16 v[156:157], v16 offset:28672
v_mul_f32 v196, v52, v196
v_mfma_f32_16x16x32_bf16 v[100:103], v[180:183], a[52:55], v[100:103]
ds_read_b64_tr_b16 v[158:159], v16 offset:30720
v_mul_f32 v197, v53, v197
v_mul_f32 v198, v54, v198
v_mfma_f32_16x16x32_bf16 v[100:103], v[184:187], a[56:59], v[100:103]
buffer_store_dwordx4 v[40:43], v20, s[12:15], s37 offen offset:1024 sc1
ds_read_b64_tr_b16 v[160:161], v17 offset:16384
v_mul_f32 v199, v55, v199
v_mfma_f32_16x16x32_bf16 v[100:103], v[188:191], a[60:63], v[100:103]
ds_read_b64_tr_b16 v[162:163], v17 offset:18432
v_cvt_pk_bf16_f32 v48, v192, v193
v_mfma_f32_16x16x32_bf16 v[116:119], v[176:179], a[176:179], v[116:119]
buffer_load_dwordx4 v18, s[8:11], s49 offen offset:3072  lds
ds_read_b64_tr_b16 v[164:165], v17 offset:20480
v_cvt_pk_bf16_f32 v49, v194, v195
v_mfma_f32_16x16x32_bf16 v[116:119], v[180:183], a[180:183], v[116:119]
ds_read_b64_tr_b16 v[166:167], v17 offset:22528
v_cvt_pk_bf16_f32 v50, v196, v197
v_mfma_f32_16x16x32_bf16 v[116:119], v[184:187], a[184:187], v[116:119]
ds_read_b64_tr_b16 v[168:169], v17 offset:24576
v_cvt_pk_bf16_f32 v51, v198, v199
v_exp_f32 v200, v80
v_mfma_f32_16x16x32_bf16 v[116:119], v[188:191], a[188:191], v[116:119]
ds_read_b64_tr_b16 v[170:171], v17 offset:26624
v_exp_f32 v201, v81
s_waitcnt lgkmcnt(6)
s_waitcnt vmcnt(23)
s_barrier
v_mfma_f32_16x16x32_bf16 v[104:107], v[144:147], a[48:51], v[104:107]
ds_read_b64_tr_b16 v[172:173], v17 offset:28672
v_exp_f32 v202, v82
v_mfma_f32_16x16x32_bf16 v[104:107], v[148:151], a[52:55], v[104:107]
ds_read_b64_tr_b16 v[174:175], v17 offset:30720
v_exp_f32 v203, v83
v_mfma_f32_16x16x32_bf16 v[104:107], v[152:155], a[56:59], v[104:107]
ds_read_b64_tr_b16 v[176:177], v2 offset:0
v_exp_f32 v204, v84
v_mfma_f32_16x16x32_bf16 v[104:107], v[156:159], a[60:63], v[104:107]
ds_read_b64_tr_b16 v[178:179], v2 offset:2048
v_exp_f32 v205, v85
v_exp_f32 v206, v86
v_mfma_f32_16x16x32_bf16 v[120:123], v[144:147], a[176:179], v[120:123]
ds_read_b64_tr_b16 v[180:181], v2 offset:4096
v_exp_f32 v207, v87
v_mfma_f32_16x16x32_bf16 v[120:123], v[148:151], a[180:183], v[120:123]
ds_read_b64_tr_b16 v[182:183], v2 offset:6144
v_add_f32 v200, 1.0, v200
v_mfma_f32_16x16x32_bf16 v[120:123], v[152:155], a[184:187], v[120:123]
buffer_store_dwordx4 v[72:75], v22, s[12:15], s37 offen offset:1024 sc1
s_add_u32 m0, s32, 98304
s_nop 0
buffer_load_dwordx4 v6, s[8:11], s50 offen offset:0  lds
ds_read_b64_tr_b16 v[184:185], v2 offset:8192
v_add_f32 v201, 1.0, v201
v_mfma_f32_16x16x32_bf16 v[120:123], v[156:159], a[188:191], v[120:123]
ds_read_b64_tr_b16 v[186:187], v2 offset:10240
v_add_f32 v202, 1.0, v202
s_waitcnt lgkmcnt(6)
v_mfma_f32_16x16x32_bf16 v[108:111], v[160:163], a[48:51], v[108:111]
ds_read_b64_tr_b16 v[188:189], v2 offset:12288
v_add_f32 v203, 1.0, v203
v_add_f32 v204, 1.0, v204
v_mfma_f32_16x16x32_bf16 v[108:111], v[164:167], a[52:55], v[108:111]
buffer_load_dwordx4 v7, s[8:11], s50 offen offset:1024  lds
ds_read_b64_tr_b16 v[190:191], v2 offset:14336
v_add_f32 v205, 1.0, v205
v_mfma_f32_16x16x32_bf16 v[108:111], v[168:171], a[56:59], v[108:111]
ds_read_b64_tr_b16 v[144:145], v3 offset:0
v_add_f32 v206, 1.0, v206
v_mfma_f32_16x16x32_bf16 v[108:111], v[172:175], a[60:63], v[108:111]
ds_read_b64_tr_b16 v[146:147], v3 offset:2048
v_add_f32 v207, 1.0, v207
v_mfma_f32_16x16x32_bf16 v[124:127], v[160:163], a[176:179], v[124:127]
buffer_load_dwordx4 v8, s[8:11], s50 offen offset:2048  lds
ds_read_b64_tr_b16 v[148:149], v3 offset:4096
v_rcp_f32 v200, v200
v_mfma_f32_16x16x32_bf16 v[124:127], v[164:167], a[180:183], v[124:127]
ds_read_b64_tr_b16 v[150:151], v3 offset:6144
v_rcp_f32 v201, v201
v_rcp_f32 v202, v202
v_mfma_f32_16x16x32_bf16 v[124:127], v[168:171], a[184:187], v[124:127]
ds_read_b64_tr_b16 v[152:153], v3 offset:8192
v_rcp_f32 v203, v203
v_mfma_f32_16x16x32_bf16 v[124:127], v[172:175], a[188:191], v[124:127]
buffer_load_dwordx4 v18, s[8:11], s50 offen offset:3072  lds
s_add_u32 m0, s32, 114688
ds_read_b64_tr_b16 v[154:155], v3 offset:10240
v_rcp_f32 v204, v204
s_waitcnt lgkmcnt(6)
v_mfma_f32_16x16x32_bf16 v[96:99], v[176:179], a[64:67], v[96:99]
ds_read_b64_tr_b16 v[156:157], v3 offset:12288
v_rcp_f32 v205, v205
v_mfma_f32_16x16x32_bf16 v[96:99], v[180:183], a[68:71], v[96:99]
ds_read_b64_tr_b16 v[158:159], v3 offset:14336
v_rcp_f32 v206, v206
v_mfma_f32_16x16x32_bf16 v[96:99], v[184:187], a[72:75], v[96:99]
buffer_load_dwordx4 v6, s[8:11], s51 offen offset:0  lds
ds_read_b64_tr_b16 v[160:161], v4 offset:0
v_rcp_f32 v207, v207
v_mul_f32 v200, v80, v200
v_mfma_f32_16x16x32_bf16 v[96:99], v[188:191], a[76:79], v[96:99]
ds_read_b64_tr_b16 v[162:163], v4 offset:2048
v_mul_f32 v201, v81, v201
v_mfma_f32_16x16x32_bf16 v[112:115], v[176:179], a[192:195], v[112:115]
ds_read_b64_tr_b16 v[164:165], v4 offset:4096
v_mul_f32 v202, v82, v202
v_mfma_f32_16x16x32_bf16 v[112:115], v[180:183], a[196:199], v[112:115]
buffer_load_dwordx4 v7, s[8:11], s51 offen offset:1024  lds
ds_read_b64_tr_b16 v[166:167], v4 offset:6144
v_mul_f32 v203, v83, v203
v_mfma_f32_16x16x32_bf16 v[112:115], v[184:187], a[200:203], v[112:115]
ds_read_b64_tr_b16 v[168:169], v4 offset:8192
v_mul_f32 v204, v84, v204
v_mfma_f32_16x16x32_bf16 v[112:115], v[188:191], a[204:207], v[112:115]
ds_read_b64_tr_b16 v[170:171], v4 offset:10240
v_mul_f32 v205, v85, v205
v_mul_f32 v206, v86, v206
s_waitcnt lgkmcnt(6)
v_mfma_f32_16x16x32_bf16 v[100:103], v[144:147], a[64:67], v[100:103]
buffer_load_dwordx4 v8, s[8:11], s51 offen offset:2048  lds
ds_read_b64_tr_b16 v[172:173], v4 offset:12288
v_mul_f32 v207, v87, v207
v_mfma_f32_16x16x32_bf16 v[100:103], v[148:151], a[68:71], v[100:103]
ds_read_b64_tr_b16 v[174:175], v4 offset:14336
v_cvt_pk_bf16_f32 v80, v200, v201
v_mfma_f32_16x16x32_bf16 v[100:103], v[152:155], a[72:75], v[100:103]
ds_read_b64_tr_b16 v[176:177], v5 offset:0
v_cvt_pk_bf16_f32 v81, v202, v203
v_mfma_f32_16x16x32_bf16 v[100:103], v[156:159], a[76:79], v[100:103]
ds_read_b64_tr_b16 v[178:179], v5 offset:2048
v_cvt_pk_bf16_f32 v82, v204, v205
v_mfma_f32_16x16x32_bf16 v[116:119], v[144:147], a[192:195], v[116:119]
buffer_load_dwordx4 v18, s[8:11], s51 offen offset:3072  lds
ds_read_b64_tr_b16 v[180:181], v5 offset:4096
v_cvt_pk_bf16_f32 v83, v206, v207
v_exp_f32 v192, v56
v_mfma_f32_16x16x32_bf16 v[116:119], v[148:151], a[196:199], v[116:119]
ds_read_b64_tr_b16 v[182:183], v5 offset:6144
v_exp_f32 v193, v57
v_mfma_f32_16x16x32_bf16 v[116:119], v[152:155], a[200:203], v[116:119]
ds_read_b64_tr_b16 v[184:185], v5 offset:8192
v_exp_f32 v194, v58
v_mfma_f32_16x16x32_bf16 v[116:119], v[156:159], a[204:207], v[116:119]
ds_read_b64_tr_b16 v[186:187], v5 offset:10240
v_exp_f32 v195, v59
s_waitcnt lgkmcnt(6)
v_mfma_f32_16x16x32_bf16 v[104:107], v[160:163], a[64:67], v[104:107]
ds_read_b64_tr_b16 v[188:189], v5 offset:12288
v_exp_f32 v196, v60
v_mfma_f32_16x16x32_bf16 v[104:107], v[164:167], a[68:71], v[104:107]
ds_read_b64_tr_b16 v[190:191], v5 offset:14336
v_exp_f32 v197, v61
v_exp_f32 v198, v62
v_mfma_f32_16x16x32_bf16 v[104:107], v[168:171], a[72:75], v[104:107]
ds_read_b64_tr_b16 v[144:145], v2 offset:16384
v_exp_f32 v199, v63
v_mfma_f32_16x16x32_bf16 v[104:107], v[172:175], a[76:79], v[104:107]
ds_read_b64_tr_b16 v[146:147], v2 offset:18432
v_add_f32 v192, 1.0, v192
v_mfma_f32_16x16x32_bf16 v[120:123], v[160:163], a[192:195], v[120:123]
ds_read_b64_tr_b16 v[148:149], v2 offset:20480
v_add_f32 v193, 1.0, v193
v_mfma_f32_16x16x32_bf16 v[120:123], v[164:167], a[196:199], v[120:123]
ds_read_b64_tr_b16 v[150:151], v2 offset:22528
v_add_f32 v194, 1.0, v194
v_mfma_f32_16x16x32_bf16 v[120:123], v[168:171], a[200:203], v[120:123]
ds_read_b64_tr_b16 v[152:153], v2 offset:24576
v_add_f32 v195, 1.0, v195
v_add_f32 v196, 1.0, v196
v_mfma_f32_16x16x32_bf16 v[120:123], v[172:175], a[204:207], v[120:123]
ds_read_b64_tr_b16 v[154:155], v2 offset:26624
v_add_f32 v197, 1.0, v197
s_waitcnt lgkmcnt(6)
v_mfma_f32_16x16x32_bf16 v[108:111], v[176:179], a[64:67], v[108:111]
ds_read_b64_tr_b16 v[156:157], v2 offset:28672
v_add_f32 v198, 1.0, v198
v_mfma_f32_16x16x32_bf16 v[108:111], v[180:183], a[68:71], v[108:111]
ds_read_b64_tr_b16 v[158:159], v2 offset:30720
v_add_f32 v199, 1.0, v199
v_mfma_f32_16x16x32_bf16 v[108:111], v[184:187], a[72:75], v[108:111]
ds_read_b64_tr_b16 v[160:161], v3 offset:16384
v_rcp_f32 v192, v192
v_mfma_f32_16x16x32_bf16 v[108:111], v[188:191], a[76:79], v[108:111]
ds_read_b64_tr_b16 v[162:163], v3 offset:18432
v_rcp_f32 v193, v193
v_rcp_f32 v194, v194
v_mfma_f32_16x16x32_bf16 v[124:127], v[176:179], a[192:195], v[124:127]
ds_read_b64_tr_b16 v[164:165], v3 offset:20480
v_rcp_f32 v195, v195
v_mfma_f32_16x16x32_bf16 v[124:127], v[180:183], a[196:199], v[124:127]
ds_read_b64_tr_b16 v[166:167], v3 offset:22528
v_rcp_f32 v196, v196
v_mfma_f32_16x16x32_bf16 v[124:127], v[184:187], a[200:203], v[124:127]
ds_read_b64_tr_b16 v[168:169], v3 offset:24576
v_rcp_f32 v197, v197
v_mfma_f32_16x16x32_bf16 v[124:127], v[188:191], a[204:207], v[124:127]
ds_read_b64_tr_b16 v[170:171], v3 offset:26624
v_rcp_f32 v198, v198
s_waitcnt lgkmcnt(6)
v_mfma_f32_16x16x32_bf16 v[96:99], v[144:147], a[80:83], v[96:99]
ds_read_b64_tr_b16 v[172:173], v3 offset:28672
v_rcp_f32 v199, v199
v_mul_f32 v192, v56, v192
v_mfma_f32_16x16x32_bf16 v[96:99], v[148:151], a[84:87], v[96:99]
ds_read_b64_tr_b16 v[174:175], v3 offset:30720
v_mul_f32 v193, v57, v193
v_mfma_f32_16x16x32_bf16 v[96:99], v[152:155], a[88:91], v[96:99]
ds_read_b64_tr_b16 v[176:177], v4 offset:16384
v_mul_f32 v194, v58, v194
v_mfma_f32_16x16x32_bf16 v[96:99], v[156:159], a[92:95], v[96:99]
ds_read_b64_tr_b16 v[178:179], v4 offset:18432
v_mul_f32 v195, v59, v195
v_mfma_f32_16x16x32_bf16 v[112:115], v[144:147], a[208:211], v[112:115]
ds_read_b64_tr_b16 v[180:181], v4 offset:20480
v_mul_f32 v196, v60, v196
v_mfma_f32_16x16x32_bf16 v[112:115], v[148:151], a[212:215], v[112:115]
ds_read_b64_tr_b16 v[182:183], v4 offset:22528
v_mul_f32 v197, v61, v197
v_mul_f32 v198, v62, v198
v_mfma_f32_16x16x32_bf16 v[112:115], v[152:155], a[216:219], v[112:115]
ds_read_b64_tr_b16 v[184:185], v4 offset:24576
v_mul_f32 v199, v63, v199
v_mfma_f32_16x16x32_bf16 v[112:115], v[156:159], a[220:223], v[112:115]
ds_read_b64_tr_b16 v[186:187], v4 offset:26624
v_cvt_pk_bf16_f32 v56, v192, v193
s_waitcnt lgkmcnt(6)
v_mfma_f32_16x16x32_bf16 v[100:103], v[160:163], a[80:83], v[100:103]
ds_read_b64_tr_b16 v[188:189], v4 offset:28672
v_cvt_pk_bf16_f32 v57, v194, v195
v_mfma_f32_16x16x32_bf16 v[100:103], v[164:167], a[84:87], v[100:103]
ds_read_b64_tr_b16 v[190:191], v4 offset:30720
v_cvt_pk_bf16_f32 v58, v196, v197
v_mfma_f32_16x16x32_bf16 v[100:103], v[168:171], a[88:91], v[100:103]
ds_read_b64_tr_b16 v[144:145], v5 offset:16384
v_cvt_pk_bf16_f32 v59, v198, v199
v_exp_f32 v200, v88
v_mfma_f32_16x16x32_bf16 v[100:103], v[172:175], a[92:95], v[100:103]
ds_read_b64_tr_b16 v[146:147], v5 offset:18432
v_exp_f32 v201, v89
v_mfma_f32_16x16x32_bf16 v[116:119], v[160:163], a[208:211], v[116:119]
ds_read_b64_tr_b16 v[148:149], v5 offset:20480
v_exp_f32 v202, v90
v_mfma_f32_16x16x32_bf16 v[116:119], v[164:167], a[212:215], v[116:119]
ds_read_b64_tr_b16 v[150:151], v5 offset:22528
v_exp_f32 v203, v91
v_mfma_f32_16x16x32_bf16 v[116:119], v[168:171], a[216:219], v[116:119]
ds_read_b64_tr_b16 v[152:153], v5 offset:24576
v_exp_f32 v204, v92
v_mfma_f32_16x16x32_bf16 v[116:119], v[172:175], a[220:223], v[116:119]
ds_read_b64_tr_b16 v[154:155], v5 offset:26624
v_exp_f32 v205, v93
v_exp_f32 v206, v94
s_waitcnt lgkmcnt(6)
s_waitcnt vmcnt(20)
s_barrier
v_mfma_f32_16x16x32_bf16 v[104:107], v[176:179], a[80:83], v[104:107]
ds_read_b64_tr_b16 v[156:157], v5 offset:28672
v_exp_f32 v207, v95
v_mfma_f32_16x16x32_bf16 v[104:107], v[180:183], a[84:87], v[104:107]
ds_read_b64_tr_b16 v[158:159], v5 offset:30720
v_add_f32 v200, 1.0, v200
v_mfma_f32_16x16x32_bf16 v[104:107], v[184:187], a[88:91], v[104:107]
ds_read_b64_tr_b16 v[160:161], v2 offset:32768
v_add_f32 v201, 1.0, v201
v_mfma_f32_16x16x32_bf16 v[104:107], v[188:191], a[92:95], v[104:107]
ds_read_b64_tr_b16 v[162:163], v2 offset:34816
v_add_f32 v202, 1.0, v202
v_mfma_f32_16x16x32_bf16 v[120:123], v[176:179], a[208:211], v[120:123]
ds_read_b64_tr_b16 v[164:165], v2 offset:36864
v_add_f32 v203, 1.0, v203
v_add_f32 v204, 1.0, v204
v_mfma_f32_16x16x32_bf16 v[120:123], v[180:183], a[212:215], v[120:123]
ds_read_b64_tr_b16 v[166:167], v2 offset:38912
v_add_f32 v205, 1.0, v205
v_mfma_f32_16x16x32_bf16 v[120:123], v[184:187], a[216:219], v[120:123]
s_add_u32 m0, s32, 131072
s_nop 0
buffer_load_dwordx4 v6, s[8:11], s52 offen offset:0  lds
ds_read_b64_tr_b16 v[168:169], v2 offset:40960
v_add_f32 v206, 1.0, v206
v_mfma_f32_16x16x32_bf16 v[120:123], v[188:191], a[220:223], v[120:123]
ds_read_b64_tr_b16 v[170:171], v2 offset:43008
v_add_f32 v207, 1.0, v207
s_waitcnt lgkmcnt(6)
v_mfma_f32_16x16x32_bf16 v[108:111], v[144:147], a[80:83], v[108:111]
ds_read_b64_tr_b16 v[172:173], v2 offset:45056
v_rcp_f32 v200, v200
v_mfma_f32_16x16x32_bf16 v[108:111], v[148:151], a[84:87], v[108:111]
buffer_load_dwordx4 v7, s[8:11], s52 offen offset:1024  lds
ds_read_b64_tr_b16 v[174:175], v2 offset:47104
v_rcp_f32 v201, v201
v_rcp_f32 v202, v202
v_mfma_f32_16x16x32_bf16 v[108:111], v[152:155], a[88:91], v[108:111]
ds_read_b64_tr_b16 v[176:177], v3 offset:32768
v_rcp_f32 v203, v203
v_mfma_f32_16x16x32_bf16 v[108:111], v[156:159], a[92:95], v[108:111]
ds_read_b64_tr_b16 v[178:179], v3 offset:34816
v_rcp_f32 v204, v204
v_mfma_f32_16x16x32_bf16 v[124:127], v[144:147], a[208:211], v[124:127]
s_waitcnt vmcnt(10)
buffer_store_dword v31, v30, s[12:15], s59 offen offset:4 sc1
buffer_load_dwordx4 v8, s[8:11], s52 offen offset:2048  lds
ds_read_b64_tr_b16 v[180:181], v3 offset:36864
v_rcp_f32 v205, v205
v_mfma_f32_16x16x32_bf16 v[124:127], v[148:151], a[212:215], v[124:127]
ds_read_b64_tr_b16 v[182:183], v3 offset:38912
v_rcp_f32 v206, v206
v_mfma_f32_16x16x32_bf16 v[124:127], v[152:155], a[216:219], v[124:127]
ds_read_b64_tr_b16 v[184:185], v3 offset:40960
v_rcp_f32 v207, v207
v_mul_f32 v200, v88, v200
v_mfma_f32_16x16x32_bf16 v[124:127], v[156:159], a[220:223], v[124:127]
buffer_load_dwordx4 v18, s[8:11], s52 offen offset:3072  lds
s_add_u32 m0, s32, 147456
ds_read_b64_tr_b16 v[186:187], v3 offset:43008
v_mul_f32 v201, v89, v201
s_waitcnt lgkmcnt(6)
v_mfma_f32_16x16x32_bf16 v[96:99], v[160:163], a[96:99], v[96:99]
ds_read_b64_tr_b16 v[188:189], v3 offset:45056
v_mul_f32 v202, v90, v202
v_mfma_f32_16x16x32_bf16 v[96:99], v[164:167], a[100:103], v[96:99]
ds_read_b64_tr_b16 v[190:191], v3 offset:47104
v_mul_f32 v203, v91, v203
v_mfma_f32_16x16x32_bf16 v[96:99], v[168:171], a[104:107], v[96:99]
buffer_load_dwordx4 v6, s[8:11], s53 offen offset:0  lds
ds_read_b64_tr_b16 v[144:145], v4 offset:32768
v_mul_f32 v204, v92, v204
v_mfma_f32_16x16x32_bf16 v[96:99], v[172:175], a[108:111], v[96:99]
ds_read_b64_tr_b16 v[146:147], v4 offset:34816
v_mul_f32 v205, v93, v205
v_mul_f32 v206, v94, v206
v_mfma_f32_16x16x32_bf16 v[112:115], v[160:163], a[224:227], v[112:115]
ds_read_b64_tr_b16 v[148:149], v4 offset:36864
v_mul_f32 v207, v95, v207
v_mfma_f32_16x16x32_bf16 v[112:115], v[164:167], a[228:231], v[112:115]
buffer_load_dwordx4 v7, s[8:11], s53 offen offset:1024  lds
ds_read_b64_tr_b16 v[150:151], v4 offset:38912
v_cvt_pk_bf16_f32 v88, v200, v201
v_mfma_f32_16x16x32_bf16 v[112:115], v[168:171], a[232:235], v[112:115]
ds_read_b64_tr_b16 v[152:153], v4 offset:40960
v_cvt_pk_bf16_f32 v89, v202, v203
v_mfma_f32_16x16x32_bf16 v[112:115], v[172:175], a[236:239], v[112:115]
ds_read_b64_tr_b16 v[154:155], v4 offset:43008
v_cvt_pk_bf16_f32 v90, v204, v205
s_waitcnt lgkmcnt(6)
v_mfma_f32_16x16x32_bf16 v[100:103], v[176:179], a[96:99], v[100:103]
buffer_load_dwordx4 v8, s[8:11], s53 offen offset:2048  lds
ds_read_b64_tr_b16 v[156:157], v4 offset:45056
v_cvt_pk_bf16_f32 v91, v206, v207
v_mfma_f32_16x16x32_bf16 v[100:103], v[180:183], a[100:103], v[100:103]
ds_read_b64_tr_b16 v[158:159], v4 offset:47104
ds_read_b64_tr_b16 v[160:161], v5 offset:32768
v_mfma_f32_16x16x32_bf16 v[100:103], v[184:187], a[104:107], v[100:103]
buffer_store_dwordx4 v[48:51], v20, s[12:15], s37 offen offset:2048 sc1
v_mfma_f32_16x16x32_bf16 v[100:103], v[188:191], a[108:111], v[100:103]
buffer_load_dwordx4 v18, s[8:11], s53 offen offset:3072  lds
ds_read_b64_tr_b16 v[162:163], v5 offset:34816
v_mfma_f32_16x16x32_bf16 v[116:119], v[176:179], a[224:227], v[116:119]
ds_read_b64_tr_b16 v[164:165], v5 offset:36864
ds_read_b64_tr_b16 v[166:167], v5 offset:38912
v_mfma_f32_16x16x32_bf16 v[116:119], v[180:183], a[228:231], v[116:119]
ds_read_b64_tr_b16 v[168:169], v5 offset:40960
ds_read_b64_tr_b16 v[170:171], v5 offset:43008
v_mfma_f32_16x16x32_bf16 v[116:119], v[184:187], a[232:235], v[116:119]
ds_read_b64_tr_b16 v[172:173], v5 offset:45056
ds_read_b64_tr_b16 v[174:175], v5 offset:47104
v_mfma_f32_16x16x32_bf16 v[116:119], v[188:191], a[236:239], v[116:119]
s_waitcnt lgkmcnt(8)
v_mfma_f32_16x16x32_bf16 v[104:107], v[144:147], a[96:99], v[104:107]
ds_read_b64_tr_b16 v[176:177], v2 offset:49152
ds_read_b64_tr_b16 v[178:179], v2 offset:51200
v_mfma_f32_16x16x32_bf16 v[104:107], v[148:151], a[100:103], v[104:107]
ds_read_b64_tr_b16 v[180:181], v2 offset:53248
v_mfma_f32_16x16x32_bf16 v[104:107], v[152:155], a[104:107], v[104:107]
ds_read_b64_tr_b16 v[182:183], v2 offset:55296
v_mfma_f32_16x16x32_bf16 v[104:107], v[156:159], a[108:111], v[104:107]
ds_read_b64_tr_b16 v[184:185], v2 offset:57344
v_mfma_f32_16x16x32_bf16 v[120:123], v[144:147], a[224:227], v[120:123]
ds_read_b64_tr_b16 v[186:187], v2 offset:59392
v_mfma_f32_16x16x32_bf16 v[120:123], v[148:151], a[228:231], v[120:123]
ds_read_b64_tr_b16 v[188:189], v2 offset:61440
v_mfma_f32_16x16x32_bf16 v[120:123], v[152:155], a[232:235], v[120:123]
buffer_store_dwordx4 v[80:83], v22, s[12:15], s37 offen offset:2048 sc1
v_mfma_f32_16x16x32_bf16 v[120:123], v[156:159], a[236:239], v[120:123]
ds_read_b64_tr_b16 v[190:191], v2 offset:63488
s_waitcnt lgkmcnt(8)
v_mfma_f32_16x16x32_bf16 v[108:111], v[160:163], a[96:99], v[108:111]
ds_read_b64_tr_b16 v[144:145], v3 offset:49152
ds_read_b64_tr_b16 v[146:147], v3 offset:51200
v_mfma_f32_16x16x32_bf16 v[108:111], v[164:167], a[100:103], v[108:111]
ds_read_b64_tr_b16 v[148:149], v3 offset:53248
v_mfma_f32_16x16x32_bf16 v[108:111], v[168:171], a[104:107], v[108:111]
ds_read_b64_tr_b16 v[150:151], v3 offset:55296
v_mfma_f32_16x16x32_bf16 v[108:111], v[172:175], a[108:111], v[108:111]
ds_read_b64_tr_b16 v[152:153], v3 offset:57344
v_mfma_f32_16x16x32_bf16 v[124:127], v[160:163], a[224:227], v[124:127]
ds_read_b64_tr_b16 v[154:155], v3 offset:59392
v_mfma_f32_16x16x32_bf16 v[124:127], v[164:167], a[228:231], v[124:127]
ds_read_b64_tr_b16 v[156:157], v3 offset:61440
v_mfma_f32_16x16x32_bf16 v[124:127], v[168:171], a[232:235], v[124:127]
ds_read_b64_tr_b16 v[158:159], v3 offset:63488
v_mfma_f32_16x16x32_bf16 v[124:127], v[172:175], a[236:239], v[124:127]
s_waitcnt lgkmcnt(8)
v_mfma_f32_16x16x32_bf16 v[96:99], v[176:179], a[112:115], v[96:99]
ds_read_b64_tr_b16 v[160:161], v4 offset:49152
ds_read_b64_tr_b16 v[162:163], v4 offset:51200
v_mfma_f32_16x16x32_bf16 v[96:99], v[180:183], a[116:119], v[96:99]
ds_read_b64_tr_b16 v[164:165], v4 offset:53248
v_mfma_f32_16x16x32_bf16 v[96:99], v[184:187], a[120:123], v[96:99]
buffer_store_dwordx4 v[56:59], v20, s[12:15], s37 offen offset:3072 sc1
v_mfma_f32_16x16x32_bf16 v[96:99], v[188:191], a[124:127], v[96:99]
ds_read_b64_tr_b16 v[166:167], v4 offset:55296
ds_read_b64_tr_b16 v[168:169], v4 offset:57344
v_mfma_f32_16x16x32_bf16 v[112:115], v[176:179], a[240:243], v[112:115]
ds_read_b64_tr_b16 v[170:171], v4 offset:59392
v_mfma_f32_16x16x32_bf16 v[112:115], v[180:183], a[244:247], v[112:115]
ds_read_b64_tr_b16 v[172:173], v4 offset:61440
v_mfma_f32_16x16x32_bf16 v[112:115], v[184:187], a[248:251], v[112:115]
ds_read_b64_tr_b16 v[174:175], v4 offset:63488
v_mfma_f32_16x16x32_bf16 v[112:115], v[188:191], a[252:255], v[112:115]
s_waitcnt lgkmcnt(8)
v_mfma_f32_16x16x32_bf16 v[100:103], v[144:147], a[112:115], v[100:103]
ds_read_b64_tr_b16 v[176:177], v5 offset:49152
ds_read_b64_tr_b16 v[178:179], v5 offset:51200
v_mfma_f32_16x16x32_bf16 v[100:103], v[148:151], a[116:119], v[100:103]
ds_read_b64_tr_b16 v[180:181], v5 offset:53248
v_mfma_f32_16x16x32_bf16 v[100:103], v[152:155], a[120:123], v[100:103]
ds_read_b64_tr_b16 v[182:183], v5 offset:55296
v_mfma_f32_16x16x32_bf16 v[100:103], v[156:159], a[124:127], v[100:103]
ds_read_b64_tr_b16 v[184:185], v5 offset:57344
v_mfma_f32_16x16x32_bf16 v[116:119], v[144:147], a[240:243], v[116:119]
ds_read_b64_tr_b16 v[186:187], v5 offset:59392
v_mfma_f32_16x16x32_bf16 v[116:119], v[148:151], a[244:247], v[116:119]
ds_read_b64_tr_b16 v[188:189], v5 offset:61440
v_mfma_f32_16x16x32_bf16 v[116:119], v[152:155], a[248:251], v[116:119]
buffer_store_dwordx4 v[88:91], v22, s[12:15], s37 offen offset:3072 sc1
v_mfma_f32_16x16x32_bf16 v[116:119], v[156:159], a[252:255], v[116:119]
s_waitcnt lgkmcnt(7)
s_barrier
v_mfma_f32_16x16x32_bf16 v[104:107], v[160:163], a[112:115], v[104:107]
s_add_u32 m0, s32, 0
ds_read_b64_tr_b16 v[190:191], v5 offset:63488
v_mfma_f32_16x16x32_bf16 v[104:107], v[164:167], a[116:119], v[104:107]
buffer_load_dwordx4 v6, s[8:11], s54 offen offset:0  lds
v_mfma_f32_16x16x32_bf16 v[104:107], v[168:171], a[120:123], v[104:107]
ds_read_b64_tr_b16 v[144:145], v26 offset:0
ds_read_b64_tr_b16 v[146:147], v26 offset:2048
v_mfma_f32_16x16x32_bf16 v[104:107], v[172:175], a[124:127], v[104:107]
buffer_load_dwordx4 v7, s[8:11], s54 offen offset:1024  lds
v_mfma_f32_16x16x32_bf16 v[120:123], v[160:163], a[240:243], v[120:123]
ds_read_b64_tr_b16 v[148:149], v26 offset:4096
ds_read_b64_tr_b16 v[150:151], v26 offset:6144
v_mfma_f32_16x16x32_bf16 v[120:123], v[164:167], a[244:247], v[120:123]
ds_read_b64_tr_b16 v[152:153], v26 offset:8192
ds_read_b64_tr_b16 v[154:155], v26 offset:10240
v_mfma_f32_16x16x32_bf16 v[120:123], v[168:171], a[248:251], v[120:123]
buffer_load_dwordx4 v8, s[8:11], s54 offen offset:2048  lds
v_mfma_f32_16x16x32_bf16 v[120:123], v[172:175], a[252:255], v[120:123]
ds_read_b64_tr_b16 v[156:157], v26 offset:12288
s_waitcnt lgkmcnt(7)
v_mfma_f32_16x16x32_bf16 v[108:111], v[176:179], a[112:115], v[108:111]
ds_read_b64_tr_b16 v[158:159], v26 offset:14336
ds_read_b64_tr_b16 v[160:161], v27 offset:0
v_mfma_f32_16x16x32_bf16 v[108:111], v[180:183], a[116:119], v[108:111]
s_buffer_load_dword s45, s[12:15], s40 offset:262148 glc
s_buffer_load_dword s46, s[12:15], s40 offset:266244 glc
v_mfma_f32_16x16x32_bf16 v[108:111], v[184:187], a[120:123], v[108:111]
s_buffer_load_dword s47, s[12:15], s40 offset:270340 glc
s_buffer_load_dword s101, s[12:15], s40 offset:274436 glc
v_mfma_f32_16x16x32_bf16 v[108:111], v[188:191], a[124:127], v[108:111]
ds_read_b64_tr_b16 v[162:163], v27 offset:2048
ds_read_b64_tr_b16 v[164:165], v27 offset:4096
v_mfma_f32_16x16x32_bf16 v[124:127], v[176:179], a[240:243], v[124:127]
buffer_load_dwordx4 v18, s[8:11], s54 offen offset:3072  lds
v_mfma_f32_16x16x32_bf16 v[124:127], v[180:183], a[244:247], v[124:127]
ds_read_b64_tr_b16 v[166:167], v27 offset:6144
s_add_u32 m0, s32, 16384
v_mfma_f32_16x16x32_bf16 v[124:127], v[184:187], a[248:251], v[124:127]
ds_read_b64_tr_b16 v[168:169], v27 offset:8192
ds_read_b64_tr_b16 v[170:171], v27 offset:10240
v_mfma_f32_16x16x32_bf16 v[124:127], v[188:191], a[252:255], v[124:127]
ds_read_b64_tr_b16 v[172:173], v27 offset:12288
s_waitcnt lgkmcnt(7)
v_mfma_f32_16x16x32_bf16 v[128:131], v[144:147], a[0:3], 0
buffer_load_dwordx4 v6, s[8:11], s55 offen offset:0  lds
v_mfma_f32_16x16x32_bf16 v[128:131], v[148:151], a[4:7], v[128:131]
ds_read_b64_tr_b16 v[174:175], v27 offset:14336
ds_read_b64_tr_b16 v[176:177], v26 offset:16384
v_mfma_f32_16x16x32_bf16 v[128:131], v[152:155], a[8:11], v[128:131]
buffer_load_dwordx4 v7, s[8:11], s55 offen offset:1024  lds
v_mfma_f32_16x16x32_bf16 v[128:131], v[156:159], a[12:15], v[128:131]
ds_read_b64_tr_b16 v[178:179], v26 offset:18432
v_exp_f32 v192, v96
v_mfma_f32_16x16x32_bf16 v[136:139], v[144:147], a[128:131], 0
ds_read_b64_tr_b16 v[180:181], v26 offset:20480
v_exp_f32 v193, v97
v_mfma_f32_16x16x32_bf16 v[136:139], v[148:151], a[132:135], v[136:139]
ds_read_b64_tr_b16 v[182:183], v26 offset:22528
v_exp_f32 v194, v98
v_mfma_f32_16x16x32_bf16 v[136:139], v[152:155], a[136:139], v[136:139]
ds_read_b64_tr_b16 v[184:185], v26 offset:24576
v_exp_f32 v195, v99
v_mfma_f32_16x16x32_bf16 v[136:139], v[156:159], a[140:143], v[136:139]
ds_read_b64_tr_b16 v[186:187], v26 offset:26624
v_exp_f32 v196, v100
s_waitcnt lgkmcnt(6)
v_mfma_f32_16x16x32_bf16 v[132:135], v[160:163], a[0:3], 0
buffer_load_dwordx4 v8, s[8:11], s55 offen offset:2048  lds
ds_read_b64_tr_b16 v[188:189], v26 offset:28672
v_exp_f32 v197, v101
v_mfma_f32_16x16x32_bf16 v[132:135], v[164:167], a[4:7], v[132:135]
ds_read_b64_tr_b16 v[190:191], v26 offset:30720
v_exp_f32 v198, v102
v_mfma_f32_16x16x32_bf16 v[132:135], v[168:171], a[8:11], v[132:135]
ds_read_b64_tr_b16 v[144:145], v27 offset:16384
v_exp_f32 v199, v103
v_mfma_f32_16x16x32_bf16 v[132:135], v[172:175], a[12:15], v[132:135]
buffer_load_dwordx4 v18, s[8:11], s55 offen offset:3072  lds
ds_read_b64_tr_b16 v[146:147], v27 offset:18432
v_add_f32 v192, 1.0, v192
v_mfma_f32_16x16x32_bf16 v[140:143], v[160:163], a[128:131], 0
ds_read_b64_tr_b16 v[148:149], v27 offset:20480
v_add_f32 v193, 1.0, v193
v_mfma_f32_16x16x32_bf16 v[140:143], v[164:167], a[132:135], v[140:143]
ds_read_b64_tr_b16 v[150:151], v27 offset:22528
v_add_f32 v194, 1.0, v194
v_mfma_f32_16x16x32_bf16 v[140:143], v[168:171], a[136:139], v[140:143]
ds_read_b64_tr_b16 v[152:153], v27 offset:24576
v_add_f32 v195, 1.0, v195
v_mfma_f32_16x16x32_bf16 v[140:143], v[172:175], a[140:143], v[140:143]
ds_read_b64_tr_b16 v[154:155], v27 offset:26624
v_add_f32 v196, 1.0, v196
s_waitcnt lgkmcnt(6)
s_waitcnt vmcnt(21)
s_barrier
v_mfma_f32_16x16x32_bf16 v[128:131], v[176:179], a[16:19], v[128:131]
ds_read_b64_tr_b16 v[156:157], v27 offset:28672
v_add_f32 v197, 1.0, v197
v_mfma_f32_16x16x32_bf16 v[128:131], v[180:183], a[20:23], v[128:131]
ds_read_b64_tr_b16 v[158:159], v27 offset:30720
v_add_f32 v198, 1.0, v198
v_mfma_f32_16x16x32_bf16 v[128:131], v[184:187], a[24:27], v[128:131]
ds_read_b64_tr_b16 v[160:161], v26 offset:32768
v_add_f32 v199, 1.0, v199
v_mfma_f32_16x16x32_bf16 v[128:131], v[188:191], a[28:31], v[128:131]
ds_read_b64_tr_b16 v[162:163], v26 offset:34816
v_rcp_f32 v192, v192
v_mfma_f32_16x16x32_bf16 v[136:139], v[176:179], a[144:147], v[136:139]
ds_read_b64_tr_b16 v[164:165], v26 offset:36864
v_rcp_f32 v193, v193
v_mfma_f32_16x16x32_bf16 v[136:139], v[180:183], a[148:151], v[136:139]
ds_read_b64_tr_b16 v[166:167], v26 offset:38912
v_rcp_f32 v194, v194
v_mfma_f32_16x16x32_bf16 v[136:139], v[184:187], a[152:155], v[136:139]
s_add_u32 m0, s32, 32768
s_add_u32 s29, s20, 0
v_add_u32 v6, 0, v254
v_add_u32 v7, 15360, v254
v_add_u32 v8, 30720, v254
v_add_u32 v18, 46080, v254
v_mfma_f32_16x16x32_bf16 v[136:139], v[188:191], a[156:159], v[136:139]
buffer_load_dwordx4 v6, s[60:63], s29 offen offset:0  lds
ds_read_b64_tr_b16 v[168:169], v26 offset:40960
ds_read_b64_tr_b16 v[170:171], v26 offset:43008
v_rcp_f32 v195, v195
v_rcp_f32 v196, v196
s_waitcnt lgkmcnt(6)
v_mfma_f32_16x16x32_bf16 v[132:135], v[144:147], a[16:19], v[132:135]
ds_read_b64_tr_b16 v[172:173], v26 offset:45056
v_rcp_f32 v197, v197
v_mfma_f32_16x16x32_bf16 v[132:135], v[148:151], a[20:23], v[132:135]
buffer_load_dwordx4 v7, s[60:63], s29 offen offset:1024  lds
ds_read_b64_tr_b16 v[174:175], v26 offset:47104
v_rcp_f32 v198, v198
v_mfma_f32_16x16x32_bf16 v[132:135], v[152:155], a[24:27], v[132:135]
ds_read_b64_tr_b16 v[176:177], v27 offset:32768
v_rcp_f32 v199, v199
v_mfma_f32_16x16x32_bf16 v[132:135], v[156:159], a[28:31], v[132:135]
ds_read_b64_tr_b16 v[178:179], v27 offset:34816
v_mul_f32 v192, v96, v192
v_mfma_f32_16x16x32_bf16 v[140:143], v[144:147], a[144:147], v[140:143]
buffer_load_dwordx4 v8, s[60:63], s29 offen offset:2048  lds
ds_read_b64_tr_b16 v[180:181], v27 offset:36864
v_mul_f32 v193, v97, v193
v_mfma_f32_16x16x32_bf16 v[140:143], v[148:151], a[148:151], v[140:143]
ds_read_b64_tr_b16 v[182:183], v27 offset:38912
v_mul_f32 v194, v98, v194
v_mfma_f32_16x16x32_bf16 v[140:143], v[152:155], a[152:155], v[140:143]
ds_read_b64_tr_b16 v[184:185], v27 offset:40960
v_mul_f32 v195, v99, v195
v_mfma_f32_16x16x32_bf16 v[140:143], v[156:159], a[156:159], v[140:143]
buffer_load_dwordx4 v18, s[60:63], s29 offen offset:3072  lds
s_add_u32 m0, s32, 49152
s_add_u32 s29, s21, 0
ds_read_b64_tr_b16 v[186:187], v27 offset:43008
v_mul_f32 v196, v100, v196
s_waitcnt lgkmcnt(6)
v_mfma_f32_16x16x32_bf16 v[128:131], v[160:163], a[32:35], v[128:131]
ds_read_b64_tr_b16 v[188:189], v27 offset:45056
v_mul_f32 v197, v101, v197
v_mfma_f32_16x16x32_bf16 v[128:131], v[164:167], a[36:39], v[128:131]
ds_read_b64_tr_b16 v[190:191], v27 offset:47104
v_mul_f32 v198, v102, v198
v_mfma_f32_16x16x32_bf16 v[128:131], v[168:171], a[40:43], v[128:131]
buffer_load_dwordx4 v6, s[60:63], s29 offen offset:0  lds
ds_read_b64_tr_b16 v[144:145], v26 offset:49152
v_mul_f32 v199, v103, v199
v_mfma_f32_16x16x32_bf16 v[128:131], v[172:175], a[44:47], v[128:131]
ds_read_b64_tr_b16 v[146:147], v26 offset:51200
v_cvt_pk_bf16_f32 v96, v192, v193
v_mfma_f32_16x16x32_bf16 v[136:139], v[160:163], a[160:163], v[136:139]
ds_read_b64_tr_b16 v[148:149], v26 offset:53248
v_cvt_pk_bf16_f32 v97, v194, v195
v_mfma_f32_16x16x32_bf16 v[136:139], v[164:167], a[164:167], v[136:139]
buffer_load_dwordx4 v7, s[60:63], s29 offen offset:1024  lds
ds_read_b64_tr_b16 v[150:151], v26 offset:55296
v_cvt_pk_bf16_f32 v98, v196, v197
v_mfma_f32_16x16x32_bf16 v[136:139], v[168:171], a[168:171], v[136:139]
ds_read_b64_tr_b16 v[152:153], v26 offset:57344
v_cvt_pk_bf16_f32 v99, v198, v199
v_mfma_f32_16x16x32_bf16 v[136:139], v[172:175], a[172:175], v[136:139]
s_waitcnt lgkmcnt(0)
s_and_b32 s45, s45, s46
s_and_b32 s45, s45, s47
s_and_b32 s45, s45, s101
s_cbranch_scc1 mlp_kernel_q5_ok
s_mov_b32 s27, 0x40000
mlp_kernel_q5:
s_sleep 4
s_buffer_load_dword s45, s[12:15], s40 offset:262148 glc
s_buffer_load_dword s46, s[12:15], s40 offset:266244 glc
s_buffer_load_dword s47, s[12:15], s40 offset:270340 glc
s_buffer_load_dword s101, s[12:15], s40 offset:274436 glc
s_waitcnt lgkmcnt(0)
s_sub_u32 s27, s27, 1
s_cbranch_scc1 mlp_kernel_q5_ok
s_and_b32 s45, s45, s46
s_and_b32 s45, s45, s47
s_and_b32 s45, s45, s101
s_cbranch_scc0 mlp_kernel_q5
mlp_kernel_q5_ok:
s_add_u32 s28, s30, 0
buffer_load_dwordx4 a[0:3], v20, s[12:15], s28 offen offset:0 sc1
ds_read_b64_tr_b16 v[154:155], v26 offset:59392
v_exp_f32 v200, v112
v_mfma_f32_16x16x32_bf16 v[132:135], v[176:179], a[32:35], v[132:135]
buffer_load_dwordx4 v8, s[60:63], s29 offen offset:2048  lds
ds_read_b64_tr_b16 v[156:157], v26 offset:61440
v_exp_f32 v201, v113
v_mfma_f32_16x16x32_bf16 v[132:135], v[180:183], a[36:39], v[132:135]
ds_read_b64_tr_b16 v[158:159], v26 offset:63488
v_exp_f32 v202, v114
v_mfma_f32_16x16x32_bf16 v[132:135], v[184:187], a[40:43], v[132:135]
buffer_load_dwordx4 a[4:7], v20, s[12:15], s28 offen offset:1024 sc1
ds_read_b64_tr_b16 v[160:161], v27 offset:49152
v_exp_f32 v203, v115
v_mfma_f32_16x16x32_bf16 v[132:135], v[188:191], a[44:47], v[132:135]
buffer_load_dwordx4 v18, s[60:63], s29 offen offset:3072  lds
ds_read_b64_tr_b16 v[162:163], v27 offset:51200
v_exp_f32 v204, v116
v_mfma_f32_16x16x32_bf16 v[140:143], v[176:179], a[160:163], v[140:143]
ds_read_b64_tr_b16 v[164:165], v27 offset:53248
v_exp_f32 v205, v117
v_mfma_f32_16x16x32_bf16 v[140:143], v[180:183], a[164:167], v[140:143]
buffer_load_dwordx4 a[128:131], v22, s[12:15], s28 offen offset:0 sc1
ds_read_b64_tr_b16 v[166:167], v27 offset:55296
v_exp_f32 v206, v118
v_mfma_f32_16x16x32_bf16 v[140:143], v[184:187], a[168:171], v[140:143]
ds_read_b64_tr_b16 v[168:169], v27 offset:57344
v_exp_f32 v207, v119
v_mfma_f32_16x16x32_bf16 v[140:143], v[188:191], a[172:175], v[140:143]
ds_read_b64_tr_b16 v[170:171], v27 offset:59392
v_add_f32 v200, 1.0, v200
s_waitcnt lgkmcnt(6)
s_waitcnt vmcnt(22)
s_barrier
v_mfma_f32_16x16x32_bf16 v[128:131], v[144:147], a[48:51], v[128:131]
buffer_load_dwordx4 a[132:135], v22, s[12:15], s28 offen offset:1024 sc1
s_add_u32 s28, s30, 8192
ds_read_b64_tr_b16 v[172:173], v27 offset:61440
v_add_f32 v201, 1.0, v201
v_mfma_f32_16x16x32_bf16 v[128:131], v[148:151], a[52:55], v[128:131]
ds_read_b64_tr_b16 v[174:175], v27 offset:63488
v_add_f32 v202, 1.0, v202
v_mfma_f32_16x16x32_bf16 v[128:131], v[152:155], a[56:59], v[128:131]
ds_read_b64_tr_b16 v[176:177], v28 offset:0
v_add_f32 v203, 1.0, v203
v_mfma_f32_16x16x32_bf16 v[128:131], v[156:159], a[60:63], v[128:131]
buffer_load_dwordx4 a[8:11], v20, s[12:15], s28 offen offset:0 sc1
ds_read_b64_tr_b16 v[178:179], v28 offset:2048
v_add_f32 v204, 1.0, v204
v_mfma_f32_16x16x32_bf16 v[136:139], v[144:147], a[176:179], v[136:139]
s_waitcnt vmcnt(21)
buffer_store_dword v31, v30, s[12:15], s59 offen offset:8 sc1
ds_read_b64_tr_b16 v[180:181], v28 offset:4096
v_add_f32 v205, 1.0, v205
v_mfma_f32_16x16x32_bf16 v[136:139], v[148:151], a[180:183], v[136:139]
ds_read_b64_tr_b16 v[182:183], v28 offset:6144
v_add_f32 v206, 1.0, v206
v_mfma_f32_16x16x32_bf16 v[136:139], v[152:155], a[184:187], v[136:139]
buffer_load_dwordx4 a[12:15], v20, s[12:15], s28 offen offset:1024 sc1
s_add_u32 m0, s32, 65536
s_add_u32 s29, s20, 917504
buffer_load_dwordx4 v6, s[60:63], s29 offen offset:0  lds
ds_read_b64_tr_b16 v[184:185], v28 offset:8192
v_add_f32 v207, 1.0, v207
v_mfma_f32_16x16x32_bf16 v[136:139], v[156:159], a[188:191], v[136:139]
ds_read_b64_tr_b16 v[186:187], v28 offset:10240
v_rcp_f32 v200, v200
s_waitcnt lgkmcnt(6)
v_mfma_f32_16x16x32_bf16 v[132:135], v[160:163], a[48:51], v[132:135]
ds_read_b64_tr_b16 v[188:189], v28 offset:12288
v_rcp_f32 v201, v201
v_mfma_f32_16x16x32_bf16 v[132:135], v[164:167], a[52:55], v[132:135]
buffer_load_dwordx4 a[136:139], v22, s[12:15], s28 offen offset:0 sc1
buffer_load_dwordx4 v7, s[60:63], s29 offen offset:1024  lds
ds_read_b64_tr_b16 v[190:191], v28 offset:14336
v_rcp_f32 v202, v202
v_mfma_f32_16x16x32_bf16 v[132:135], v[168:171], a[56:59], v[132:135]
ds_read_b64_tr_b16 v[144:145], v29 offset:0
v_rcp_f32 v203, v203
v_mfma_f32_16x16x32_bf16 v[132:135], v[172:175], a[60:63], v[132:135]
ds_read_b64_tr_b16 v[146:147], v29 offset:2048
v_rcp_f32 v204, v204
v_mfma_f32_16x16x32_bf16 v[140:143], v[160:163], a[176:179], v[140:143]
buffer_load_dwordx4 a[140:143], v22, s[12:15], s28 offen offset:1024 sc1
s_add_u32 s28, s30, 14336
buffer_load_dwordx4 v8, s[60:63], s29 offen offset:2048  lds
ds_read_b64_tr_b16 v[148:149], v29 offset:4096
v_rcp_f32 v205, v205
v_mfma_f32_16x16x32_bf16 v[140:143], v[164:167], a[180:183], v[140:143]
ds_read_b64_tr_b16 v[150:151], v29 offset:6144
v_rcp_f32 v206, v206
v_mfma_f32_16x16x32_bf16 v[140:143], v[168:171], a[184:187], v[140:143]
ds_read_b64_tr_b16 v[152:153], v29 offset:8192
v_rcp_f32 v207, v207
v_mfma_f32_16x16x32_bf16 v[140:143], v[172:175], a[188:191], v[140:143]
buffer_load_dwordx4 a[16:19], v20, s[12:15], s28 offen offset:0 sc1
buffer_load_dwordx4 v18, s[60:63], s29 offen offset:3072  lds
s_add_u32 m0, s32, 81920
s_add_u32 s29, s21, 917504
ds_read_b64_tr_b16 v[154:155], v29 offset:10240
v_mul_f32 v200, v112, v200
s_waitcnt lgkmcnt(6)
v_mfma_f32_16x16x32_bf16 v[128:131], v[176:179], a[64:67], v[128:131]
ds_read_b64_tr_b16 v[156:157], v29 offset:12288
v_mul_f32 v201, v113, v201
v_mfma_f32_16x16x32_bf16 v[128:131], v[180:183], a[68:71], v[128:131]
ds_read_b64_tr_b16 v[158:159], v29 offset:14336
v_mul_f32 v202, v114, v202
v_mfma_f32_16x16x32_bf16 v[128:131], v[184:187], a[72:75], v[128:131]
buffer_load_dwordx4 a[20:23], v20, s[12:15], s28 offen offset:1024 sc1
buffer_load_dwordx4 v6, s[60:63], s29 offen offset:0  lds
ds_read_b64_tr_b16 v[160:161], v28 offset:16384
v_mul_f32 v203, v115, v203
v_mfma_f32_16x16x32_bf16 v[128:131], v[188:191], a[76:79], v[128:131]
ds_read_b64_tr_b16 v[162:163], v28 offset:18432
v_mul_f32 v204, v116, v204
v_mfma_f32_16x16x32_bf16 v[136:139], v[176:179], a[192:195], v[136:139]
ds_read_b64_tr_b16 v[164:165], v28 offset:20480
v_mul_f32 v205, v117, v205
v_mfma_f32_16x16x32_bf16 v[136:139], v[180:183], a[196:199], v[136:139]
buffer_load_dwordx4 a[144:147], v22, s[12:15], s28 offen offset:0 sc1
buffer_load_dwordx4 v7, s[60:63], s29 offen offset:1024  lds
ds_read_b64_tr_b16 v[166:167], v28 offset:22528
v_mul_f32 v206, v118, v206
v_mfma_f32_16x16x32_bf16 v[136:139], v[184:187], a[200:203], v[136:139]
ds_read_b64_tr_b16 v[168:169], v28 offset:24576
v_mul_f32 v207, v119, v207
v_mfma_f32_16x16x32_bf16 v[136:139], v[188:191], a[204:207], v[136:139]
ds_read_b64_tr_b16 v[170:171], v28 offset:26624
v_cvt_pk_bf16_f32 v112, v200, v201
s_waitcnt lgkmcnt(6)
v_mfma_f32_16x16x32_bf16 v[132:135], v[144:147], a[64:67], v[132:135]
buffer_load_dwordx4 a[148:151], v22, s[12:15], s28 offen offset:1024 sc1
s_add_u32 s28, s30, 22528
buffer_load_dwordx4 v8, s[60:63], s29 offen offset:2048  lds
ds_read_b64_tr_b16 v[172:173], v28 offset:28672
v_cvt_pk_bf16_f32 v113, v202, v203
v_mfma_f32_16x16x32_bf16 v[132:135], v[148:151], a[68:71], v[132:135]
ds_read_b64_tr_b16 v[174:175], v28 offset:30720
v_cvt_pk_bf16_f32 v114, v204, v205
v_mfma_f32_16x16x32_bf16 v[132:135], v[152:155], a[72:75], v[132:135]
ds_read_b64_tr_b16 v[176:177], v29 offset:16384
v_cvt_pk_bf16_f32 v115, v206, v207
v_mfma_f32_16x16x32_bf16 v[132:135], v[156:159], a[76:79], v[132:135]
buffer_load_dwordx4 a[24:27], v20, s[12:15], s28 offen offset:0 sc1
buffer_load_dwordx4 v18, s[60:63], s29 offen offset:3072  lds
ds_read_b64_tr_b16 v[178:179], v29 offset:18432
v_mfma_f32_16x16x32_bf16 v[140:143], v[144:147], a[192:195], v[140:143]
ds_read_b64_tr_b16 v[180:181], v29 offset:20480
v_exp_f32 v192, v104
v_mfma_f32_16x16x32_bf16 v[140:143], v[148:151], a[196:199], v[140:143]
ds_read_b64_tr_b16 v[182:183], v29 offset:22528
v_exp_f32 v193, v105
v_mfma_f32_16x16x32_bf16 v[140:143], v[152:155], a[200:203], v[140:143]
buffer_load_dwordx4 a[28:31], v20, s[12:15], s28 offen offset:1024 sc1
ds_read_b64_tr_b16 v[184:185], v29 offset:24576
v_exp_f32 v194, v106
v_mfma_f32_16x16x32_bf16 v[140:143], v[156:159], a[204:207], v[140:143]
ds_read_b64_tr_b16 v[186:187], v29 offset:26624
v_exp_f32 v195, v107
s_waitcnt lgkmcnt(6)
s_waitcnt vmcnt(31)
s_barrier
v_mfma_f32_16x16x32_bf16 v[128:131], v[160:163], a[80:83], v[128:131]
ds_read_b64_tr_b16 v[188:189], v29 offset:28672
v_exp_f32 v196, v108
v_mfma_f32_16x16x32_bf16 v[128:131], v[164:167], a[84:87], v[128:131]
buffer_load_dwordx4 a[152:155], v22, s[12:15], s28 offen offset:0 sc1
ds_read_b64_tr_b16 v[190:191], v29 offset:30720
v_exp_f32 v197, v109
v_mfma_f32_16x16x32_bf16 v[128:131], v[168:171], a[88:91], v[128:131]
ds_read_b64_tr_b16 v[144:145], v24 offset:0
v_exp_f32 v198, v110
v_mfma_f32_16x16x32_bf16 v[128:131], v[172:175], a[92:95], v[128:131]
ds_read_b64_tr_b16 v[146:147], v24 offset:2048
v_exp_f32 v199, v111
v_mfma_f32_16x16x32_bf16 v[136:139], v[160:163], a[208:211], v[136:139]
buffer_load_dwordx4 a[156:159], v22, s[12:15], s28 offen offset:1024 sc1
ds_read_b64_tr_b16 v[148:149], v24 offset:4096
v_add_f32 v192, 1.0, v192
v_mfma_f32_16x16x32_bf16 v[136:139], v[164:167], a[212:215], v[136:139]
ds_read_b64_tr_b16 v[150:151], v24 offset:6144
v_add_f32 v193, 1.0, v193
v_mfma_f32_16x16x32_bf16 v[136:139], v[168:171], a[216:219], v[136:139]
s_add_u32 m0, s32, 98304
s_add_u32 s29, s20, 131072
buffer_load_dwordx4 v6, s[60:63], s29 offen offset:0  lds
ds_read_b64_tr_b16 v[152:153], v24 offset:8192
v_add_f32 v194, 1.0, v194
v_mfma_f32_16x16x32_bf16 v[136:139], v[172:175], a[220:223], v[136:139]
ds_read_b64_tr_b16 v[154:155], v24 offset:10240
v_add_f32 v195, 1.0, v195
s_waitcnt lgkmcnt(6)
v_mfma_f32_16x16x32_bf16 v[132:135], v[176:179], a[80:83], v[132:135]
ds_read_b64_tr_b16 v[156:157], v24 offset:12288
v_add_f32 v196, 1.0, v196
v_mfma_f32_16x16x32_bf16 v[132:135], v[180:183], a[84:87], v[132:135]
buffer_load_dwordx4 v7, s[60:63], s29 offen offset:1024  lds
ds_read_b64_tr_b16 v[158:159], v24 offset:14336
v_add_f32 v197, 1.0, v197
v_mfma_f32_16x16x32_bf16 v[132:135], v[184:187], a[88:91], v[132:135]
ds_read_b64_tr_b16 v[160:161], v25 offset:0
v_add_f32 v198, 1.0, v198
v_mfma_f32_16x16x32_bf16 v[132:135], v[188:191], a[92:95], v[132:135]
ds_read_b64_tr_b16 v[162:163], v25 offset:2048
v_add_f32 v199, 1.0, v199
v_mfma_f32_16x16x32_bf16 v[140:143], v[176:179], a[208:211], v[140:143]
buffer_load_dwordx4 v8, s[60:63], s29 offen offset:2048  lds
ds_read_b64_tr_b16 v[164:165], v25 offset:4096
v_rcp_f32 v192, v192
v_mfma_f32_16x16x32_bf16 v[140:143], v[180:183], a[212:215], v[140:143]
ds_read_b64_tr_b16 v[166:167], v25 offset:6144
v_rcp_f32 v193, v193
v_mfma_f32_16x16x32_bf16 v[140:143], v[184:187], a[216:219], v[140:143]
ds_read_b64_tr_b16 v[168:169], v25 offset:8192
v_rcp_f32 v194, v194
v_mfma_f32_16x16x32_bf16 v[140:143], v[188:191], a[220:223], v[140:143]
buffer_load_dwordx4 v18, s[60:63], s29 offen offset:3072  lds
s_add_u32 m0, s32, 114688
s_add_u32 s29, s21, 131072
ds_read_b64_tr_b16 v[170:171], v25 offset:10240
v_rcp_f32 v195, v195
s_waitcnt lgkmcnt(6)
v_mfma_f32_16x16x32_bf16 v[128:131], v[144:147], a[96:99], v[128:131]
ds_read_b64_tr_b16 v[172:173], v25 offset:12288
v_rcp_f32 v196, v196
v_mfma_f32_16x16x32_bf16 v[128:131], v[148:151], a[100:103], v[128:131]
ds_read_b64_tr_b16 v[174:175], v25 offset:14336
v_rcp_f32 v197, v197
v_mfma_f32_16x16x32_bf16 v[128:131], v[152:155], a[104:107], v[128:131]
buffer_load_dwordx4 v6, s[60:63], s29 offen offset:0  lds
ds_read_b64_tr_b16 v[176:177], v24 offset:16384
v_rcp_f32 v198, v198
v_mfma_f32_16x16x32_bf16 v[128:131], v[156:159], a[108:111], v[128:131]
ds_read_b64_tr_b16 v[178:179], v24 offset:18432
v_rcp_f32 v199, v199
v_mfma_f32_16x16x32_bf16 v[136:139], v[144:147], a[224:227], v[136:139]
ds_read_b64_tr_b16 v[180:181], v24 offset:20480
v_mul_f32 v192, v104, v192
v_mfma_f32_16x16x32_bf16 v[136:139], v[148:151], a[228:231], v[136:139]
buffer_load_dwordx4 v7, s[60:63], s29 offen offset:1024  lds
ds_read_b64_tr_b16 v[182:183], v24 offset:22528
v_mul_f32 v193, v105, v193
v_mfma_f32_16x16x32_bf16 v[136:139], v[152:155], a[232:235], v[136:139]
ds_read_b64_tr_b16 v[184:185], v24 offset:24576
v_mul_f32 v194, v106, v194
v_mfma_f32_16x16x32_bf16 v[136:139], v[156:159], a[236:239], v[136:139]
ds_read_b64_tr_b16 v[186:187], v24 offset:26624
v_mul_f32 v195, v107, v195
s_waitcnt lgkmcnt(6)
v_mfma_f32_16x16x32_bf16 v[132:135], v[160:163], a[96:99], v[132:135]
buffer_load_dwordx4 v8, s[60:63], s29 offen offset:2048  lds
ds_read_b64_tr_b16 v[188:189], v24 offset:28672
v_mul_f32 v196, v108, v196
v_mfma_f32_16x16x32_bf16 v[132:135], v[164:167], a[100:103], v[132:135]
ds_read_b64_tr_b16 v[190:191], v24 offset:30720
v_mul_f32 v197, v109, v197
v_mfma_f32_16x16x32_bf16 v[132:135], v[168:171], a[104:107], v[132:135]
ds_read_b64_tr_b16 v[144:145], v25 offset:16384
v_mul_f32 v198, v110, v198
v_mfma_f32_16x16x32_bf16 v[132:135], v[172:175], a[108:111], v[132:135]
buffer_load_dwordx4 v18, s[60:63], s29 offen offset:3072  lds
ds_read_b64_tr_b16 v[146:147], v25 offset:18432
v_mul_f32 v199, v111, v199
v_mfma_f32_16x16x32_bf16 v[140:143], v[160:163], a[224:227], v[140:143]
ds_read_b64_tr_b16 v[148:149], v25 offset:20480
v_cvt_pk_bf16_f32 v104, v192, v193
v_mfma_f32_16x16x32_bf16 v[140:143], v[164:167], a[228:231], v[140:143]
ds_read_b64_tr_b16 v[150:151], v25 offset:22528
v_cvt_pk_bf16_f32 v105, v194, v195
v_mfma_f32_16x16x32_bf16 v[140:143], v[168:171], a[232:235], v[140:143]
s_buffer_load_dword s45, s[12:15], s40 offset:262152 glc
s_buffer_load_dword s46, s[12:15], s40 offset:266248 glc
s_buffer_load_dword s47, s[12:15], s40 offset:270344 glc
s_buffer_load_dword s101, s[12:15], s40 offset:274440 glc
ds_read_b64_tr_b16 v[152:153], v25 offset:24576
v_cvt_pk_bf16_f32 v106, v196, v197
v_mfma_f32_16x16x32_bf16 v[140:143], v[172:175], a[236:239], v[140:143]
ds_read_b64_tr_b16 v[154:155], v25 offset:26624
v_cvt_pk_bf16_f32 v107, v198, v199
s_waitcnt lgkmcnt(6)
s_waitcnt vmcnt(22)
s_barrier
v_mfma_f32_16x16x32_bf16 v[128:131], v[176:179], a[112:115], v[128:131]
ds_read_b64_tr_b16 v[156:157], v25 offset:28672
v_exp_f32 v200, v120
v_mfma_f32_16x16x32_bf16 v[128:131], v[180:183], a[116:119], v[128:131]
ds_read_b64_tr_b16 v[158:159], v25 offset:30720
v_exp_f32 v201, v121
v_mfma_f32_16x16x32_bf16 v[128:131], v[184:187], a[120:123], v[128:131]
ds_read_b64_tr_b16 v[160:161], v2 offset:32768
v_exp_f32 v202, v122
v_mfma_f32_16x16x32_bf16 v[128:131], v[188:191], a[124:127], v[128:131]
ds_read_b64_tr_b16 v[162:163], v2 offset:34816
v_exp_f32 v203, v123
v_mfma_f32_16x16x32_bf16 v[136:139], v[176:179], a[240:243], v[136:139]
ds_read_b64_tr_b16 v[164:165], v2 offset:36864
v_exp_f32 v204, v124
v_mfma_f32_16x16x32_bf16 v[136:139], v[180:183], a[244:247], v[136:139]
ds_read_b64_tr_b16 v[166:167], v2 offset:38912
v_exp_f32 v205, v125
v_mfma_f32_16x16x32_bf16 v[136:139], v[184:187], a[248:251], v[136:139]
s_add_u32 m0, s32, 131072
s_add_u32 s29, s20, 1048576
buffer_load_dwordx4 v6, s[60:63], s29 offen offset:0  lds
ds_read_b64_tr_b16 v[168:169], v2 offset:40960
v_exp_f32 v206, v126
v_mfma_f32_16x16x32_bf16 v[136:139], v[188:191], a[252:255], v[136:139]
ds_read_b64_tr_b16 v[170:171], v2 offset:43008
v_exp_f32 v207, v127
s_waitcnt lgkmcnt(6)
v_mfma_f32_16x16x32_bf16 v[132:135], v[144:147], a[112:115], v[132:135]
ds_read_b64_tr_b16 v[172:173], v2 offset:45056
v_add_f32 v200, 1.0, v200
v_mfma_f32_16x16x32_bf16 v[132:135], v[148:151], a[116:119], v[132:135]
buffer_load_dwordx4 v7, s[60:63], s29 offen offset:1024  lds
ds_read_b64_tr_b16 v[174:175], v2 offset:47104
v_add_f32 v201, 1.0, v201
v_mfma_f32_16x16x32_bf16 v[132:135], v[152:155], a[120:123], v[132:135]
ds_read_b64_tr_b16 v[176:177], v3 offset:32768
v_add_f32 v202, 1.0, v202
v_mfma_f32_16x16x32_bf16 v[132:135], v[156:159], a[124:127], v[132:135]
ds_read_b64_tr_b16 v[178:179], v3 offset:34816
v_add_f32 v203, 1.0, v203
v_mfma_f32_16x16x32_bf16 v[140:143], v[144:147], a[240:243], v[140:143]
buffer_load_dwordx4 v8, s[60:63], s29 offen offset:2048  lds
ds_read_b64_tr_b16 v[180:181], v3 offset:36864
v_add_f32 v204, 1.0, v204
v_mfma_f32_16x16x32_bf16 v[140:143], v[148:151], a[244:247], v[140:143]
ds_read_b64_tr_b16 v[182:183], v3 offset:38912
v_add_f32 v205, 1.0, v205
v_mfma_f32_16x16x32_bf16 v[140:143], v[152:155], a[248:251], v[140:143]
ds_read_b64_tr_b16 v[184:185], v3 offset:40960
v_add_f32 v206, 1.0, v206
v_mfma_f32_16x16x32_bf16 v[140:143], v[156:159], a[252:255], v[140:143]
buffer_load_dwordx4 v18, s[60:63], s29 offen offset:3072  lds
s_add_u32 m0, s32, 147456
s_add_u32 s29, s21, 1048576
ds_read_b64_tr_b16 v[186:187], v3 offset:43008
v_add_f32 v207, 1.0, v207
s_waitcnt lgkmcnt(6)
v_mfma_f32_16x16x32_bf16 v[32:35], v[160:163], a[0:3], 0
ds_read_b64_tr_b16 v[188:189], v3 offset:45056
v_rcp_f32 v200, v200
v_mfma_f32_16x16x32_bf16 v[32:35], v[164:167], a[4:7], v[32:35]
ds_read_b64_tr_b16 v[190:191], v3 offset:47104
v_rcp_f32 v201, v201
v_mfma_f32_16x16x32_bf16 v[32:35], v[168:171], a[8:11], v[32:35]
buffer_load_dwordx4 v6, s[60:63], s29 offen offset:0  lds
ds_read_b64_tr_b16 v[144:145], v4 offset:32768
v_rcp_f32 v202, v202
v_mfma_f32_16x16x32_bf16 v[32:35], v[172:175], a[12:15], v[32:35]
ds_read_b64_tr_b16 v[146:147], v4 offset:34816
v_rcp_f32 v203, v203
v_mfma_f32_16x16x32_bf16 v[48:51], v[160:163], a[128:131], 0
ds_read_b64_tr_b16 v[148:149], v4 offset:36864
v_rcp_f32 v204, v204
v_mfma_f32_16x16x32_bf16 v[48:51], v[164:167], a[132:135], v[48:51]
buffer_load_dwordx4 v7, s[60:63], s29 offen offset:1024  lds
ds_read_b64_tr_b16 v[150:151], v4 offset:38912
v_rcp_f32 v205, v205
v_mfma_f32_16x16x32_bf16 v[48:51], v[168:171], a[136:139], v[48:51]
ds_read_b64_tr_b16 v[152:153], v4 offset:40960
v_rcp_f32 v206, v206
v_mfma_f32_16x16x32_bf16 v[48:51], v[172:175], a[140:143], v[48:51]
ds_read_b64_tr_b16 v[154:155], v4 offset:43008
v_rcp_f32 v207, v207
s_waitcnt lgkmcnt(6)
v_mfma_f32_16x16x32_bf16 v[36:39], v[176:179], a[0:3], 0
buffer_load_dwordx4 v8, s[60:63], s29 offen offset:2048  lds
ds_read_b64_tr_b16 v[156:157], v4 offset:45056
v_mul_f32 v200, v120, v200
v_mfma_f32_16x16x32_bf16 v[36:39], v[180:183], a[4:7], v[36:39]
ds_read_b64_tr_b16 v[158:159], v4 offset:47104
v_mul_f32 v201, v121, v201
v_mfma_f32_16x16x32_bf16 v[36:39], v[184:187], a[8:11], v[36:39]
ds_read_b64_tr_b16 v[160:161], v5 offset:32768
v_mul_f32 v202, v122, v202
v_mfma_f32_16x16x32_bf16 v[36:39], v[188:191], a[12:15], v[36:39]
ds_read_b64_tr_b16 v[162:163], v5 offset:34816
v_mul_f32 v203, v123, v203
v_mfma_f32_16x16x32_bf16 v[52:55], v[176:179], a[128:131], 0
ds_read_b64_tr_b16 v[164:165], v5 offset:36864
v_mul_f32 v204, v124, v204
v_mfma_f32_16x16x32_bf16 v[52:55], v[180:183], a[132:135], v[52:55]
ds_read_b64_tr_b16 v[166:167], v5 offset:38912
v_mul_f32 v205, v125, v205
v_mfma_f32_16x16x32_bf16 v[52:55], v[184:187], a[136:139], v[52:55]
buffer_load_dwordx4 v18, s[60:63], s29 offen offset:3072  lds
ds_read_b64_tr_b16 v[168:169], v5 offset:40960
v_mul_f32 v206, v126, v206
v_mfma_f32_16x16x32_bf16 v[52:55], v[188:191], a[140:143], v[52:55]
ds_read_b64_tr_b16 v[170:171], v5 offset:43008
v_mul_f32 v207, v127, v207
s_waitcnt lgkmcnt(6)
s_barrier
v_mfma_f32_16x16x32_bf16 v[40:43], v[144:147], a[0:3], 0
ds_read_b64_tr_b16 v[172:173], v5 offset:45056
v_cvt_pk_bf16_f32 v120, v200, v201
v_mfma_f32_16x16x32_bf16 v[40:43], v[148:151], a[4:7], v[40:43]
ds_read_b64_tr_b16 v[174:175], v5 offset:47104
v_cvt_pk_bf16_f32 v121, v202, v203
v_mfma_f32_16x16x32_bf16 v[40:43], v[152:155], a[8:11], v[40:43]
ds_read_b64_tr_b16 v[176:177], v2 offset:49152
v_cvt_pk_bf16_f32 v122, v204, v205
v_mfma_f32_16x16x32_bf16 v[40:43], v[156:159], a[12:15], v[40:43]
ds_read_b64_tr_b16 v[178:179], v2 offset:51200
s_add_u32 m0, s32, 0
v_mfma_f32_16x16x32_bf16 v[56:59], v[144:147], a[128:131], 0
ds_read_b64_tr_b16 v[180:181], v2 offset:53248
v_cvt_pk_bf16_f32 v123, v206, v207
v_exp_f32 v192, v128
v_mfma_f32_16x16x32_bf16 v[56:59], v[148:151], a[132:135], v[56:59]
ds_read_b64_tr_b16 v[182:183], v2 offset:55296
v_exp_f32 v193, v129
v_mfma_f32_16x16x32_bf16 v[56:59], v[152:155], a[136:139], v[56:59]
s_add_u32 s29, s22, 0
buffer_load_dwordx4 v6, s[60:63], s29 offen offset:0  lds
ds_read_b64_tr_b16 v[184:185], v2 offset:57344
v_exp_f32 v194, v130
v_exp_f32 v195, v131
v_mfma_f32_16x16x32_bf16 v[56:59], v[156:159], a[140:143], v[56:59]
ds_read_b64_tr_b16 v[186:187], v2 offset:59392
v_exp_f32 v196, v132
s_waitcnt lgkmcnt(6)
v_mfma_f32_16x16x32_bf16 v[44:47], v[160:163], a[0:3], 0
ds_read_b64_tr_b16 v[188:189], v2 offset:61440
v_exp_f32 v197, v133
v_exp_f32 v198, v134
v_mfma_f32_16x16x32_bf16 v[44:47], v[164:167], a[4:7], v[44:47]
ds_read_b64_tr_b16 v[190:191], v2 offset:63488
v_exp_f32 v199, v135
v_mfma_f32_16x16x32_bf16 v[44:47], v[168:171], a[8:11], v[44:47]
s_waitcnt lgkmcnt(0)
s_and_b32 s45, s45, s46
s_and_b32 s45, s45, s47
s_and_b32 s45, s45, s101
s_cbranch_scc1 mlp_kernel_q6_ok
s_mov_b32 s27, 0x40000
mlp_kernel_q6:
s_sleep 4
s_buffer_load_dword s45, s[12:15], s40 offset:262152 glc
s_buffer_load_dword s46, s[12:15], s40 offset:266248 glc
s_buffer_load_dword s47, s[12:15], s40 offset:270344 glc
s_buffer_load_dword s101, s[12:15], s40 offset:274440 glc
s_waitcnt lgkmcnt(0)
s_sub_u32 s27, s27, 1
s_cbranch_scc1 mlp_kernel_q6_ok
s_and_b32 s45, s45, s46
s_and_b32 s45, s45, s47
s_and_b32 s45, s45, s101
s_cbranch_scc0 mlp_kernel_q6
mlp_kernel_q6_ok:
s_add_u32 s28, s30, 2048
buffer_load_dwordx4 a[32:35], v20, s[12:15], s28 offen offset:0 sc1
ds_read_b64_tr_b16 v[144:145], v3 offset:49152
v_add_f32 v192, 1.0, v192
v_add_f32 v193, 1.0, v193
v_mfma_f32_16x16x32_bf16 v[44:47], v[172:175], a[12:15], v[44:47]
ds_read_b64_tr_b16 v[146:147], v3 offset:51200
v_add_f32 v194, 1.0, v194
v_mfma_f32_16x16x32_bf16 v[60:63], v[160:163], a[128:131], 0
ds_read_b64_tr_b16 v[148:149], v3 offset:53248
v_add_f32 v195, 1.0, v195
v_mfma_f32_16x16x32_bf16 v[60:63], v[164:167], a[132:135], v[60:63]
buffer_load_dwordx4 a[36:39], v20, s[12:15], s28 offen offset:1024 sc1
ds_read_b64_tr_b16 v[150:151], v3 offset:55296
v_add_f32 v196, 1.0, v196
v_add_f32 v197, 1.0, v197
v_mfma_f32_16x16x32_bf16 v[60:63], v[168:171], a[136:139], v[60:63]
buffer_load_dwordx4 v7, s[60:63], s29 offen offset:1024  lds
ds_read_b64_tr_b16 v[152:153], v3 offset:57344
v_add_f32 v198, 1.0, v198
v_mfma_f32_16x16x32_bf16 v[60:63], v[172:175], a[140:143], v[60:63]
ds_read_b64_tr_b16 v[154:155], v3 offset:59392
v_add_f32 v199, 1.0, v199
v_rcp_f32 v192, v192
v_mfma_f32_16x16x32_bf16 v[64:67], v[176:179], a[0:3], 0
buffer_load_dwordx4 a[160:163], v22, s[12:15], s28 offen offset:0 sc1
ds_read_b64_tr_b16 v[156:157], v3 offset:61440
v_rcp_f32 v193, v193
v_mfma_f32_16x16x32_bf16 v[64:67], v[180:183], a[4:7], v[64:67]
ds_read_b64_tr_b16 v[158:159], v3 offset:63488
v_rcp_f32 v194, v194
v_rcp_f32 v195, v195
v_mfma_f32_16x16x32_bf16 v[64:67], v[184:187], a[8:11], v[64:67]
ds_read_b64_tr_b16 v[160:161], v4 offset:49152
v_rcp_f32 v196, v196
v_mfma_f32_16x16x32_bf16 v[64:67], v[188:191], a[12:15], v[64:67]
buffer_load_dwordx4 a[164:167], v22, s[12:15], s28 offen offset:1024 sc1
s_add_u32 s28, s30, 10240
ds_read_b64_tr_b16 v[162:163], v4 offset:51200
v_rcp_f32 v197, v197
v_rcp_f32 v198, v198
v_mfma_f32_16x16x32_bf16 v[80:83], v[176:179], a[128:131], 0
ds_read_b64_tr_b16 v[164:165], v4 offset:53248
v_rcp_f32 v199, v199
v_mfma_f32_16x16x32_bf16 v[80:83], v[180:183], a[132:135], v[80:83]
ds_read_b64_tr_b16 v[166:167], v4 offset:55296
v_mul_f32 v192, v128, v192
v_mfma_f32_16x16x32_bf16 v[80:83], v[184:187], a[136:139], v[80:83]
buffer_load_dwordx4 a[40:43], v20, s[12:15], s28 offen offset:0 sc1
buffer_load_dwordx4 v8, s[60:63], s29 offen offset:2048  lds
ds_read_b64_tr_b16 v[168:169], v4 offset:57344
v_mul_f32 v193, v129, v193
v_mul_f32 v194, v130, v194
v_mfma_f32_16x16x32_bf16 v[80:83], v[188:191], a[140:143], v[80:83]
ds_read_b64_tr_b16 v[170:171], v4 offset:59392
v_mul_f32 v195, v131, v195
s_waitcnt lgkmcnt(6)
v_mfma_f32_16x16x32_bf16 v[68:71], v[144:147], a[0:3], 0
ds_read_b64_tr_b16 v[172:173], v4 offset:61440
v_mul_f32 v196, v132, v196
v_mul_f32 v197, v133, v197
v_mfma_f32_16x16x32_bf16 v[68:71], v[148:151], a[4:7], v[68:71]
buffer_load_dwordx4 a[44:47], v20, s[12:15], s28 offen offset:1024 sc1
ds_read_b64_tr_b16 v[174:175], v4 offset:63488
v_mul_f32 v198, v134, v198
v_mfma_f32_16x16x32_bf16 v[68:71], v[152:155], a[8:11], v[68:71]
ds_read_b64_tr_b16 v[176:177], v5 offset:49152
v_mul_f32 v199, v135, v199
v_cvt_pk_bf16_f32 v128, v192, v193
v_mfma_f32_16x16x32_bf16 v[68:71], v[156:159], a[12:15], v[68:71]
ds_read_b64_tr_b16 v[178:179], v5 offset:51200
v_cvt_pk_bf16_f32 v129, v194, v195
v_mfma_f32_16x16x32_bf16 v[84:87], v[144:147], a[128:131], 0
buffer_load_dwordx4 a[168:171], v22, s[12:15], s28 offen offset:0 sc1
ds_read_b64_tr_b16 v[180:181], v5 offset:53248
v_cvt_pk_bf16_f32 v130, v196, v197
v_mfma_f32_16x16x32_bf16 v[84:87], v[148:151], a[132:135], v[84:87]
ds_read_b64_tr_b16 v[182:183], v5 offset:55296
v_cvt_pk_bf16_f32 v131, v198, v199
v_exp_f32 v200, v136
v_mfma_f32_16x16x32_bf16 v[84:87], v[152:155], a[136:139], v[84:87]
buffer_load_dwordx4 v18, s[60:63], s29 offen offset:3072  lds
ds_read_b64_tr_b16 v[184:185], v5 offset:57344
v_exp_f32 v201, v137
v_mfma_f32_16x16x32_bf16 v[84:87], v[156:159], a[140:143], v[84:87]
buffer_load_dwordx4 a[172:175], v22, s[12:15], s28 offen offset:1024 sc1
s_add_u32 s28, s30, 16384
ds_read_b64_tr_b16 v[186:187], v5 offset:59392
v_exp_f32 v202, v138
v_exp_f32 v203, v139
s_waitcnt lgkmcnt(6)
s_waitcnt vmcnt(28)
s_barrier
v_mfma_f32_16x16x32_bf16 v[72:75], v[160:163], a[0:3], 0
ds_read_b64_tr_b16 v[188:189], v5 offset:61440
v_exp_f32 v204, v140
v_mfma_f32_16x16x32_bf16 v[72:75], v[164:167], a[4:7], v[72:75]
ds_read_b64_tr_b16 v[190:191], v5 offset:63488
v_exp_f32 v205, v141
v_exp_f32 v206, v142
v_mfma_f32_16x16x32_bf16 v[72:75], v[168:171], a[8:11], v[72:75]
buffer_load_dwordx4 a[48:51], v20, s[12:15], s28 offen offset:0 sc1
ds_read_b64_tr_b16 v[144:145], v10 offset:0
v_exp_f32 v207, v143
v_mfma_f32_16x16x32_bf16 v[72:75], v[172:175], a[12:15], v[72:75]
ds_read_b64_tr_b16 v[146:147], v10 offset:2048
v_add_f32 v200, 1.0, v200
v_add_f32 v201, 1.0, v201
v_mfma_f32_16x16x32_bf16 v[88:91], v[160:163], a[128:131], 0
ds_read_b64_tr_b16 v[148:149], v10 offset:4096
v_add_f32 v202, 1.0, v202
v_mfma_f32_16x16x32_bf16 v[88:91], v[164:167], a[132:135], v[88:91]
buffer_load_dwordx4 a[52:55], v20, s[12:15], s28 offen offset:1024 sc1
ds_read_b64_tr_b16 v[150:151], v10 offset:6144
v_add_f32 v203, 1.0, v203
v_mfma_f32_16x16x32_bf16 v[88:91], v[168:171], a[136:139], v[88:91]
s_add_u32 m0, s32, 16384
s_add_u32 s29, s22, 917504
buffer_load_dwordx4 v6, s[60:63], s29 offen offset:0  lds
ds_read_b64_tr_b16 v[152:153], v10 offset:8192
v_add_f32 v204, 1.0, v204
v_add_f32 v205, 1.0, v205
v_mfma_f32_16x16x32_bf16 v[88:91], v[172:175], a[140:143], v[88:91]
ds_read_b64_tr_b16 v[154:155], v10 offset:10240
v_add_f32 v206, 1.0, v206
s_waitcnt lgkmcnt(6)
v_mfma_f32_16x16x32_bf16 v[76:79], v[176:179], a[0:3], 0
buffer_load_dwordx4 a[176:179], v22, s[12:15], s28 offen offset:0 sc1
ds_read_b64_tr_b16 v[156:157], v10 offset:12288
v_add_f32 v207, 1.0, v207
v_rcp_f32 v200, v200
v_mfma_f32_16x16x32_bf16 v[76:79], v[180:183], a[4:7], v[76:79]
ds_read_b64_tr_b16 v[158:159], v10 offset:14336
v_rcp_f32 v201, v201
v_mfma_f32_16x16x32_bf16 v[76:79], v[184:187], a[8:11], v[76:79]
ds_read_b64_tr_b16 v[160:161], v11 offset:0
v_rcp_f32 v202, v202
v_rcp_f32 v203, v203
v_mfma_f32_16x16x32_bf16 v[76:79], v[188:191], a[12:15], v[76:79]
buffer_load_dwordx4 a[180:183], v22, s[12:15], s28 offen offset:1024 sc1
s_add_u32 s28, s30, 24576
ds_read_b64_tr_b16 v[162:163], v11 offset:2048
v_rcp_f32 v204, v204
v_mfma_f32_16x16x32_bf16 v[92:95], v[176:179], a[128:131], 0
ds_read_b64_tr_b16 v[164:165], v11 offset:4096
v_rcp_f32 v205, v205
v_rcp_f32 v206, v206
v_mfma_f32_16x16x32_bf16 v[92:95], v[180:183], a[132:135], v[92:95]
ds_read_b64_tr_b16 v[166:167], v11 offset:6144
v_rcp_f32 v207, v207
v_mfma_f32_16x16x32_bf16 v[92:95], v[184:187], a[136:139], v[92:95]
buffer_load_dwordx4 a[56:59], v20, s[12:15], s28 offen offset:0 sc1
buffer_load_dwordx4 v7, s[60:63], s29 offen offset:1024  lds
ds_read_b64_tr_b16 v[168:169], v11 offset:8192
v_mul_f32 v200, v136, v200
v_mfma_f32_16x16x32_bf16 v[92:95], v[188:191], a[140:143], v[92:95]
ds_read_b64_tr_b16 v[170:171], v11 offset:10240
v_mul_f32 v201, v137, v201
v_mul_f32 v202, v138, v202
s_waitcnt lgkmcnt(6)
v_mfma_f32_16x16x32_bf16 v[32:35], v[144:147], a[16:19], v[32:35]
ds_read_b64_tr_b16 v[172:173], v11 offset:12288
v_mul_f32 v203, v139, v203
v_mfma_f32_16x16x32_bf16 v[32:35], v[148:151], a[20:23], v[32:35]
buffer_load_dwordx4 a[60:63], v20, s[12:15], s28 offen offset:1024 sc1
ds_read_b64_tr_b16 v[174:175], v11 offset:14336
v_mul_f32 v204, v140, v204
v_mul_f32 v205, v141, v205
v_mfma_f32_16x16x32_bf16 v[32:35], v[152:155], a[24:27], v[32:35]
ds_read_b64_tr_b16 v[176:177], v12 offset:0
v_mul_f32 v206, v142, v206
v_mfma_f32_16x16x32_bf16 v[32:35], v[156:159], a[28:31], v[32:35]
ds_read_b64_tr_b16 v[178:179], v12 offset:2048
v_mul_f32 v207, v143, v207
v_cvt_pk_bf16_f32 v136, v200, v201
v_mfma_f32_16x16x32_bf16 v[48:51], v[144:147], a[144:147], v[48:51]
buffer_load_dwordx4 a[184:187], v22, s[12:15], s28 offen offset:0 sc1
ds_read_b64_tr_b16 v[180:181], v12 offset:4096
v_cvt_pk_bf16_f32 v137, v202, v203
v_mfma_f32_16x16x32_bf16 v[48:51], v[148:151], a[148:151], v[48:51]
ds_read_b64_tr_b16 v[182:183], v12 offset:6144
v_cvt_pk_bf16_f32 v138, v204, v205
v_mfma_f32_16x16x32_bf16 v[48:51], v[152:155], a[152:155], v[48:51]
buffer_load_dwordx4 v8, s[60:63], s29 offen offset:2048  lds
ds_read_b64_tr_b16 v[184:185], v12 offset:8192
v_cvt_pk_bf16_f32 v139, v206, v207
v_mfma_f32_16x16x32_bf16 v[48:51], v[156:159], a[156:159], v[48:51]
buffer_load_dwordx4 a[188:191], v22, s[12:15], s28 offen offset:1024 sc1
ds_read_b64_tr_b16 v[186:187], v12 offset:10240
s_waitcnt lgkmcnt(6)
v_mfma_f32_16x16x32_bf16 v[36:39], v[160:163], a[16:19], v[36:39]
buffer_store_dwordx4 v[96:99], v20, s[12:15], s38 offen offset:0 sc1
ds_read_b64_tr_b16 v[188:189], v12 offset:12288
v_mfma_f32_16x16x32_bf16 v[36:39], v[164:167], a[20:23], v[36:39]
ds_read_b64_tr_b16 v[190:191], v12 offset:14336
ds_read_b64_tr_b16 v[144:145], v13 offset:0
v_mfma_f32_16x16x32_bf16 v[36:39], v[168:171], a[24:27], v[36:39]
buffer_load_dwordx4 v18, s[60:63], s29 offen offset:3072  lds
v_mfma_f32_16x16x32_bf16 v[36:39], v[172:175], a[28:31], v[36:39]
ds_read_b64_tr_b16 v[146:147], v13 offset:2048
ds_read_b64_tr_b16 v[148:149], v13 offset:4096
v_mfma_f32_16x16x32_bf16 v[52:55], v[160:163], a[144:147], v[52:55]
ds_read_b64_tr_b16 v[150:151], v13 offset:6144
ds_read_b64_tr_b16 v[152:153], v13 offset:8192
v_mfma_f32_16x16x32_bf16 v[52:55], v[164:167], a[148:151], v[52:55]
ds_read_b64_tr_b16 v[154:155], v13 offset:10240
ds_read_b64_tr_b16 v[156:157], v13 offset:12288
v_mfma_f32_16x16x32_bf16 v[52:55], v[168:171], a[152:155], v[52:55]
ds_read_b64_tr_b16 v[158:159], v13 offset:14336
v_mfma_f32_16x16x32_bf16 v[52:55], v[172:175], a[156:159], v[52:55]
s_waitcnt lgkmcnt(8)
s_barrier
v_mfma_f32_16x16x32_bf16 v[40:43], v[176:179], a[16:19], v[40:43]
s_add_u32 m0, s32, 32768
s_add_u32 s29, s22, 131072
v_mfma_f32_16x16x32_bf16 v[40:43], v[180:183], a[20:23], v[40:43]
buffer_load_dwordx4 v6, s[60:63], s29 offen offset:0  lds
v_mfma_f32_16x16x32_bf16 v[40:43], v[184:187], a[24:27], v[40:43]
ds_read_b64_tr_b16 v[160:161], v10 offset:16384
ds_read_b64_tr_b16 v[162:163], v10 offset:18432
v_mfma_f32_16x16x32_bf16 v[40:43], v[188:191], a[28:31], v[40:43]
ds_read_b64_tr_b16 v[164:165], v10 offset:20480
ds_read_b64_tr_b16 v[166:167], v10 offset:22528
v_mfma_f32_16x16x32_bf16 v[56:59], v[176:179], a[144:147], v[56:59]
buffer_store_dwordx4 v[112:115], v22, s[12:15], s38 offen offset:0 sc1
v_mfma_f32_16x16x32_bf16 v[56:59], v[180:183], a[148:151], v[56:59]
ds_read_b64_tr_b16 v[168:169], v10 offset:24576
ds_read_b64_tr_b16 v[170:171], v10 offset:26624
v_mfma_f32_16x16x32_bf16 v[56:59], v[184:187], a[152:155], v[56:59]
ds_read_b64_tr_b16 v[172:173], v10 offset:28672
ds_read_b64_tr_b16 v[174:175], v10 offset:30720
v_mfma_f32_16x16x32_bf16 v[56:59], v[188:191], a[156:159], v[56:59]
s_waitcnt lgkmcnt(8)
v_mfma_f32_16x16x32_bf16 v[44:47], v[144:147], a[16:19], v[44:47]
buffer_load_dwordx4 v7, s[60:63], s29 offen offset:1024  lds
v_mfma_f32_16x16x32_bf16 v[44:47], v[148:151], a[20:23], v[44:47]
ds_read_b64_tr_b16 v[176:177], v11 offset:16384
ds_read_b64_tr_b16 v[178:179], v11 offset:18432
v_mfma_f32_16x16x32_bf16 v[44:47], v[152:155], a[24:27], v[44:47]
ds_read_b64_tr_b16 v[180:181], v11 offset:20480
ds_read_b64_tr_b16 v[182:183], v11 offset:22528
v_mfma_f32_16x16x32_bf16 v[44:47], v[156:159], a[28:31], v[44:47]
ds_read_b64_tr_b16 v[184:185], v11 offset:24576
v_mfma_f32_16x16x32_bf16 v[60:63], v[144:147], a[144:147], v[60:63]
ds_read_b64_tr_b16 v[186:187], v11 offset:26624
v_mfma_f32_16x16x32_bf16 v[60:63], v[148:151], a[148:151], v[60:63]
ds_read_b64_tr_b16 v[188:189], v11 offset:28672
v_mfma_f32_16x16x32_bf16 v[60:63], v[152:155], a[152:155], v[60:63]
ds_read_b64_tr_b16 v[190:191], v11 offset:30720
v_mfma_f32_16x16x32_bf16 v[60:63], v[156:159], a[156:159], v[60:63]
s_waitcnt lgkmcnt(8)
v_mfma_f32_16x16x32_bf16 v[64:67], v[160:163], a[16:19], v[64:67]
buffer_store_dwordx4 v[104:107], v20, s[12:15], s38 offen offset:1024 sc1
v_mfma_f32_16x16x32_bf16 v[64:67], v[164:167], a[20:23], v[64:67]
buffer_load_dwordx4 v8, s[60:63], s29 offen offset:2048  lds
v_mfma_f32_16x16x32_bf16 v[64:67], v[168:171], a[24:27], v[64:67]
ds_read_b64_tr_b16 v[144:145], v12 offset:16384
ds_read_b64_tr_b16 v[146:147], v12 offset:18432
v_mfma_f32_16x16x32_bf16 v[64:67], v[172:175], a[28:31], v[64:67]
ds_read_b64_tr_b16 v[148:149], v12 offset:20480
ds_read_b64_tr_b16 v[150:151], v12 offset:22528
v_mfma_f32_16x16x32_bf16 v[80:83], v[160:163], a[144:147], v[80:83]
ds_read_b64_tr_b16 v[152:153], v12 offset:24576
ds_read_b64_tr_b16 v[154:155], v12 offset:26624
v_mfma_f32_16x16x32_bf16 v[80:83], v[164:167], a[148:151], v[80:83]
ds_read_b64_tr_b16 v[156:157], v12 offset:28672
v_mfma_f32_16x16x32_bf16 v[80:83], v[168:171], a[152:155], v[80:83]
ds_read_b64_tr_b16 v[158:159], v12 offset:30720
v_mfma_f32_16x16x32_bf16 v[80:83], v[172:175], a[156:159], v[80:83]
s_waitcnt lgkmcnt(8)
v_mfma_f32_16x16x32_bf16 v[68:71], v[176:179], a[16:19], v[68:71]
buffer_load_dwordx4 v18, s[60:63], s29 offen offset:3072  lds
v_mfma_f32_16x16x32_bf16 v[68:71], v[180:183], a[20:23], v[68:71]
ds_read_b64_tr_b16 v[160:161], v13 offset:16384
ds_read_b64_tr_b16 v[162:163], v13 offset:18432
v_mfma_f32_16x16x32_bf16 v[68:71], v[184:187], a[24:27], v[68:71]
ds_read_b64_tr_b16 v[164:165], v13 offset:20480
ds_read_b64_tr_b16 v[166:167], v13 offset:22528
v_mfma_f32_16x16x32_bf16 v[68:71], v[188:191], a[28:31], v[68:71]
ds_read_b64_tr_b16 v[168:169], v13 offset:24576
v_mfma_f32_16x16x32_bf16 v[84:87], v[176:179], a[144:147], v[84:87]
buffer_store_dwordx4 v[120:123], v22, s[12:15], s38 offen offset:1024 sc1
v_mfma_f32_16x16x32_bf16 v[84:87], v[180:183], a[148:151], v[84:87]
ds_read_b64_tr_b16 v[170:171], v13 offset:26624
ds_read_b64_tr_b16 v[172:173], v13 offset:28672
v_mfma_f32_16x16x32_bf16 v[84:87], v[184:187], a[152:155], v[84:87]
ds_read_b64_tr_b16 v[174:175], v13 offset:30720
v_mfma_f32_16x16x32_bf16 v[84:87], v[188:191], a[156:159], v[84:87]
s_waitcnt lgkmcnt(8)
s_waitcnt vmcnt(20)
s_barrier
v_mfma_f32_16x16x32_bf16 v[72:75], v[144:147], a[16:19], v[72:75]
s_add_u32 m0, s32, 49152
s_add_u32 s29, s20, 262144
v_mfma_f32_16x16x32_bf16 v[72:75], v[148:151], a[20:23], v[72:75]
buffer_load_dwordx4 v6, s[60:63], s29 offen offset:0  lds
v_mfma_f32_16x16x32_bf16 v[72:75], v[152:155], a[24:27], v[72:75]
ds_read_b64_tr_b16 v[176:177], v10 offset:32768
ds_read_b64_tr_b16 v[178:179], v10 offset:34816
v_mfma_f32_16x16x32_bf16 v[72:75], v[156:159], a[28:31], v[72:75]
ds_read_b64_tr_b16 v[180:181], v10 offset:36864
ds_read_b64_tr_b16 v[182:183], v10 offset:38912
v_mfma_f32_16x16x32_bf16 v[88:91], v[144:147], a[144:147], v[88:91]
ds_read_b64_tr_b16 v[184:185], v10 offset:40960
ds_read_b64_tr_b16 v[186:187], v10 offset:43008
v_mfma_f32_16x16x32_bf16 v[88:91], v[148:151], a[148:151], v[88:91]
ds_read_b64_tr_b16 v[188:189], v10 offset:45056
v_mfma_f32_16x16x32_bf16 v[88:91], v[152:155], a[152:155], v[88:91]
ds_read_b64_tr_b16 v[190:191], v10 offset:47104
v_mfma_f32_16x16x32_bf16 v[88:91], v[156:159], a[156:159], v[88:91]
s_waitcnt lgkmcnt(8)
v_mfma_f32_16x16x32_bf16 v[76:79], v[160:163], a[16:19], v[76:79]
buffer_store_dwordx4 v[128:131], v20, s[12:15], s39 offen offset:0 sc1
v_mfma_f32_16x16x32_bf16 v[76:79], v[164:167], a[20:23], v[76:79]
buffer_load_dwordx4 v7, s[60:63], s29 offen offset:1024  lds
v_mfma_f32_16x16x32_bf16 v[76:79], v[168:171], a[24:27], v[76:79]
ds_read_b64_tr_b16 v[144:145], v11 offset:32768
ds_read_b64_tr_b16 v[146:147], v11 offset:34816
v_mfma_f32_16x16x32_bf16 v[76:79], v[172:175], a[28:31], v[76:79]
ds_read_b64_tr_b16 v[148:149], v11 offset:36864
ds_read_b64_tr_b16 v[150:151], v11 offset:38912
v_mfma_f32_16x16x32_bf16 v[92:95], v[160:163], a[144:147], v[92:95]
ds_read_b64_tr_b16 v[152:153], v11 offset:40960
ds_read_b64_tr_b16 v[154:155], v11 offset:43008
v_mfma_f32_16x16x32_bf16 v[92:95], v[164:167], a[148:151], v[92:95]
ds_read_b64_tr_b16 v[156:157], v11 offset:45056
v_mfma_f32_16x16x32_bf16 v[92:95], v[168:171], a[152:155], v[92:95]
ds_read_b64_tr_b16 v[158:159], v11 offset:47104
v_mfma_f32_16x16x32_bf16 v[92:95], v[172:175], a[156:159], v[92:95]
s_waitcnt lgkmcnt(8)
v_mfma_f32_16x16x32_bf16 v[32:35], v[176:179], a[32:35], v[32:35]
buffer_load_dwordx4 v8, s[60:63], s29 offen offset:2048  lds
v_mfma_f32_16x16x32_bf16 v[32:35], v[180:183], a[36:39], v[32:35]
ds_read_b64_tr_b16 v[160:161], v12 offset:32768
ds_read_b64_tr_b16 v[162:163], v12 offset:34816
v_mfma_f32_16x16x32_bf16 v[32:35], v[184:187], a[40:43], v[32:35]
ds_read_b64_tr_b16 v[164:165], v12 offset:36864
ds_read_b64_tr_b16 v[166:167], v12 offset:38912
v_mfma_f32_16x16x32_bf16 v[32:35], v[188:191], a[44:47], v[32:35]
ds_read_b64_tr_b16 v[168:169], v12 offset:40960
v_mfma_f32_16x16x32_bf16 v[48:51], v[176:179], a[160:163], v[48:51]
buffer_store_dwordx4 v[136:139], v22, s[12:15], s39 offen offset:0 sc1
v_mfma_f32_16x16x32_bf16 v[48:51], v[180:183], a[164:167], v[48:51]
ds_read_b64_tr_b16 v[170:171], v12 offset:43008
ds_read_b64_tr_b16 v[172:173], v12 offset:45056
v_mfma_f32_16x16x32_bf16 v[48:51], v[184:187], a[168:171], v[48:51]
ds_read_b64_tr_b16 v[174:175], v12 offset:47104
v_mfma_f32_16x16x32_bf16 v[48:51], v[188:191], a[172:175], v[48:51]
s_waitcnt lgkmcnt(8)
v_mfma_f32_16x16x32_bf16 v[36:39], v[144:147], a[32:35], v[36:39]
buffer_load_dwordx4 v18, s[60:63], s29 offen offset:3072  lds
v_mfma_f32_16x16x32_bf16 v[36:39], v[148:151], a[36:39], v[36:39]
ds_read_b64_tr_b16 v[176:177], v13 offset:32768
ds_read_b64_tr_b16 v[178:179], v13 offset:34816
v_mfma_f32_16x16x32_bf16 v[36:39], v[152:155], a[40:43], v[36:39]
ds_read_b64_tr_b16 v[180:181], v13 offset:36864
ds_read_b64_tr_b16 v[182:183], v13 offset:38912
v_mfma_f32_16x16x32_bf16 v[36:39], v[156:159], a[44:47], v[36:39]
ds_read_b64_tr_b16 v[184:185], v13 offset:40960
v_mfma_f32_16x16x32_bf16 v[52:55], v[144:147], a[160:163], v[52:55]
ds_read_b64_tr_b16 v[186:187], v13 offset:43008
v_mfma_f32_16x16x32_bf16 v[52:55], v[148:151], a[164:167], v[52:55]
ds_read_b64_tr_b16 v[188:189], v13 offset:45056
v_mfma_f32_16x16x32_bf16 v[52:55], v[152:155], a[168:171], v[52:55]
ds_read_b64_tr_b16 v[190:191], v13 offset:47104
v_mfma_f32_16x16x32_bf16 v[52:55], v[156:159], a[172:175], v[52:55]
s_waitcnt lgkmcnt(8)
s_barrier
v_mfma_f32_16x16x32_bf16 v[40:43], v[160:163], a[32:35], v[40:43]
s_add_u32 m0, s32, 65536
s_add_u32 s29, s21, 262144
v_mfma_f32_16x16x32_bf16 v[40:43], v[164:167], a[36:39], v[40:43]
buffer_load_dwordx4 v6, s[60:63], s29 offen offset:0  lds
v_mfma_f32_16x16x32_bf16 v[40:43], v[168:171], a[40:43], v[40:43]
ds_read_b64_tr_b16 v[144:145], v10 offset:49152
ds_read_b64_tr_b16 v[146:147], v10 offset:51200
v_mfma_f32_16x16x32_bf16 v[40:43], v[172:175], a[44:47], v[40:43]
ds_read_b64_tr_b16 v[148:149], v10 offset:53248
ds_read_b64_tr_b16 v[150:151], v10 offset:55296
v_mfma_f32_16x16x32_bf16 v[56:59], v[160:163], a[160:163], v[56:59]
ds_read_b64_tr_b16 v[152:153], v10 offset:57344
ds_read_b64_tr_b16 v[154:155], v10 offset:59392
v_mfma_f32_16x16x32_bf16 v[56:59], v[164:167], a[164:167], v[56:59]
ds_read_b64_tr_b16 v[156:157], v10 offset:61440
v_mfma_f32_16x16x32_bf16 v[56:59], v[168:171], a[168:171], v[56:59]
ds_read_b64_tr_b16 v[158:159], v10 offset:63488
v_mfma_f32_16x16x32_bf16 v[56:59], v[172:175], a[172:175], v[56:59]
s_waitcnt lgkmcnt(8)
v_mfma_f32_16x16x32_bf16 v[44:47], v[176:179], a[32:35], v[44:47]
buffer_load_dwordx4 v7, s[60:63], s29 offen offset:1024  lds
v_mfma_f32_16x16x32_bf16 v[44:47], v[180:183], a[36:39], v[44:47]
ds_read_b64_tr_b16 v[160:161], v11 offset:49152
ds_read_b64_tr_b16 v[162:163], v11 offset:51200
v_mfma_f32_16x16x32_bf16 v[44:47], v[184:187], a[40:43], v[44:47]
ds_read_b64_tr_b16 v[164:165], v11 offset:53248
ds_read_b64_tr_b16 v[166:167], v11 offset:55296
v_mfma_f32_16x16x32_bf16 v[44:47], v[188:191], a[44:47], v[44:47]
ds_read_b64_tr_b16 v[168:169], v11 offset:57344
v_mfma_f32_16x16x32_bf16 v[60:63], v[176:179], a[160:163], v[60:63]
ds_read_b64_tr_b16 v[170:171], v11 offset:59392
v_mfma_f32_16x16x32_bf16 v[60:63], v[180:183], a[164:167], v[60:63]
ds_read_b64_tr_b16 v[172:173], v11 offset:61440
v_mfma_f32_16x16x32_bf16 v[60:63], v[184:187], a[168:171], v[60:63]
ds_read_b64_tr_b16 v[174:175], v11 offset:63488
v_mfma_f32_16x16x32_bf16 v[60:63], v[188:191], a[172:175], v[60:63]
s_waitcnt lgkmcnt(8)
v_mfma_f32_16x16x32_bf16 v[64:67], v[144:147], a[32:35], v[64:67]
buffer_load_dwordx4 v8, s[60:63], s29 offen offset:2048  lds
v_mfma_f32_16x16x32_bf16 v[64:67], v[148:151], a[36:39], v[64:67]
ds_read_b64_tr_b16 v[176:177], v12 offset:49152
ds_read_b64_tr_b16 v[178:179], v12 offset:51200
v_mfma_f32_16x16x32_bf16 v[64:67], v[152:155], a[40:43], v[64:67]
ds_read_b64_tr_b16 v[180:181], v12 offset:53248
ds_read_b64_tr_b16 v[182:183], v12 offset:55296
v_mfma_f32_16x16x32_bf16 v[64:67], v[156:159], a[44:47], v[64:67]
ds_read_b64_tr_b16 v[184:185], v12 offset:57344
v_mfma_f32_16x16x32_bf16 v[80:83], v[144:147], a[160:163], v[80:83]
ds_read_b64_tr_b16 v[186:187], v12 offset:59392
v_mfma_f32_16x16x32_bf16 v[80:83], v[148:151], a[164:167], v[80:83]
ds_read_b64_tr_b16 v[188:189], v12 offset:61440
v_mfma_f32_16x16x32_bf16 v[80:83], v[152:155], a[168:171], v[80:83]
ds_read_b64_tr_b16 v[190:191], v12 offset:63488
v_mfma_f32_16x16x32_bf16 v[80:83], v[156:159], a[172:175], v[80:83]
s_waitcnt lgkmcnt(8)
v_mfma_f32_16x16x32_bf16 v[68:71], v[160:163], a[32:35], v[68:71]
buffer_load_dwordx4 v18, s[60:63], s29 offen offset:3072  lds
v_mfma_f32_16x16x32_bf16 v[68:71], v[164:167], a[36:39], v[68:71]
ds_read_b64_tr_b16 v[144:145], v13 offset:49152
ds_read_b64_tr_b16 v[146:147], v13 offset:51200
v_mfma_f32_16x16x32_bf16 v[68:71], v[168:171], a[40:43], v[68:71]
ds_read_b64_tr_b16 v[148:149], v13 offset:53248
ds_read_b64_tr_b16 v[150:151], v13 offset:55296
v_mfma_f32_16x16x32_bf16 v[68:71], v[172:175], a[44:47], v[68:71]
ds_read_b64_tr_b16 v[152:153], v13 offset:57344
v_mfma_f32_16x16x32_bf16 v[84:87], v[160:163], a[160:163], v[84:87]
ds_read_b64_tr_b16 v[154:155], v13 offset:59392
v_mfma_f32_16x16x32_bf16 v[84:87], v[164:167], a[164:167], v[84:87]
ds_read_b64_tr_b16 v[156:157], v13 offset:61440
v_mfma_f32_16x16x32_bf16 v[84:87], v[168:171], a[168:171], v[84:87]
ds_read_b64_tr_b16 v[158:159], v13 offset:63488
v_mfma_f32_16x16x32_bf16 v[84:87], v[172:175], a[172:175], v[84:87]
s_waitcnt lgkmcnt(8)
s_waitcnt vmcnt(19)
s_barrier
v_mfma_f32_16x16x32_bf16 v[72:75], v[176:179], a[32:35], v[72:75]
s_add_u32 m0, s32, 81920
s_add_u32 s29, s20, 1179648
v_mfma_f32_16x16x32_bf16 v[72:75], v[180:183], a[36:39], v[72:75]
buffer_load_dwordx4 v6, s[60:63], s29 offen offset:0  lds
v_mfma_f32_16x16x32_bf16 v[72:75], v[184:187], a[40:43], v[72:75]
ds_read_b64_tr_b16 v[160:161], v14 offset:0
ds_read_b64_tr_b16 v[162:163], v14 offset:2048
v_mfma_f32_16x16x32_bf16 v[72:75], v[188:191], a[44:47], v[72:75]
ds_read_b64_tr_b16 v[164:165], v14 offset:4096
ds_read_b64_tr_b16 v[166:167], v14 offset:6144
v_mfma_f32_16x16x32_bf16 v[88:91], v[176:179], a[160:163], v[88:91]
ds_read_b64_tr_b16 v[168:169], v14 offset:8192
ds_read_b64_tr_b16 v[170:171], v14 offset:10240
v_mfma_f32_16x16x32_bf16 v[88:91], v[180:183], a[164:167], v[88:91]
ds_read_b64_tr_b16 v[172:173], v14 offset:12288
v_mfma_f32_16x16x32_bf16 v[88:91], v[184:187], a[168:171], v[88:91]
ds_read_b64_tr_b16 v[174:175], v14 offset:14336
v_mfma_f32_16x16x32_bf16 v[88:91], v[188:191], a[172:175], v[88:91]
s_waitcnt lgkmcnt(8)
v_mfma_f32_16x16x32_bf16 v[76:79], v[144:147], a[32:35], v[76:79]
buffer_load_dwordx4 v7, s[60:63], s29 offen offset:1024  lds
v_mfma_f32_16x16x32_bf16 v[76:79], v[148:151], a[36:39], v[76:79]
ds_read_b64_tr_b16 v[176:177], v15 offset:0
ds_read_b64_tr_b16 v[178:179], v15 offset:2048
v_mfma_f32_16x16x32_bf16 v[76:79], v[152:155], a[40:43], v[76:79]
ds_read_b64_tr_b16 v[180:181], v15 offset:4096
ds_read_b64_tr_b16 v[182:183], v15 offset:6144
v_mfma_f32_16x16x32_bf16 v[76:79], v[156:159], a[44:47], v[76:79]
ds_read_b64_tr_b16 v[184:185], v15 offset:8192
v_mfma_f32_16x16x32_bf16 v[92:95], v[144:147], a[160:163], v[92:95]
ds_read_b64_tr_b16 v[186:187], v15 offset:10240
v_mfma_f32_16x16x32_bf16 v[92:95], v[148:151], a[164:167], v[92:95]
ds_read_b64_tr_b16 v[188:189], v15 offset:12288
v_mfma_f32_16x16x32_bf16 v[92:95], v[152:155], a[168:171], v[92:95]
ds_read_b64_tr_b16 v[190:191], v15 offset:14336
v_mfma_f32_16x16x32_bf16 v[92:95], v[156:159], a[172:175], v[92:95]
s_waitcnt lgkmcnt(8)
v_mfma_f32_16x16x32_bf16 v[32:35], v[160:163], a[48:51], v[32:35]
buffer_load_dwordx4 v8, s[60:63], s29 offen offset:2048  lds
v_mfma_f32_16x16x32_bf16 v[32:35], v[164:167], a[52:55], v[32:35]
ds_read_b64_tr_b16 v[144:145], v16 offset:0
ds_read_b64_tr_b16 v[146:147], v16 offset:2048
v_mfma_f32_16x16x32_bf16 v[32:35], v[168:171], a[56:59], v[32:35]
ds_read_b64_tr_b16 v[148:149], v16 offset:4096
ds_read_b64_tr_b16 v[150:151], v16 offset:6144
v_mfma_f32_16x16x32_bf16 v[32:35], v[172:175], a[60:63], v[32:35]
ds_read_b64_tr_b16 v[152:153], v16 offset:8192
v_mfma_f32_16x16x32_bf16 v[48:51], v[160:163], a[176:179], v[48:51]
ds_read_b64_tr_b16 v[154:155], v16 offset:10240
v_mfma_f32_16x16x32_bf16 v[48:51], v[164:167], a[180:183], v[48:51]
ds_read_b64_tr_b16 v[156:157], v16 offset:12288
v_mfma_f32_16x16x32_bf16 v[48:51], v[168:171], a[184:187], v[48:51]
ds_read_b64_tr_b16 v[158:159], v16 offset:14336
v_mfma_f32_16x16x32_bf16 v[48:51], v[172:175], a[188:191], v[48:51]
s_waitcnt lgkmcnt(8)
v_mfma_f32_16x16x32_bf16 v[36:39], v[176:179], a[48:51], v[36:39]
buffer_load_dwordx4 v18, s[60:63], s29 offen offset:3072  lds
v_mfma_f32_16x16x32_bf16 v[36:39], v[180:183], a[52:55], v[36:39]
ds_read_b64_tr_b16 v[160:161], v17 offset:0
ds_read_b64_tr_b16 v[162:163], v17 offset:2048
v_mfma_f32_16x16x32_bf16 v[36:39], v[184:187], a[56:59], v[36:39]
s_waitcnt vmcnt(9)
buffer_store_dword v31, v30, s[12:15], s59 offen offset:12 sc1
v_mfma_f32_16x16x32_bf16 v[36:39], v[188:191], a[60:63], v[36:39]
ds_read_b64_tr_b16 v[164:165], v17 offset:4096
ds_read_b64_tr_b16 v[166:167], v17 offset:6144
v_mfma_f32_16x16x32_bf16 v[52:55], v[176:179], a[176:179], v[52:55]
ds_read_b64_tr_b16 v[168:169], v17 offset:8192
ds_read_b64_tr_b16 v[170:171], v17 offset:10240
v_mfma_f32_16x16x32_bf16 v[52:55], v[180:183], a[180:183], v[52:55]
ds_read_b64_tr_b16 v[172:173], v17 offset:12288
v_mfma_f32_16x16x32_bf16 v[52:55], v[184:187], a[184:187], v[52:55]
ds_read_b64_tr_b16 v[174:175], v17 offset:14336
v_mfma_f32_16x16x32_bf16 v[52:55], v[188:191], a[188:191], v[52:55]
s_waitcnt lgkmcnt(8)
s_barrier
v_mfma_f32_16x16x32_bf16 v[40:43], v[144:147], a[48:51], v[40:43]
s_add_u32 m0, s32, 98304
s_add_u32 s29, s21, 1179648
v_mfma_f32_16x16x32_bf16 v[40:43], v[148:151], a[52:55], v[40:43]
buffer_load_dwordx4 v6, s[60:63], s29 offen offset:0  lds
v_mfma_f32_16x16x32_bf16 v[40:43], v[152:155], a[56:59], v[40:43]
ds_read_b64_tr_b16 v[176:177], v14 offset:16384
ds_read_b64_tr_b16 v[178:179], v14 offset:18432
v_mfma_f32_16x16x32_bf16 v[40:43], v[156:159], a[60:63], v[40:43]
ds_read_b64_tr_b16 v[180:181], v14 offset:20480
ds_read_b64_tr_b16 v[182:183], v14 offset:22528
v_mfma_f32_16x16x32_bf16 v[56:59], v[144:147], a[176:179], v[56:59]
ds_read_b64_tr_b16 v[184:185], v14 offset:24576
ds_read_b64_tr_b16 v[186:187], v14 offset:26624
v_mfma_f32_16x16x32_bf16 v[56:59], v[148:151], a[180:183], v[56:59]
ds_read_b64_tr_b16 v[188:189], v14 offset:28672
v_mfma_f32_16x16x32_bf16 v[56:59], v[152:155], a[184:187], v[56:59]
ds_read_b64_tr_b16 v[190:191], v14 offset:30720
v_mfma_f32_16x16x32_bf16 v[56:59], v[156:159], a[188:191], v[56:59]
s_waitcnt lgkmcnt(8)
v_mfma_f32_16x16x32_bf16 v[44:47], v[160:163], a[48:51], v[44:47]
buffer_load_dwordx4 v7, s[60:63], s29 offen offset:1024  lds
v_mfma_f32_16x16x32_bf16 v[44:47], v[164:167], a[52:55], v[44:47]
ds_read_b64_tr_b16 v[144:145], v15 offset:16384
ds_read_b64_tr_b16 v[146:147], v15 offset:18432
v_mfma_f32_16x16x32_bf16 v[44:47], v[168:171], a[56:59], v[44:47]
ds_read_b64_tr_b16 v[148:149], v15 offset:20480
ds_read_b64_tr_b16 v[150:151], v15 offset:22528
v_mfma_f32_16x16x32_bf16 v[44:47], v[172:175], a[60:63], v[44:47]
ds_read_b64_tr_b16 v[152:153], v15 offset:24576
v_mfma_f32_16x16x32_bf16 v[60:63], v[160:163], a[176:179], v[60:63]
ds_read_b64_tr_b16 v[154:155], v15 offset:26624
v_mfma_f32_16x16x32_bf16 v[60:63], v[164:167], a[180:183], v[60:63]
ds_read_b64_tr_b16 v[156:157], v15 offset:28672
v_mfma_f32_16x16x32_bf16 v[60:63], v[168:171], a[184:187], v[60:63]
ds_read_b64_tr_b16 v[158:159], v15 offset:30720
v_mfma_f32_16x16x32_bf16 v[60:63], v[172:175], a[188:191], v[60:63]
s_waitcnt lgkmcnt(8)
v_mfma_f32_16x16x32_bf16 v[64:67], v[176:179], a[48:51], v[64:67]
buffer_load_dwordx4 v8, s[60:63], s29 offen offset:2048  lds
v_mfma_f32_16x16x32_bf16 v[64:67], v[180:183], a[52:55], v[64:67]
ds_read_b64_tr_b16 v[160:161], v16 offset:16384
ds_read_b64_tr_b16 v[162:163], v16 offset:18432
v_mfma_f32_16x16x32_bf16 v[64:67], v[184:187], a[56:59], v[64:67]
ds_read_b64_tr_b16 v[164:165], v16 offset:20480
ds_read_b64_tr_b16 v[166:167], v16 offset:22528
v_mfma_f32_16x16x32_bf16 v[64:67], v[188:191], a[60:63], v[64:67]
ds_read_b64_tr_b16 v[168:169], v16 offset:24576
v_mfma_f32_16x16x32_bf16 v[80:83], v[176:179], a[176:179], v[80:83]
ds_read_b64_tr_b16 v[170:171], v16 offset:26624
v_mfma_f32_16x16x32_bf16 v[80:83], v[180:183], a[180:183], v[80:83]
ds_read_b64_tr_b16 v[172:173], v16 offset:28672
v_mfma_f32_16x16x32_bf16 v[80:83], v[184:187], a[184:187], v[80:83]
s_buffer_load_dword s45, s[12:15], s40 offset:262156 glc
s_buffer_load_dword s46, s[12:15], s40 offset:266252 glc
v_mfma_f32_16x16x32_bf16 v[80:83], v[188:191], a[188:191], v[80:83]
s_buffer_load_dword s47, s[12:15], s40 offset:270348 glc
s_waitcnt lgkmcnt(7)
v_mfma_f32_16x16x32_bf16 v[68:71], v[144:147], a[48:51], v[68:71]
s_buffer_load_dword s101, s[12:15], s40 offset:274444 glc
ds_read_b64_tr_b16 v[174:175], v16 offset:30720
v_mfma_f32_16x16x32_bf16 v[68:71], v[148:151], a[52:55], v[68:71]
buffer_load_dwordx4 v18, s[60:63], s29 offen offset:3072  lds
v_mfma_f32_16x16x32_bf16 v[68:71], v[152:155], a[56:59], v[68:71]
ds_read_b64_tr_b16 v[176:177], v17 offset:16384
ds_read_b64_tr_b16 v[178:179], v17 offset:18432
v_mfma_f32_16x16x32_bf16 v[68:71], v[156:159], a[60:63], v[68:71]
ds_read_b64_tr_b16 v[180:181], v17 offset:20480
ds_read_b64_tr_b16 v[182:183], v17 offset:22528
v_mfma_f32_16x16x32_bf16 v[84:87], v[144:147], a[176:179], v[84:87]
ds_read_b64_tr_b16 v[184:185], v17 offset:24576
ds_read_b64_tr_b16 v[186:187], v17 offset:26624
v_mfma_f32_16x16x32_bf16 v[84:87], v[148:151], a[180:183], v[84:87]
ds_read_b64_tr_b16 v[188:189], v17 offset:28672
v_mfma_f32_16x16x32_bf16 v[84:87], v[152:155], a[184:187], v[84:87]
ds_read_b64_tr_b16 v[190:191], v17 offset:30720
v_mfma_f32_16x16x32_bf16 v[84:87], v[156:159], a[188:191], v[84:87]
s_waitcnt lgkmcnt(8)
s_barrier
v_mfma_f32_16x16x32_bf16 v[72:75], v[160:163], a[48:51], v[72:75]
s_add_u32 m0, s32, 114688
s_add_u32 s29, s20, 393216
v_mfma_f32_16x16x32_bf16 v[72:75], v[164:167], a[52:55], v[72:75]
s_add_u32 s29, s29, s31
ds_read_b64_tr_b16 v[144:145], v2 offset:0
v_mfma_f32_16x16x32_bf16 v[72:75], v[168:171], a[56:59], v[72:75]
buffer_load_dwordx4 v6, s[60:63], s29 offen offset:0  lds
v_mfma_f32_16x16x32_bf16 v[72:75], v[172:175], a[60:63], v[72:75]
ds_read_b64_tr_b16 v[146:147], v2 offset:2048
ds_read_b64_tr_b16 v[148:149], v2 offset:4096
v_mfma_f32_16x16x32_bf16 v[88:91], v[160:163], a[176:179], v[88:91]
ds_read_b64_tr_b16 v[150:151], v2 offset:6144
ds_read_b64_tr_b16 v[152:153], v2 offset:8192
v_mfma_f32_16x16x32_bf16 v[88:91], v[164:167], a[180:183], v[88:91]
ds_read_b64_tr_b16 v[154:155], v2 offset:10240
ds_read_b64_tr_b16 v[156:157], v2 offset:12288
v_mfma_f32_16x16x32_bf16 v[88:91], v[168:171], a[184:187], v[88:91]
ds_read_b64_tr_b16 v[158:159], v2 offset:14336
v_mfma_f32_16x16x32_bf16 v[88:91], v[172:175], a[188:191], v[88:91]
s_waitcnt lgkmcnt(8)
v_mfma_f32_16x16x32_bf16 v[76:79], v[176:179], a[48:51], v[76:79]
buffer_load_dwordx4 v7, s[60:63], s29 offen offset:1024  lds
v_mfma_f32_16x16x32_bf16 v[76:79], v[180:183], a[52:55], v[76:79]
ds_read_b64_tr_b16 v[160:161], v3 offset:0
ds_read_b64_tr_b16 v[162:163], v3 offset:2048
v_mfma_f32_16x16x32_bf16 v[76:79], v[184:187], a[56:59], v[76:79]
ds_read_b64_tr_b16 v[164:165], v3 offset:4096
ds_read_b64_tr_b16 v[166:167], v3 offset:6144
v_mfma_f32_16x16x32_bf16 v[76:79], v[188:191], a[60:63], v[76:79]
ds_read_b64_tr_b16 v[168:169], v3 offset:8192
v_mfma_f32_16x16x32_bf16 v[92:95], v[176:179], a[176:179], v[92:95]
ds_read_b64_tr_b16 v[170:171], v3 offset:10240
v_mfma_f32_16x16x32_bf16 v[92:95], v[180:183], a[180:183], v[92:95]
ds_read_b64_tr_b16 v[172:173], v3 offset:12288
v_mfma_f32_16x16x32_bf16 v[92:95], v[184:187], a[184:187], v[92:95]
ds_read_b64_tr_b16 v[174:175], v3 offset:14336
v_mfma_f32_16x16x32_bf16 v[92:95], v[188:191], a[188:191], v[92:95]
s_waitcnt lgkmcnt(8)
v_mfma_f32_16x16x32_bf16 v[96:99], v[144:147], a[0:3], 0
buffer_load_dwordx4 v8, s[60:63], s29 offen offset:2048  lds
v_mfma_f32_16x16x32_bf16 v[96:99], v[148:151], a[4:7], v[96:99]
ds_read_b64_tr_b16 v[176:177], v4 offset:0
ds_read_b64_tr_b16 v[178:179], v4 offset:2048
v_mfma_f32_16x16x32_bf16 v[96:99], v[152:155], a[8:11], v[96:99]
ds_read_b64_tr_b16 v[180:181], v4 offset:4096
ds_read_b64_tr_b16 v[182:183], v4 offset:6144
v_mfma_f32_16x16x32_bf16 v[96:99], v[156:159], a[12:15], v[96:99]
ds_read_b64_tr_b16 v[184:185], v4 offset:8192
v_mfma_f32_16x16x32_bf16 v[112:115], v[144:147], a[128:131], 0
ds_read_b64_tr_b16 v[186:187], v4 offset:10240
v_mfma_f32_16x16x32_bf16 v[112:115], v[148:151], a[132:135], v[112:115]
ds_read_b64_tr_b16 v[188:189], v4 offset:12288
v_mfma_f32_16x16x32_bf16 v[112:115], v[152:155], a[136:139], v[112:115]
ds_read_b64_tr_b16 v[190:191], v4 offset:14336
v_mfma_f32_16x16x32_bf16 v[112:115], v[156:159], a[140:143], v[112:115]
s_waitcnt lgkmcnt(8)
v_mfma_f32_16x16x32_bf16 v[100:103], v[160:163], a[0:3], 0
buffer_load_dwordx4 v18, s[60:63], s29 offen offset:3072  lds
v_mfma_f32_16x16x32_bf16 v[100:103], v[164:167], a[4:7], v[100:103]
ds_read_b64_tr_b16 v[144:145], v5 offset:0
ds_read_b64_tr_b16 v[146:147], v5 offset:2048
v_mfma_f32_16x16x32_bf16 v[100:103], v[168:171], a[8:11], v[100:103]
ds_read_b64_tr_b16 v[148:149], v5 offset:4096
ds_read_b64_tr_b16 v[150:151], v5 offset:6144
v_mfma_f32_16x16x32_bf16 v[100:103], v[172:175], a[12:15], v[100:103]
ds_read_b64_tr_b16 v[152:153], v5 offset:8192
v_mfma_f32_16x16x32_bf16 v[116:119], v[160:163], a[128:131], 0
ds_read_b64_tr_b16 v[154:155], v5 offset:10240
v_mfma_f32_16x16x32_bf16 v[116:119], v[164:167], a[132:135], v[116:119]
ds_read_b64_tr_b16 v[156:157], v5 offset:12288
v_mfma_f32_16x16x32_bf16 v[116:119], v[168:171], a[136:139], v[116:119]
s_waitcnt lgkmcnt(0)
s_and_b32 s45, s45, s46
s_and_b32 s45, s45, s47
s_and_b32 s45, s45, s101
s_cbranch_scc1 mlp_kernel_q7_ok
s_mov_b32 s27, 0x40000
mlp_kernel_q7:
s_sleep 4
s_buffer_load_dword s45, s[12:15], s40 offset:262156 glc
s_buffer_load_dword s46, s[12:15], s40 offset:266252 glc
s_buffer_load_dword s47, s[12:15], s40 offset:270348 glc
s_buffer_load_dword s101, s[12:15], s40 offset:274444 glc
s_waitcnt lgkmcnt(0)
s_sub_u32 s27, s27, 1
s_cbranch_scc1 mlp_kernel_q7_ok
s_and_b32 s45, s45, s46
s_and_b32 s45, s45, s47
s_and_b32 s45, s45, s101
s_cbranch_scc0 mlp_kernel_q7
mlp_kernel_q7_ok:
s_add_u32 s28, s30, 4096
v_mfma_f32_16x16x32_bf16 v[116:119], v[172:175], a[140:143], v[116:119]
s_barrier
v_mfma_f32_16x16x32_bf16 v[104:107], v[176:179], a[0:3], 0
buffer_load_dwordx4 a[64:67], v20, s[12:15], s28 offen offset:0 sc1
v_mfma_f32_16x16x32_bf16 v[104:107], v[180:183], a[4:7], v[104:107]
ds_read_b64_tr_b16 v[158:159], v5 offset:14336
s_add_u32 m0, s32, 131072
v_mfma_f32_16x16x32_bf16 v[104:107], v[184:187], a[8:11], v[104:107]
ds_read_b64_tr_b16 v[160:161], v2 offset:16384
s_add_u32 s29, s21, 393216
v_mfma_f32_16x16x32_bf16 v[104:107], v[188:191], a[12:15], v[104:107]
ds_read_b64_tr_b16 v[162:163], v2 offset:18432
s_add_u32 s29, s29, s31
v_mfma_f32_16x16x32_bf16 v[120:123], v[176:179], a[128:131], 0
ds_read_b64_tr_b16 v[164:165], v2 offset:20480
ds_read_b64_tr_b16 v[166:167], v2 offset:22528
v_mfma_f32_16x16x32_bf16 v[120:123], v[180:183], a[132:135], v[120:123]
buffer_load_dwordx4 a[68:71], v20, s[12:15], s28 offen offset:1024 sc1
v_mfma_f32_16x16x32_bf16 v[120:123], v[184:187], a[136:139], v[120:123]
buffer_load_dwordx4 v6, s[60:63], s29 offen offset:0  lds
ds_read_b64_tr_b16 v[168:169], v2 offset:24576
v_mfma_f32_16x16x32_bf16 v[120:123], v[188:191], a[140:143], v[120:123]
ds_read_b64_tr_b16 v[170:171], v2 offset:26624
s_waitcnt lgkmcnt(6)
v_mfma_f32_16x16x32_bf16 v[108:111], v[144:147], a[0:3], 0
ds_read_b64_tr_b16 v[172:173], v2 offset:28672
ds_read_b64_tr_b16 v[174:175], v2 offset:30720
v_mfma_f32_16x16x32_bf16 v[108:111], v[148:151], a[4:7], v[108:111]
buffer_load_dwordx4 a[192:195], v22, s[12:15], s28 offen offset:0 sc1
v_mfma_f32_16x16x32_bf16 v[108:111], v[152:155], a[8:11], v[108:111]
ds_read_b64_tr_b16 v[176:177], v3 offset:16384
ds_read_b64_tr_b16 v[178:179], v3 offset:18432
v_mfma_f32_16x16x32_bf16 v[108:111], v[156:159], a[12:15], v[108:111]
buffer_load_dwordx4 a[196:199], v22, s[12:15], s28 offen offset:1024 sc1
v_mfma_f32_16x16x32_bf16 v[124:127], v[144:147], a[128:131], 0
ds_read_b64_tr_b16 v[180:181], v3 offset:20480
s_add_u32 s28, s30, 12288
v_mfma_f32_16x16x32_bf16 v[124:127], v[148:151], a[132:135], v[124:127]
ds_read_b64_tr_b16 v[182:183], v3 offset:22528
ds_read_b64_tr_b16 v[184:185], v3 offset:24576
v_mfma_f32_16x16x32_bf16 v[124:127], v[152:155], a[136:139], v[124:127]
buffer_load_dwordx4 v7, s[60:63], s29 offen offset:1024  lds
v_mfma_f32_16x16x32_bf16 v[124:127], v[156:159], a[140:143], v[124:127]
ds_read_b64_tr_b16 v[186:187], v3 offset:26624
s_waitcnt lgkmcnt(6)
v_mfma_f32_16x16x32_bf16 v[96:99], v[160:163], a[16:19], v[96:99]
buffer_load_dwordx4 a[72:75], v20, s[12:15], s28 offen offset:0 sc1
ds_read_b64_tr_b16 v[188:189], v3 offset:28672
v_mfma_f32_16x16x32_bf16 v[96:99], v[164:167], a[20:23], v[96:99]
ds_read_b64_tr_b16 v[190:191], v3 offset:30720
ds_read_b64_tr_b16 v[144:145], v4 offset:16384
v_mfma_f32_16x16x32_bf16 v[96:99], v[168:171], a[24:27], v[96:99]
buffer_load_dwordx4 a[76:79], v20, s[12:15], s28 offen offset:1024 sc1
v_mfma_f32_16x16x32_bf16 v[96:99], v[172:175], a[28:31], v[96:99]
ds_read_b64_tr_b16 v[146:147], v4 offset:18432
ds_read_b64_tr_b16 v[148:149], v4 offset:20480
v_mfma_f32_16x16x32_bf16 v[112:115], v[160:163], a[144:147], v[112:115]
buffer_load_dwordx4 a[200:203], v22, s[12:15], s28 offen offset:0 sc1
v_mfma_f32_16x16x32_bf16 v[112:115], v[164:167], a[148:151], v[112:115]
ds_read_b64_tr_b16 v[150:151], v4 offset:22528
ds_read_b64_tr_b16 v[152:153], v4 offset:24576
v_mfma_f32_16x16x32_bf16 v[112:115], v[168:171], a[152:155], v[112:115]
buffer_load_dwordx4 v8, s[60:63], s29 offen offset:2048  lds
v_mfma_f32_16x16x32_bf16 v[112:115], v[172:175], a[156:159], v[112:115]
ds_read_b64_tr_b16 v[154:155], v4 offset:26624
s_waitcnt lgkmcnt(6)
v_mfma_f32_16x16x32_bf16 v[100:103], v[176:179], a[16:19], v[100:103]
ds_read_b64_tr_b16 v[156:157], v4 offset:28672
ds_read_b64_tr_b16 v[158:159], v4 offset:30720
v_mfma_f32_16x16x32_bf16 v[100:103], v[180:183], a[20:23], v[100:103]
buffer_load_dwordx4 a[204:207], v22, s[12:15], s28 offen offset:1024 sc1
s_add_u32 s28, s30, 18432
v_mfma_f32_16x16x32_bf16 v[100:103], v[184:187], a[24:27], v[100:103]
ds_read_b64_tr_b16 v[160:161], v5 offset:16384
ds_read_b64_tr_b16 v[162:163], v5 offset:18432
v_mfma_f32_16x16x32_bf16 v[100:103], v[188:191], a[28:31], v[100:103]
buffer_load_dwordx4 a[80:83], v20, s[12:15], s28 offen offset:0 sc1
v_mfma_f32_16x16x32_bf16 v[116:119], v[176:179], a[144:147], v[116:119]
ds_read_b64_tr_b16 v[164:165], v5 offset:20480
ds_read_b64_tr_b16 v[166:167], v5 offset:22528
v_mfma_f32_16x16x32_bf16 v[116:119], v[180:183], a[148:151], v[116:119]
buffer_load_dwordx4 a[84:87], v20, s[12:15], s28 offen offset:1024 sc1
v_mfma_f32_16x16x32_bf16 v[116:119], v[184:187], a[152:155], v[116:119]
buffer_load_dwordx4 v18, s[60:63], s29 offen offset:3072  lds
ds_read_b64_tr_b16 v[168:169], v5 offset:24576
v_mfma_f32_16x16x32_bf16 v[116:119], v[188:191], a[156:159], v[116:119]
ds_read_b64_tr_b16 v[170:171], v5 offset:26624
s_waitcnt lgkmcnt(6)
s_barrier
v_mfma_f32_16x16x32_bf16 v[104:107], v[144:147], a[16:19], v[104:107]
ds_read_b64_tr_b16 v[172:173], v5 offset:28672
s_add_u32 m0, s32, 147456
v_mfma_f32_16x16x32_bf16 v[104:107], v[148:151], a[20:23], v[104:107]
ds_read_b64_tr_b16 v[174:175], v5 offset:30720
s_add_u32 s29, s22, 1048576
v_mfma_f32_16x16x32_bf16 v[104:107], v[152:155], a[24:27], v[104:107]
buffer_load_dwordx4 a[208:211], v22, s[12:15], s28 offen offset:0 sc1
ds_read_b64_tr_b16 v[176:177], v2 offset:32768
v_mfma_f32_16x16x32_bf16 v[104:107], v[156:159], a[28:31], v[104:107]
ds_read_b64_tr_b16 v[178:179], v2 offset:34816
ds_read_b64_tr_b16 v[180:181], v2 offset:36864
v_mfma_f32_16x16x32_bf16 v[120:123], v[144:147], a[144:147], v[120:123]
buffer_load_dwordx4 a[212:215], v22, s[12:15], s28 offen offset:1024 sc1
v_mfma_f32_16x16x32_bf16 v[120:123], v[148:151], a[148:151], v[120:123]
s_add_u32 s28, s30, 26624
ds_read_b64_tr_b16 v[182:183], v2 offset:38912
v_mfma_f32_16x16x32_bf16 v[120:123], v[152:155], a[152:155], v[120:123]
buffer_load_dwordx4 v6, s[60:63], s29 offen offset:0  lds
ds_read_b64_tr_b16 v[184:185], v2 offset:40960
v_mfma_f32_16x16x32_bf16 v[120:123], v[156:159], a[156:159], v[120:123]
ds_read_b64_tr_b16 v[186:187], v2 offset:43008
s_waitcnt lgkmcnt(6)
v_mfma_f32_16x16x32_bf16 v[108:111], v[160:163], a[16:19], v[108:111]
buffer_load_dwordx4 a[88:91], v20, s[12:15], s28 offen offset:0 sc1
ds_read_b64_tr_b16 v[188:189], v2 offset:45056
v_mfma_f32_16x16x32_bf16 v[108:111], v[164:167], a[20:23], v[108:111]
ds_read_b64_tr_b16 v[190:191], v2 offset:47104
ds_read_b64_tr_b16 v[144:145], v3 offset:32768
v_mfma_f32_16x16x32_bf16 v[108:111], v[168:171], a[24:27], v[108:111]
buffer_load_dwordx4 a[92:95], v20, s[12:15], s28 offen offset:1024 sc1
v_mfma_f32_16x16x32_bf16 v[108:111], v[172:175], a[28:31], v[108:111]
ds_read_b64_tr_b16 v[146:147], v3 offset:34816
ds_read_b64_tr_b16 v[148:149], v3 offset:36864
v_mfma_f32_16x16x32_bf16 v[124:127], v[160:163], a[144:147], v[124:127]
buffer_load_dwordx4 a[216:219], v22, s[12:15], s28 offen offset:0 sc1
v_mfma_f32_16x16x32_bf16 v[124:127], v[164:167], a[148:151], v[124:127]
ds_read_b64_tr_b16 v[150:151], v3 offset:38912
ds_read_b64_tr_b16 v[152:153], v3 offset:40960
v_mfma_f32_16x16x32_bf16 v[124:127], v[168:171], a[152:155], v[124:127]
buffer_load_dwordx4 v7, s[60:63], s29 offen offset:1024  lds
v_mfma_f32_16x16x32_bf16 v[124:127], v[172:175], a[156:159], v[124:127]
ds_read_b64_tr_b16 v[154:155], v3 offset:43008
s_waitcnt lgkmcnt(6)
v_mfma_f32_16x16x32_bf16 v[96:99], v[176:179], a[32:35], v[96:99]
ds_read_b64_tr_b16 v[156:157], v3 offset:45056
ds_read_b64_tr_b16 v[158:159], v3 offset:47104
v_mfma_f32_16x16x32_bf16 v[96:99], v[180:183], a[36:39], v[96:99]
buffer_load_dwordx4 a[220:223], v22, s[12:15], s28 offen offset:1024 sc1
s_add_u32 s28, s30, 6144
v_mfma_f32_16x16x32_bf16 v[96:99], v[184:187], a[40:43], v[96:99]
ds_read_b64_tr_b16 v[160:161], v4 offset:32768
ds_read_b64_tr_b16 v[162:163], v4 offset:34816
v_mfma_f32_16x16x32_bf16 v[96:99], v[188:191], a[44:47], v[96:99]
buffer_load_dwordx4 a[96:99], v20, s[12:15], s28 offen offset:0 sc1
v_mfma_f32_16x16x32_bf16 v[112:115], v[176:179], a[160:163], v[112:115]
ds_read_b64_tr_b16 v[164:165], v4 offset:36864
ds_read_b64_tr_b16 v[166:167], v4 offset:38912
v_mfma_f32_16x16x32_bf16 v[112:115], v[180:183], a[164:167], v[112:115]
buffer_load_dwordx4 a[100:103], v20, s[12:15], s28 offen offset:1024 sc1
v_mfma_f32_16x16x32_bf16 v[112:115], v[184:187], a[168:171], v[112:115]
buffer_load_dwordx4 v8, s[60:63], s29 offen offset:2048  lds
ds_read_b64_tr_b16 v[168:169], v4 offset:40960
v_mfma_f32_16x16x32_bf16 v[112:115], v[188:191], a[172:175], v[112:115]
ds_read_b64_tr_b16 v[170:171], v4 offset:43008
s_waitcnt lgkmcnt(6)
v_mfma_f32_16x16x32_bf16 v[100:103], v[144:147], a[32:35], v[100:103]
ds_read_b64_tr_b16 v[172:173], v4 offset:45056
ds_read_b64_tr_b16 v[174:175], v4 offset:47104
v_mfma_f32_16x16x32_bf16 v[100:103], v[148:151], a[36:39], v[100:103]
buffer_load_dwordx4 a[224:227], v22, s[12:15], s28 offen offset:0 sc1
v_mfma_f32_16x16x32_bf16 v[100:103], v[152:155], a[40:43], v[100:103]
ds_read_b64_tr_b16 v[176:177], v5 offset:32768
ds_read_b64_tr_b16 v[178:179], v5 offset:34816
v_mfma_f32_16x16x32_bf16 v[100:103], v[156:159], a[44:47], v[100:103]
buffer_load_dwordx4 a[228:231], v22, s[12:15], s28 offen offset:1024 sc1
v_mfma_f32_16x16x32_bf16 v[116:119], v[144:147], a[160:163], v[116:119]
ds_read_b64_tr_b16 v[180:181], v5 offset:36864
s_add_u32 s28, s30, 20480
v_mfma_f32_16x16x32_bf16 v[116:119], v[148:151], a[164:167], v[116:119]
ds_read_b64_tr_b16 v[182:183], v5 offset:38912
ds_read_b64_tr_b16 v[184:185], v5 offset:40960
v_mfma_f32_16x16x32_bf16 v[116:119], v[152:155], a[168:171], v[116:119]
buffer_load_dwordx4 v18, s[60:63], s29 offen offset:3072  lds
v_mfma_f32_16x16x32_bf16 v[116:119], v[156:159], a[172:175], v[116:119]
ds_read_b64_tr_b16 v[186:187], v5 offset:43008
s_waitcnt lgkmcnt(6)
s_waitcnt vmcnt(17)
s_barrier
v_mfma_f32_16x16x32_bf16 v[104:107], v[160:163], a[32:35], v[104:107]
buffer_load_dwordx4 a[104:107], v20, s[12:15], s28 offen offset:0 sc1
ds_read_b64_tr_b16 v[188:189], v5 offset:45056
v_mfma_f32_16x16x32_bf16 v[104:107], v[164:167], a[36:39], v[104:107]
ds_read_b64_tr_b16 v[190:191], v5 offset:47104
s_add_u32 m0, s32, 0
v_mfma_f32_16x16x32_bf16 v[104:107], v[168:171], a[40:43], v[104:107]
ds_read_b64_tr_b16 v[144:145], v2 offset:49152
s_add_u32 s29, s22, 262144
v_mfma_f32_16x16x32_bf16 v[104:107], v[172:175], a[44:47], v[104:107]
buffer_load_dwordx4 a[108:111], v20, s[12:15], s28 offen offset:1024 sc1
ds_read_b64_tr_b16 v[146:147], v2 offset:51200
v_mfma_f32_16x16x32_bf16 v[120:123], v[160:163], a[160:163], v[120:123]
ds_read_b64_tr_b16 v[148:149], v2 offset:53248
ds_read_b64_tr_b16 v[150:151], v2 offset:55296
v_mfma_f32_16x16x32_bf16 v[120:123], v[164:167], a[164:167], v[120:123]
buffer_load_dwordx4 a[232:235], v22, s[12:15], s28 offen offset:0 sc1
v_mfma_f32_16x16x32_bf16 v[120:123], v[168:171], a[168:171], v[120:123]
buffer_load_dwordx4 v6, s[60:63], s29 offen offset:0  lds
ds_read_b64_tr_b16 v[152:153], v2 offset:57344
v_mfma_f32_16x16x32_bf16 v[120:123], v[172:175], a[172:175], v[120:123]
ds_read_b64_tr_b16 v[154:155], v2 offset:59392
s_waitcnt lgkmcnt(6)
v_mfma_f32_16x16x32_bf16 v[108:111], v[176:179], a[32:35], v[108:111]
ds_read_b64_tr_b16 v[156:157], v2 offset:61440
ds_read_b64_tr_b16 v[158:159], v2 offset:63488
v_mfma_f32_16x16x32_bf16 v[108:111], v[180:183], a[36:39], v[108:111]
buffer_load_dwordx4 a[236:239], v22, s[12:15], s28 offen offset:1024 sc1
v_mfma_f32_16x16x32_bf16 v[108:111], v[184:187], a[40:43], v[108:111]
ds_read_b64_tr_b16 v[160:161], v3 offset:49152
ds_read_b64_tr_b16 v[162:163], v3 offset:51200
v_mfma_f32_16x16x32_bf16 v[108:111], v[188:191], a[44:47], v[108:111]
buffer_load_dwordx4 v7, s[60:63], s29 offen offset:1024  lds
v_mfma_f32_16x16x32_bf16 v[124:127], v[176:179], a[160:163], v[124:127]
ds_read_b64_tr_b16 v[164:165], v3 offset:53248
ds_read_b64_tr_b16 v[166:167], v3 offset:55296
v_mfma_f32_16x16x32_bf16 v[124:127], v[180:183], a[164:167], v[124:127]
ds_read_b64_tr_b16 v[168:169], v3 offset:57344
ds_read_b64_tr_b16 v[170:171], v3 offset:59392
v_mfma_f32_16x16x32_bf16 v[124:127], v[184:187], a[168:171], v[124:127]
ds_read_b64_tr_b16 v[172:173], v3 offset:61440
ds_read_b64_tr_b16 v[174:175], v3 offset:63488
v_mfma_f32_16x16x32_bf16 v[124:127], v[188:191], a[172:175], v[124:127]
s_waitcnt lgkmcnt(8)
v_mfma_f32_16x16x32_bf16 v[32:35], v[144:147], a[64:67], v[32:35]
buffer_load_dwordx4 v8, s[60:63], s29 offen offset:2048  lds
v_mfma_f32_16x16x32_bf16 v[32:35], v[148:151], a[68:71], v[32:35]
ds_read_b64_tr_b16 v[176:177], v4 offset:49152
ds_read_b64_tr_b16 v[178:179], v4 offset:51200
v_mfma_f32_16x16x32_bf16 v[32:35], v[152:155], a[72:75], v[32:35]
ds_read_b64_tr_b16 v[180:181], v4 offset:53248
ds_read_b64_tr_b16 v[182:183], v4 offset:55296
v_mfma_f32_16x16x32_bf16 v[32:35], v[156:159], a[76:79], v[32:35]
ds_read_b64_tr_b16 v[184:185], v4 offset:57344
v_mfma_f32_16x16x32_bf16 v[48:51], v[144:147], a[192:195], v[48:51]
ds_read_b64_tr_b16 v[186:187], v4 offset:59392
v_mfma_f32_16x16x32_bf16 v[48:51], v[148:151], a[196:199], v[48:51]
ds_read_b64_tr_b16 v[188:189], v4 offset:61440
v_mfma_f32_16x16x32_bf16 v[48:51], v[152:155], a[200:203], v[48:51]
ds_read_b64_tr_b16 v[190:191], v4 offset:63488
v_mfma_f32_16x16x32_bf16 v[48:51], v[156:159], a[204:207], v[48:51]
s_waitcnt lgkmcnt(8)
v_mfma_f32_16x16x32_bf16 v[36:39], v[160:163], a[64:67], v[36:39]
buffer_load_dwordx4 v18, s[60:63], s29 offen offset:3072  lds
v_mfma_f32_16x16x32_bf16 v[36:39], v[164:167], a[68:71], v[36:39]
ds_read_b64_tr_b16 v[144:145], v5 offset:49152
ds_read_b64_tr_b16 v[146:147], v5 offset:51200
v_mfma_f32_16x16x32_bf16 v[36:39], v[168:171], a[72:75], v[36:39]
ds_read_b64_tr_b16 v[148:149], v5 offset:53248
ds_read_b64_tr_b16 v[150:151], v5 offset:55296
v_mfma_f32_16x16x32_bf16 v[36:39], v[172:175], a[76:79], v[36:39]
ds_read_b64_tr_b16 v[152:153], v5 offset:57344
v_mfma_f32_16x16x32_bf16 v[52:55], v[160:163], a[192:195], v[52:55]
ds_read_b64_tr_b16 v[154:155], v5 offset:59392
v_mfma_f32_16x16x32_bf16 v[52:55], v[164:167], a[196:199], v[52:55]
ds_read_b64_tr_b16 v[156:157], v5 offset:61440
v_mfma_f32_16x16x32_bf16 v[52:55], v[168:171], a[200:203], v[52:55]
ds_read_b64_tr_b16 v[158:159], v5 offset:63488
v_mfma_f32_16x16x32_bf16 v[52:55], v[172:175], a[204:207], v[52:55]
s_waitcnt lgkmcnt(8)
s_barrier
v_mfma_f32_16x16x32_bf16 v[40:43], v[176:179], a[64:67], v[40:43]
s_add_u32 m0, s32, 16384
s_add_u32 s29, s22, 1179648
v_mfma_f32_16x16x32_bf16 v[40:43], v[180:183], a[68:71], v[40:43]
buffer_load_dwordx4 v6, s[60:63], s29 offen offset:0  lds
v_mfma_f32_16x16x32_bf16 v[40:43], v[184:187], a[72:75], v[40:43]
ds_read_b64_tr_b16 v[160:161], v10 offset:0
ds_read_b64_tr_b16 v[162:163], v10 offset:2048
v_mfma_f32_16x16x32_bf16 v[40:43], v[188:191], a[76:79], v[40:43]
ds_read_b64_tr_b16 v[164:165], v10 offset:4096
ds_read_b64_tr_b16 v[166:167], v10 offset:6144
v_mfma_f32_16x16x32_bf16 v[56:59], v[176:179], a[192:195], v[56:59]
ds_read_b64_tr_b16 v[168:169], v10 offset:8192
ds_read_b64_tr_b16 v[170:171], v10 offset:10240
v_mfma_f32_16x16x32_bf16 v[56:59], v[180:183], a[196:199], v[56:59]
ds_read_b64_tr_b16 v[172:173], v10 offset:12288
v_mfma_f32_16x16x32_bf16 v[56:59], v[184:187], a[200:203], v[56:59]
ds_read_b64_tr_b16 v[174:175], v10 offset:14336
v_mfma_f32_16x16x32_bf16 v[56:59], v[188:191], a[204:207], v[56:59]
s_waitcnt lgkmcnt(8)
v_mfma_f32_16x16x32_bf16 v[44:47], v[144:147], a[64:67], v[44:47]
buffer_load_dwordx4 v7, s[60:63], s29 offen offset:1024  lds
v_mfma_f32_16x16x32_bf16 v[44:47], v[148:151], a[68:71], v[44:47]
ds_read_b64_tr_b16 v[176:177], v11 offset:0
ds_read_b64_tr_b16 v[178:179], v11 offset:2048
v_mfma_f32_16x16x32_bf16 v[44:47], v[152:155], a[72:75], v[44:47]
ds_read_b64_tr_b16 v[180:181], v11 offset:4096
ds_read_b64_tr_b16 v[182:183], v11 offset:6144
v_mfma_f32_16x16x32_bf16 v[44:47], v[156:159], a[76:79], v[44:47]
ds_read_b64_tr_b16 v[184:185], v11 offset:8192
v_mfma_f32_16x16x32_bf16 v[60:63], v[144:147], a[192:195], v[60:63]
ds_read_b64_tr_b16 v[186:187], v11 offset:10240
v_mfma_f32_16x16x32_bf16 v[60:63], v[148:151], a[196:199], v[60:63]
ds_read_b64_tr_b16 v[188:189], v11 offset:12288
v_mfma_f32_16x16x32_bf16 v[60:63], v[152:155], a[200:203], v[60:63]
ds_read_b64_tr_b16 v[190:191], v11 offset:14336
v_mfma_f32_16x16x32_bf16 v[60:63], v[156:159], a[204:207], v[60:63]
s_waitcnt lgkmcnt(8)
v_mfma_f32_16x16x32_bf16 v[64:67], v[160:163], a[64:67], v[64:67]
buffer_load_dwordx4 v8, s[60:63], s29 offen offset:2048  lds
v_mfma_f32_16x16x32_bf16 v[64:67], v[164:167], a[68:71], v[64:67]
ds_read_b64_tr_b16 v[144:145], v12 offset:0
ds_read_b64_tr_b16 v[146:147], v12 offset:2048
v_mfma_f32_16x16x32_bf16 v[64:67], v[168:171], a[72:75], v[64:67]
ds_read_b64_tr_b16 v[148:149], v12 offset:4096
ds_read_b64_tr_b16 v[150:151], v12 offset:6144
v_mfma_f32_16x16x32_bf16 v[64:67], v[172:175], a[76:79], v[64:67]
ds_read_b64_tr_b16 v[152:153], v12 offset:8192
v_mfma_f32_16x16x32_bf16 v[80:83], v[160:163], a[192:195], v[80:83]
ds_read_b64_tr_b16 v[154:155], v12 offset:10240
v_mfma_f32_16x16x32_bf16 v[80:83], v[164:167], a[196:199], v[80:83]
ds_read_b64_tr_b16 v[156:157], v12 offset:12288
v_mfma_f32_16x16x32_bf16 v[80:83], v[168:171], a[200:203], v[80:83]
ds_read_b64_tr_b16 v[158:159], v12 offset:14336
v_mfma_f32_16x16x32_bf16 v[80:83], v[172:175], a[204:207], v[80:83]
s_waitcnt lgkmcnt(8)
v_mfma_f32_16x16x32_bf16 v[68:71], v[176:179], a[64:67], v[68:71]
buffer_load_dwordx4 v18, s[60:63], s29 offen offset:3072  lds
v_mfma_f32_16x16x32_bf16 v[68:71], v[180:183], a[68:71], v[68:71]
ds_read_b64_tr_b16 v[160:161], v13 offset:0
ds_read_b64_tr_b16 v[162:163], v13 offset:2048
v_mfma_f32_16x16x32_bf16 v[68:71], v[184:187], a[72:75], v[68:71]
ds_read_b64_tr_b16 v[164:165], v13 offset:4096
ds_read_b64_tr_b16 v[166:167], v13 offset:6144
v_mfma_f32_16x16x32_bf16 v[68:71], v[188:191], a[76:79], v[68:71]
ds_read_b64_tr_b16 v[168:169], v13 offset:8192
v_mfma_f32_16x16x32_bf16 v[84:87], v[176:179], a[192:195], v[84:87]
ds_read_b64_tr_b16 v[170:171], v13 offset:10240
v_mfma_f32_16x16x32_bf16 v[84:87], v[180:183], a[196:199], v[84:87]
ds_read_b64_tr_b16 v[172:173], v13 offset:12288
v_mfma_f32_16x16x32_bf16 v[84:87], v[184:187], a[200:203], v[84:87]
ds_read_b64_tr_b16 v[174:175], v13 offset:14336
v_mfma_f32_16x16x32_bf16 v[84:87], v[188:191], a[204:207], v[84:87]
s_waitcnt lgkmcnt(8)
s_waitcnt vmcnt(18)
s_barrier
v_mfma_f32_16x16x32_bf16 v[72:75], v[144:147], a[64:67], v[72:75]
s_add_u32 m0, s32, 32768
s_add_u32 s29, s22, 393216
v_mfma_f32_16x16x32_bf16 v[72:75], v[148:151], a[68:71], v[72:75]
s_add_u32 s29, s29, s31
ds_read_b64_tr_b16 v[176:177], v10 offset:16384
v_mfma_f32_16x16x32_bf16 v[72:75], v[152:155], a[72:75], v[72:75]
buffer_load_dwordx4 v6, s[60:63], s29 offen offset:0  lds
v_mfma_f32_16x16x32_bf16 v[72:75], v[156:159], a[76:79], v[72:75]
ds_read_b64_tr_b16 v[178:179], v10 offset:18432
ds_read_b64_tr_b16 v[180:181], v10 offset:20480
v_mfma_f32_16x16x32_bf16 v[88:91], v[144:147], a[192:195], v[88:91]
ds_read_b64_tr_b16 v[182:183], v10 offset:22528
ds_read_b64_tr_b16 v[184:185], v10 offset:24576
v_mfma_f32_16x16x32_bf16 v[88:91], v[148:151], a[196:199], v[88:91]
ds_read_b64_tr_b16 v[186:187], v10 offset:26624
ds_read_b64_tr_b16 v[188:189], v10 offset:28672
v_mfma_f32_16x16x32_bf16 v[88:91], v[152:155], a[200:203], v[88:91]
ds_read_b64_tr_b16 v[190:191], v10 offset:30720
v_mfma_f32_16x16x32_bf16 v[88:91], v[156:159], a[204:207], v[88:91]
s_waitcnt lgkmcnt(8)
v_mfma_f32_16x16x32_bf16 v[76:79], v[160:163], a[64:67], v[76:79]
buffer_load_dwordx4 v7, s[60:63], s29 offen offset:1024  lds
v_mfma_f32_16x16x32_bf16 v[76:79], v[164:167], a[68:71], v[76:79]
ds_read_b64_tr_b16 v[144:145], v11 offset:16384
ds_read_b64_tr_b16 v[146:147], v11 offset:18432
v_mfma_f32_16x16x32_bf16 v[76:79], v[168:171], a[72:75], v[76:79]
ds_read_b64_tr_b16 v[148:149], v11 offset:20480
ds_read_b64_tr_b16 v[150:151], v11 offset:22528
v_mfma_f32_16x16x32_bf16 v[76:79], v[172:175], a[76:79], v[76:79]
ds_read_b64_tr_b16 v[152:153], v11 offset:24576
v_mfma_f32_16x16x32_bf16 v[92:95], v[160:163], a[192:195], v[92:95]
ds_read_b64_tr_b16 v[154:155], v11 offset:26624
v_mfma_f32_16x16x32_bf16 v[92:95], v[164:167], a[196:199], v[92:95]
ds_read_b64_tr_b16 v[156:157], v11 offset:28672
v_mfma_f32_16x16x32_bf16 v[92:95], v[168:171], a[200:203], v[92:95]
ds_read_b64_tr_b16 v[158:159], v11 offset:30720
v_mfma_f32_16x16x32_bf16 v[92:95], v[172:175], a[204:207], v[92:95]
s_waitcnt lgkmcnt(8)
v_mfma_f32_16x16x32_bf16 v[32:35], v[176:179], a[80:83], v[32:35]
buffer_load_dword v235, v234, s[12:15], s26 offen offset:4 sc1
v_mfma_f32_16x16x32_bf16 v[32:35], v[180:183], a[84:87], v[32:35]
buffer_load_dwordx4 v8, s[60:63], s29 offen offset:2048  lds
v_mfma_f32_16x16x32_bf16 v[32:35], v[184:187], a[88:91], v[32:35]
ds_read_b64_tr_b16 v[160:161], v12 offset:16384
ds_read_b64_tr_b16 v[162:163], v12 offset:18432
v_mfma_f32_16x16x32_bf16 v[32:35], v[188:191], a[92:95], v[32:35]
ds_read_b64_tr_b16 v[164:165], v12 offset:20480
ds_read_b64_tr_b16 v[166:167], v12 offset:22528
v_mfma_f32_16x16x32_bf16 v[48:51], v[176:179], a[208:211], v[48:51]
ds_read_b64_tr_b16 v[168:169], v12 offset:24576
ds_read_b64_tr_b16 v[170:171], v12 offset:26624
v_mfma_f32_16x16x32_bf16 v[48:51], v[180:183], a[212:215], v[48:51]
ds_read_b64_tr_b16 v[172:173], v12 offset:28672
v_mfma_f32_16x16x32_bf16 v[48:51], v[184:187], a[216:219], v[48:51]
ds_read_b64_tr_b16 v[174:175], v12 offset:30720
v_mfma_f32_16x16x32_bf16 v[48:51], v[188:191], a[220:223], v[48:51]
s_waitcnt lgkmcnt(8)
v_mfma_f32_16x16x32_bf16 v[36:39], v[144:147], a[80:83], v[36:39]
buffer_load_dwordx4 v18, s[60:63], s29 offen offset:3072  lds
v_mfma_f32_16x16x32_bf16 v[36:39], v[148:151], a[84:87], v[36:39]
ds_read_b64_tr_b16 v[176:177], v13 offset:16384
ds_read_b64_tr_b16 v[178:179], v13 offset:18432
v_mfma_f32_16x16x32_bf16 v[36:39], v[152:155], a[88:91], v[36:39]
ds_read_b64_tr_b16 v[180:181], v13 offset:20480
ds_read_b64_tr_b16 v[182:183], v13 offset:22528
v_mfma_f32_16x16x32_bf16 v[36:39], v[156:159], a[92:95], v[36:39]
ds_read_b64_tr_b16 v[184:185], v13 offset:24576
v_mfma_f32_16x16x32_bf16 v[52:55], v[144:147], a[208:211], v[52:55]
ds_read_b64_tr_b16 v[186:187], v13 offset:26624
v_mfma_f32_16x16x32_bf16 v[52:55], v[148:151], a[212:215], v[52:55]
ds_read_b64_tr_b16 v[188:189], v13 offset:28672
v_mfma_f32_16x16x32_bf16 v[52:55], v[152:155], a[216:219], v[52:55]
ds_read_b64_tr_b16 v[190:191], v13 offset:30720
v_mfma_f32_16x16x32_bf16 v[52:55], v[156:159], a[220:223], v[52:55]
s_waitcnt lgkmcnt(8)
s_barrier
v_mfma_f32_16x16x32_bf16 v[40:43], v[160:163], a[80:83], v[40:43]
s_add_u32 m0, s32, 49152
s_add_u32 s29, s33, 0
v_mfma_f32_16x16x32_bf16 v[40:43], v[164:167], a[84:87], v[40:43]
buffer_load_dwordx4 v6, s[60:63], s29 offen offset:0  lds
v_mfma_f32_16x16x32_bf16 v[40:43], v[168:171], a[88:91], v[40:43]
ds_read_b64_tr_b16 v[144:145], v10 offset:32768
ds_read_b64_tr_b16 v[146:147], v10 offset:34816
v_mfma_f32_16x16x32_bf16 v[40:43], v[172:175], a[92:95], v[40:43]
ds_read_b64_tr_b16 v[148:149], v10 offset:36864
ds_read_b64_tr_b16 v[150:151], v10 offset:38912
v_mfma_f32_16x16x32_bf16 v[56:59], v[160:163], a[208:211], v[56:59]
ds_read_b64_tr_b16 v[152:153], v10 offset:40960
ds_read_b64_tr_b16 v[154:155], v10 offset:43008
v_mfma_f32_16x16x32_bf16 v[56:59], v[164:167], a[212:215], v[56:59]
ds_read_b64_tr_b16 v[156:157], v10 offset:45056
v_mfma_f32_16x16x32_bf16 v[56:59], v[168:171], a[216:219], v[56:59]
ds_read_b64_tr_b16 v[158:159], v10 offset:47104
v_mfma_f32_16x16x32_bf16 v[56:59], v[172:175], a[220:223], v[56:59]
s_waitcnt lgkmcnt(8)
v_mfma_f32_16x16x32_bf16 v[44:47], v[176:179], a[80:83], v[44:47]
buffer_load_dwordx4 v7, s[60:63], s29 offen offset:1024  lds
v_mfma_f32_16x16x32_bf16 v[44:47], v[180:183], a[84:87], v[44:47]
ds_read_b64_tr_b16 v[160:161], v11 offset:32768
ds_read_b64_tr_b16 v[162:163], v11 offset:34816
v_mfma_f32_16x16x32_bf16 v[44:47], v[184:187], a[88:91], v[44:47]
ds_read_b64_tr_b16 v[164:165], v11 offset:36864
ds_read_b64_tr_b16 v[166:167], v11 offset:38912
v_mfma_f32_16x16x32_bf16 v[44:47], v[188:191], a[92:95], v[44:47]
ds_read_b64_tr_b16 v[168:169], v11 offset:40960
v_mfma_f32_16x16x32_bf16 v[60:63], v[176:179], a[208:211], v[60:63]
ds_read_b64_tr_b16 v[170:171], v11 offset:43008
v_mfma_f32_16x16x32_bf16 v[60:63], v[180:183], a[212:215], v[60:63]
ds_read_b64_tr_b16 v[172:173], v11 offset:45056
v_mfma_f32_16x16x32_bf16 v[60:63], v[184:187], a[216:219], v[60:63]
ds_read_b64_tr_b16 v[174:175], v11 offset:47104
v_mfma_f32_16x16x32_bf16 v[60:63], v[188:191], a[220:223], v[60:63]
s_waitcnt lgkmcnt(8)
v_mfma_f32_16x16x32_bf16 v[64:67], v[144:147], a[80:83], v[64:67]
buffer_load_dwordx4 v8, s[60:63], s29 offen offset:2048  lds
v_mfma_f32_16x16x32_bf16 v[64:67], v[148:151], a[84:87], v[64:67]
ds_read_b64_tr_b16 v[176:177], v12 offset:32768
ds_read_b64_tr_b16 v[178:179], v12 offset:34816
v_mfma_f32_16x16x32_bf16 v[64:67], v[152:155], a[88:91], v[64:67]
ds_read_b64_tr_b16 v[180:181], v12 offset:36864
ds_read_b64_tr_b16 v[182:183], v12 offset:38912
v_mfma_f32_16x16x32_bf16 v[64:67], v[156:159], a[92:95], v[64:67]
ds_read_b64_tr_b16 v[184:185], v12 offset:40960
v_mfma_f32_16x16x32_bf16 v[80:83], v[144:147], a[208:211], v[80:83]
ds_read_b64_tr_b16 v[186:187], v12 offset:43008
v_mfma_f32_16x16x32_bf16 v[80:83], v[148:151], a[212:215], v[80:83]
ds_read_b64_tr_b16 v[188:189], v12 offset:45056
v_mfma_f32_16x16x32_bf16 v[80:83], v[152:155], a[216:219], v[80:83]
ds_read_b64_tr_b16 v[190:191], v12 offset:47104
v_mfma_f32_16x16x32_bf16 v[80:83], v[156:159], a[220:223], v[80:83]
s_waitcnt lgkmcnt(8)
v_mfma_f32_16x16x32_bf16 v[68:71], v[160:163], a[80:83], v[68:71]
buffer_load_dwordx4 v18, s[60:63], s29 offen offset:3072  lds
v_mfma_f32_16x16x32_bf16 v[68:71], v[164:167], a[84:87], v[68:71]
ds_read_b64_tr_b16 v[144:145], v13 offset:32768
ds_read_b64_tr_b16 v[146:147], v13 offset:34816
v_mfma_f32_16x16x32_bf16 v[68:71], v[168:171], a[88:91], v[68:71]
ds_read_b64_tr_b16 v[148:149], v13 offset:36864
ds_read_b64_tr_b16 v[150:151], v13 offset:38912
v_mfma_f32_16x16x32_bf16 v[68:71], v[172:175], a[92:95], v[68:71]
ds_read_b64_tr_b16 v[152:153], v13 offset:40960
v_mfma_f32_16x16x32_bf16 v[84:87], v[160:163], a[208:211], v[84:87]
ds_read_b64_tr_b16 v[154:155], v13 offset:43008
v_mfma_f32_16x16x32_bf16 v[84:87], v[164:167], a[212:215], v[84:87]
ds_read_b64_tr_b16 v[156:157], v13 offset:45056
v_mfma_f32_16x16x32_bf16 v[84:87], v[168:171], a[216:219], v[84:87]
ds_read_b64_tr_b16 v[158:159], v13 offset:47104
v_mfma_f32_16x16x32_bf16 v[84:87], v[172:175], a[220:223], v[84:87]
s_waitcnt lgkmcnt(8)
s_waitcnt vmcnt(16)
s_barrier
v_mfma_f32_16x16x32_bf16 v[72:75], v[176:179], a[80:83], v[72:75]
s_add_u32 m0, s32, 65536
s_add_u32 s29, s33, 917504
v_mfma_f32_16x16x32_bf16 v[72:75], v[180:183], a[84:87], v[72:75]
buffer_load_dwordx4 v6, s[60:63], s29 offen offset:0  lds
v_mfma_f32_16x16x32_bf16 v[72:75], v[184:187], a[88:91], v[72:75]
ds_read_b64_tr_b16 v[160:161], v10 offset:49152
ds_read_b64_tr_b16 v[162:163], v10 offset:51200
v_mfma_f32_16x16x32_bf16 v[72:75], v[188:191], a[92:95], v[72:75]
ds_read_b64_tr_b16 v[164:165], v10 offset:53248
ds_read_b64_tr_b16 v[166:167], v10 offset:55296
v_mfma_f32_16x16x32_bf16 v[88:91], v[176:179], a[208:211], v[88:91]
ds_read_b64_tr_b16 v[168:169], v10 offset:57344
ds_read_b64_tr_b16 v[170:171], v10 offset:59392
v_mfma_f32_16x16x32_bf16 v[88:91], v[180:183], a[212:215], v[88:91]
ds_read_b64_tr_b16 v[172:173], v10 offset:61440
v_mfma_f32_16x16x32_bf16 v[88:91], v[184:187], a[216:219], v[88:91]
ds_read_b64_tr_b16 v[174:175], v10 offset:63488
v_mfma_f32_16x16x32_bf16 v[88:91], v[188:191], a[220:223], v[88:91]
s_waitcnt lgkmcnt(8)
v_mfma_f32_16x16x32_bf16 v[76:79], v[144:147], a[80:83], v[76:79]
buffer_load_dwordx4 v7, s[60:63], s29 offen offset:1024  lds
v_mfma_f32_16x16x32_bf16 v[76:79], v[148:151], a[84:87], v[76:79]
ds_read_b64_tr_b16 v[176:177], v11 offset:49152
ds_read_b64_tr_b16 v[178:179], v11 offset:51200
v_mfma_f32_16x16x32_bf16 v[76:79], v[152:155], a[88:91], v[76:79]
ds_read_b64_tr_b16 v[180:181], v11 offset:53248
ds_read_b64_tr_b16 v[182:183], v11 offset:55296
v_mfma_f32_16x16x32_bf16 v[76:79], v[156:159], a[92:95], v[76:79]
ds_read_b64_tr_b16 v[184:185], v11 offset:57344
v_mfma_f32_16x16x32_bf16 v[92:95], v[144:147], a[208:211], v[92:95]
s_waitcnt vmcnt(8)
s_mov_b32 s27, 0x40000
v_cmp_eq_u32 vcc, 0, v235
s_nop 0
s_cbranch_vccz mlp_kernel_p8_ok
mlp_kernel_p8:
s_sleep 4
buffer_load_dword v235, v234, s[12:15], s26 offen offset:4 sc1
s_waitcnt vmcnt(0)
v_cmp_eq_u32 vcc, 0, v235
s_sub_u32 s27, s27, 1
s_cbranch_scc1 mlp_kernel_p8_ok
s_cbranch_vccnz mlp_kernel_p8
mlp_kernel_p8_ok:
v_mfma_f32_16x16x32_bf16 v[92:95], v[148:151], a[212:215], v[92:95]
ds_read_b64_tr_b16 v[186:187], v11 offset:59392
ds_read_b64_tr_b16 v[188:189], v11 offset:61440
v_mfma_f32_16x16x32_bf16 v[92:95], v[152:155], a[216:219], v[92:95]
buffer_load_dwordx4 v[216:219], v20, s[12:15], s25 offen offset:0 sc1
v_mfma_f32_16x16x32_bf16 v[92:95], v[156:159], a[220:223], v[92:95]
ds_read_b64_tr_b16 v[190:191], v11 offset:63488
s_waitcnt lgkmcnt(8)
v_mfma_f32_16x16x32_bf16 v[32:35], v[160:163], a[96:99], v[32:35]
buffer_load_dwordx4 v8, s[60:63], s29 offen offset:2048  lds
v_mfma_f32_16x16x32_bf16 v[32:35], v[164:167], a[100:103], v[32:35]
buffer_load_dwordx4 v[220:223], v20, s[12:15], s25 offen offset:1024 sc1
v_mfma_f32_16x16x32_bf16 v[32:35], v[168:171], a[104:107], v[32:35]
ds_read_b64_tr_b16 v[144:145], v12 offset:49152
ds_read_b64_tr_b16 v[146:147], v12 offset:51200
v_mfma_f32_16x16x32_bf16 v[32:35], v[172:175], a[108:111], v[32:35]
buffer_load_dwordx4 v[224:227], v21, s[12:15], s25 offen offset:0 sc1
v_mfma_f32_16x16x32_bf16 v[48:51], v[160:163], a[224:227], v[48:51]
ds_read_b64_tr_b16 v[148:149], v12 offset:53248
ds_read_b64_tr_b16 v[150:151], v12 offset:55296
v_mfma_f32_16x16x32_bf16 v[48:51], v[164:167], a[228:231], v[48:51]
buffer_load_dwordx4 v[228:231], v21, s[12:15], s25 offen offset:1024 sc1
v_mfma_f32_16x16x32_bf16 v[48:51], v[168:171], a[232:235], v[48:51]
ds_read_b64_tr_b16 v[152:153], v12 offset:57344
ds_read_b64_tr_b16 v[154:155], v12 offset:59392
v_mfma_f32_16x16x32_bf16 v[48:51], v[172:175], a[236:239], v[48:51]
ds_read_b64_tr_b16 v[156:157], v12 offset:61440
s_waitcnt lgkmcnt(7)
v_mfma_f32_16x16x32_bf16 v[36:39], v[176:179], a[96:99], v[36:39]
buffer_load_dwordx4 v18, s[60:63], s29 offen offset:3072  lds
v_mfma_f32_16x16x32_bf16 v[36:39], v[180:183], a[100:103], v[36:39]
ds_read_b64_tr_b16 v[158:159], v12 offset:63488
ds_read_b64_tr_b16 v[160:161], v13 offset:49152
v_mfma_f32_16x16x32_bf16 v[36:39], v[184:187], a[104:107], v[36:39]
ds_read_b64_tr_b16 v[162:163], v13 offset:51200
ds_read_b64_tr_b16 v[164:165], v13 offset:53248
v_mfma_f32_16x16x32_bf16 v[36:39], v[188:191], a[108:111], v[36:39]
ds_read_b64_tr_b16 v[166:167], v13 offset:55296
ds_read_b64_tr_b16 v[168:169], v13 offset:57344
v_mfma_f32_16x16x32_bf16 v[52:55], v[176:179], a[224:227], v[52:55]
ds_read_b64_tr_b16 v[170:171], v13 offset:59392
v_mfma_f32_16x16x32_bf16 v[52:55], v[180:183], a[228:231], v[52:55]
ds_read_b64_tr_b16 v[172:173], v13 offset:61440
v_mfma_f32_16x16x32_bf16 v[52:55], v[184:187], a[232:235], v[52:55]
ds_read_b64_tr_b16 v[174:175], v13 offset:63488
v_mfma_f32_16x16x32_bf16 v[52:55], v[188:191], a[236:239], v[52:55]
s_waitcnt lgkmcnt(8)
s_barrier
v_mfma_f32_16x16x32_bf16 v[40:43], v[144:147], a[96:99], v[40:43]
s_add_u32 m0, s32, 81920
s_add_u32 s29, s33, 131072
v_mfma_f32_16x16x32_bf16 v[40:43], v[148:151], a[100:103], v[40:43]
buffer_load_dwordx4 v6, s[60:63], s29 offen offset:0  lds
v_mfma_f32_16x16x32_bf16 v[40:43], v[152:155], a[104:107], v[40:43]
ds_read_b64_tr_b16 v[176:177], v14 offset:0
ds_read_b64_tr_b16 v[178:179], v14 offset:2048
v_mfma_f32_16x16x32_bf16 v[40:43], v[156:159], a[108:111], v[40:43]
ds_read_b64_tr_b16 v[180:181], v14 offset:4096
ds_read_b64_tr_b16 v[182:183], v14 offset:6144
v_mfma_f32_16x16x32_bf16 v[56:59], v[144:147], a[224:227], v[56:59]
ds_read_b64_tr_b16 v[184:185], v14 offset:8192
ds_read_b64_tr_b16 v[186:187], v14 offset:10240
v_mfma_f32_16x16x32_bf16 v[56:59], v[148:151], a[228:231], v[56:59]
ds_read_b64_tr_b16 v[188:189], v14 offset:12288
v_mfma_f32_16x16x32_bf16 v[56:59], v[152:155], a[232:235], v[56:59]
ds_read_b64_tr_b16 v[190:191], v14 offset:14336
v_mfma_f32_16x16x32_bf16 v[56:59], v[156:159], a[236:239], v[56:59]
s_waitcnt lgkmcnt(8)
v_mfma_f32_16x16x32_bf16 v[44:47], v[160:163], a[96:99], v[44:47]
buffer_load_dwordx4 v7, s[60:63], s29 offen offset:1024  lds
v_mfma_f32_16x16x32_bf16 v[44:47], v[164:167], a[100:103], v[44:47]
ds_read_b64_tr_b16 v[144:145], v15 offset:0
ds_read_b64_tr_b16 v[146:147], v15 offset:2048
v_mfma_f32_16x16x32_bf16 v[44:47], v[168:171], a[104:107], v[44:47]
ds_read_b64_tr_b16 v[148:149], v15 offset:4096
ds_read_b64_tr_b16 v[150:151], v15 offset:6144
v_mfma_f32_16x16x32_bf16 v[44:47], v[172:175], a[108:111], v[44:47]
ds_read_b64_tr_b16 v[152:153], v15 offset:8192
v_mfma_f32_16x16x32_bf16 v[60:63], v[160:163], a[224:227], v[60:63]
ds_read_b64_tr_b16 v[154:155], v15 offset:10240
v_mfma_f32_16x16x32_bf16 v[60:63], v[164:167], a[228:231], v[60:63]
ds_read_b64_tr_b16 v[156:157], v15 offset:12288
v_mfma_f32_16x16x32_bf16 v[60:63], v[168:171], a[232:235], v[60:63]
ds_read_b64_tr_b16 v[158:159], v15 offset:14336
v_mfma_f32_16x16x32_bf16 v[60:63], v[172:175], a[236:239], v[60:63]
s_waitcnt lgkmcnt(8)
v_mfma_f32_16x16x32_bf16 v[64:67], v[176:179], a[96:99], v[64:67]
buffer_load_dwordx4 v8, s[60:63], s29 offen offset:2048  lds
v_mfma_f32_16x16x32_bf16 v[64:67], v[180:183], a[100:103], v[64:67]
ds_read_b64_tr_b16 v[160:161], v16 offset:0
ds_read_b64_tr_b16 v[162:163], v16 offset:2048
v_mfma_f32_16x16x32_bf16 v[64:67], v[184:187], a[104:107], v[64:67]
ds_read_b64_tr_b16 v[164:165], v16 offset:4096
ds_read_b64_tr_b16 v[166:167], v16 offset:6144
v_mfma_f32_16x16x32_bf16 v[64:67], v[188:191], a[108:111], v[64:67]
ds_read_b64_tr_b16 v[168:169], v16 offset:8192
v_mfma_f32_16x16x32_bf16 v[80:83], v[176:179], a[224:227], v[80:83]
ds_read_b64_tr_b16 v[170:171], v16 offset:10240
v_mfma_f32_16x16x32_bf16 v[80:83], v[180:183], a[228:231], v[80:83]
ds_read_b64_tr_b16 v[172:173], v16 offset:12288
v_mfma_f32_16x16x32_bf16 v[80:83], v[184:187], a[232:235], v[80:83]
ds_read_b64_tr_b16 v[174:175], v16 offset:14336
v_mfma_f32_16x16x32_bf16 v[80:83], v[188:191], a[236:239], v[80:83]
s_waitcnt lgkmcnt(8)
v_mfma_f32_16x16x32_bf16 v[68:71], v[144:147], a[96:99], v[68:71]
buffer_load_dwordx4 v18, s[60:63], s29 offen offset:3072  lds
v_mfma_f32_16x16x32_bf16 v[68:71], v[148:151], a[100:103], v[68:71]
ds_read_b64_tr_b16 v[176:177], v17 offset:0
ds_read_b64_tr_b16 v[178:179], v17 offset:2048
v_mfma_f32_16x16x32_bf16 v[68:71], v[152:155], a[104:107], v[68:71]
ds_read_b64_tr_b16 v[180:181], v17 offset:4096
ds_read_b64_tr_b16 v[182:183], v17 offset:6144
v_mfma_f32_16x16x32_bf16 v[68:71], v[156:159], a[108:111], v[68:71]
ds_read_b64_tr_b16 v[184:185], v17 offset:8192
v_mfma_f32_16x16x32_bf16 v[84:87], v[144:147], a[224:227], v[84:87]
ds_read_b64_tr_b16 v[186:187], v17 offset:10240
v_mfma_f32_16x16x32_bf16 v[84:87], v[148:151], a[228:231], v[84:87]
ds_read_b64_tr_b16 v[188:189], v17 offset:12288
v_mfma_f32_16x16x32_bf16 v[84:87], v[152:155], a[232:235], v[84:87]
ds_read_b64_tr_b16 v[190:191], v17 offset:14336
v_mfma_f32_16x16x32_bf16 v[84:87], v[156:159], a[236:239], v[84:87]
s_waitcnt lgkmcnt(8)
s_barrier
v_mfma_f32_16x16x32_bf16 v[72:75], v[160:163], a[96:99], v[72:75]
s_add_u32 m0, s32, 98304
s_add_u32 s29, s33, 1048576
v_mfma_f32_16x16x32_bf16 v[72:75], v[164:167], a[100:103], v[72:75]
buffer_load_dwordx4 v6, s[60:63], s29 offen offset:0  lds
v_mfma_f32_16x16x32_bf16 v[72:75], v[168:171], a[104:107], v[72:75]
ds_read_b64_tr_b16 v[144:145], v14 offset:16384
ds_read_b64_tr_b16 v[146:147], v14 offset:18432
v_mfma_f32_16x16x32_bf16 v[72:75], v[172:175], a[108:111], v[72:75]
ds_read_b64_tr_b16 v[148:149], v14 offset:20480
ds_read_b64_tr_b16 v[150:151], v14 offset:22528
v_mfma_f32_16x16x32_bf16 v[88:91], v[160:163], a[224:227], v[88:91]
ds_read_b64_tr_b16 v[152:153], v14 offset:24576
ds_read_b64_tr_b16 v[154:155], v14 offset:26624
v_mfma_f32_16x16x32_bf16 v[88:91], v[164:167], a[228:231], v[88:91]
ds_read_b64_tr_b16 v[156:157], v14 offset:28672
v_mfma_f32_16x16x32_bf16 v[88:91], v[168:171], a[232:235], v[88:91]
ds_read_b64_tr_b16 v[158:159], v14 offset:30720
v_mfma_f32_16x16x32_bf16 v[88:91], v[172:175], a[236:239], v[88:91]
s_waitcnt lgkmcnt(8)
v_mfma_f32_16x16x32_bf16 v[76:79], v[176:179], a[96:99], v[76:79]
buffer_load_dwordx4 v7, s[60:63], s29 offen offset:1024  lds
v_mfma_f32_16x16x32_bf16 v[76:79], v[180:183], a[100:103], v[76:79]
ds_read_b64_tr_b16 v[160:161], v15 offset:16384
ds_read_b64_tr_b16 v[162:163], v15 offset:18432
v_mfma_f32_16x16x32_bf16 v[76:79], v[184:187], a[104:107], v[76:79]
ds_read_b64_tr_b16 v[164:165], v15 offset:20480
ds_read_b64_tr_b16 v[166:167], v15 offset:22528
v_mfma_f32_16x16x32_bf16 v[76:79], v[188:191], a[108:111], v[76:79]
ds_read_b64_tr_b16 v[168:169], v15 offset:24576
v_mfma_f32_16x16x32_bf16 v[92:95], v[176:179], a[224:227], v[92:95]
ds_read_b64_tr_b16 v[170:171], v15 offset:26624
v_mfma_f32_16x16x32_bf16 v[92:95], v[180:183], a[228:231], v[92:95]
ds_read_b64_tr_b16 v[172:173], v15 offset:28672
v_mfma_f32_16x16x32_bf16 v[92:95], v[184:187], a[232:235], v[92:95]
ds_read_b64_tr_b16 v[174:175], v15 offset:30720
v_mfma_f32_16x16x32_bf16 v[92:95], v[188:191], a[236:239], v[92:95]
s_waitcnt lgkmcnt(8)
v_mfma_f32_16x16x32_bf16 v[96:99], v[144:147], a[48:51], v[96:99]
buffer_load_dwordx4 v8, s[60:63], s29 offen offset:2048  lds
v_mfma_f32_16x16x32_bf16 v[96:99], v[148:151], a[52:55], v[96:99]
ds_read_b64_tr_b16 v[176:177], v16 offset:16384
ds_read_b64_tr_b16 v[178:179], v16 offset:18432
v_mfma_f32_16x16x32_bf16 v[96:99], v[152:155], a[56:59], v[96:99]
ds_read_b64_tr_b16 v[180:181], v16 offset:20480
ds_read_b64_tr_b16 v[182:183], v16 offset:22528
v_mfma_f32_16x16x32_bf16 v[96:99], v[156:159], a[60:63], v[96:99]
ds_read_b64_tr_b16 v[184:185], v16 offset:24576
v_mfma_f32_16x16x32_bf16 v[112:115], v[144:147], a[176:179], v[112:115]
ds_read_b64_tr_b16 v[186:187], v16 offset:26624
v_mfma_f32_16x16x32_bf16 v[112:115], v[148:151], a[180:183], v[112:115]
ds_read_b64_tr_b16 v[188:189], v16 offset:28672
v_mfma_f32_16x16x32_bf16 v[112:115], v[152:155], a[184:187], v[112:115]
v_cvt_pk_bf16_f32 v32, v32, v33
v_cvt_pk_bf16_f32 v33, v34, v35
v_mfma_f32_16x16x32_bf16 v[112:115], v[156:159], a[188:191], v[112:115]
v_cvt_pk_bf16_f32 v34, v36, v37
s_waitcnt lgkmcnt(7)
v_mfma_f32_16x16x32_bf16 v[100:103], v[160:163], a[48:51], v[100:103]
v_cvt_pk_bf16_f32 v35, v38, v39
v_cvt_pk_bf16_f32 v36, v40, v41
v_mfma_f32_16x16x32_bf16 v[100:103], v[164:167], a[52:55], v[100:103]
ds_read_b64_tr_b16 v[190:191], v16 offset:30720
v_cvt_pk_bf16_f32 v37, v42, v43
v_mfma_f32_16x16x32_bf16 v[100:103], v[168:171], a[56:59], v[100:103]
ds_read_b64_tr_b16 v[144:145], v17 offset:16384
v_cvt_pk_bf16_f32 v38, v44, v45
v_mfma_f32_16x16x32_bf16 v[100:103], v[172:175], a[60:63], v[100:103]
ds_read_b64_tr_b16 v[146:147], v17 offset:18432
v_cvt_pk_bf16_f32 v39, v46, v47
v_cvt_pk_bf16_f32 v40, v48, v49
v_mfma_f32_16x16x32_bf16 v[116:119], v[160:163], a[176:179], v[116:119]
ds_read_b64_tr_b16 v[148:149], v17 offset:20480
v_cvt_pk_bf16_f32 v41, v50, v51
v_cvt_pk_bf16_f32 v42, v52, v53
v_mfma_f32_16x16x32_bf16 v[116:119], v[164:167], a[180:183], v[116:119]
ds_read_b64_tr_b16 v[150:151], v17 offset:22528
v_cvt_pk_bf16_f32 v43, v54, v55
v_mfma_f32_16x16x32_bf16 v[116:119], v[168:171], a[184:187], v[116:119]
buffer_load_dwordx4 v18, s[60:63], s29 offen offset:3072  lds
ds_read_b64_tr_b16 v[152:153], v17 offset:24576
v_cvt_pk_bf16_f32 v44, v56, v57
v_cvt_pk_bf16_f32 v45, v58, v59
v_mfma_f32_16x16x32_bf16 v[116:119], v[172:175], a[188:191], v[116:119]
ds_read_b64_tr_b16 v[154:155], v17 offset:26624
v_cvt_pk_bf16_f32 v46, v60, v61
s_waitcnt lgkmcnt(6)
s_barrier
v_mfma_f32_16x16x32_bf16 v[104:107], v[176:179], a[48:51], v[104:107]
ds_read_b64_tr_b16 v[156:157], v17 offset:28672
v_cvt_pk_bf16_f32 v47, v62, v63
v_cvt_pk_bf16_f32 v64, v64, v65
v_mfma_f32_16x16x32_bf16 v[104:107], v[180:183], a[52:55], v[104:107]
ds_read_b64_tr_b16 v[158:159], v17 offset:30720
v_cvt_pk_bf16_f32 v65, v66, v67
v_cvt_pk_bf16_f32 v66, v68, v69
v_mfma_f32_16x16x32_bf16 v[104:107], v[184:187], a[56:59], v[104:107]
buffer_store_dwordx4 v[32:35], v20, s[12:15], s57 offen offset:0 sc1
ds_read_b64_tr_b16 v[160:161], v2 offset:0
v_cvt_pk_bf16_f32 v67, v70, v71
v_mfma_f32_16x16x32_bf16 v[104:107], v[188:191], a[60:63], v[104:107]
ds_read_b64_tr_b16 v[162:163], v2 offset:2048
v_cvt_pk_bf16_f32 v68, v72, v73
v_cvt_pk_bf16_f32 v69, v74, v75
v_mfma_f32_16x16x32_bf16 v[120:123], v[176:179], a[176:179], v[120:123]
ds_read_b64_tr_b16 v[164:165], v2 offset:4096
v_cvt_pk_bf16_f32 v70, v76, v77
v_mfma_f32_16x16x32_bf16 v[120:123], v[180:183], a[180:183], v[120:123]
ds_read_b64_tr_b16 v[166:167], v2 offset:6144
v_cvt_pk_bf16_f32 v71, v78, v79
v_cvt_pk_bf16_f32 v72, v80, v81
v_mfma_f32_16x16x32_bf16 v[120:123], v[184:187], a[184:187], v[120:123]
s_add_u32 m0, s32, 114688
s_add_u32 s29, s33, 262144
buffer_load_dwordx4 v6, s[60:63], s29 offen offset:0  lds
ds_read_b64_tr_b16 v[168:169], v2 offset:8192
v_cvt_pk_bf16_f32 v73, v82, v83
v_cvt_pk_bf16_f32 v74, v84, v85
v_mfma_f32_16x16x32_bf16 v[120:123], v[188:191], a[188:191], v[120:123]
ds_read_b64_tr_b16 v[170:171], v2 offset:10240
v_cvt_pk_bf16_f32 v75, v86, v87
s_waitcnt lgkmcnt(6)
v_mfma_f32_16x16x32_bf16 v[108:111], v[144:147], a[48:51], v[108:111]
ds_read_b64_tr_b16 v[172:173], v2 offset:12288
v_cvt_pk_bf16_f32 v76, v88, v89
v_cvt_pk_bf16_f32 v77, v90, v91
v_mfma_f32_16x16x32_bf16 v[108:111], v[148:151], a[52:55], v[108:111]
ds_read_b64_tr_b16 v[174:175], v2 offset:14336
v_cvt_pk_bf16_f32 v78, v92, v93
v_mfma_f32_16x16x32_bf16 v[108:111], v[152:155], a[56:59], v[108:111]
ds_read_b64_tr_b16 v[176:177], v3 offset:0
v_cvt_pk_bf16_f32 v79, v94, v95
v_mfma_f32_16x16x32_bf16 v[108:111], v[156:159], a[60:63], v[108:111]
ds_read_b64_tr_b16 v[178:179], v3 offset:2048
ds_read_b64_tr_b16 v[180:181], v3 offset:4096
v_mfma_f32_16x16x32_bf16 v[124:127], v[144:147], a[176:179], v[124:127]
buffer_store_dwordx4 v[36:39], v20, s[12:15], s57 offen offset:1024 sc1
v_mfma_f32_16x16x32_bf16 v[124:127], v[148:151], a[180:183], v[124:127]
ds_read_b64_tr_b16 v[182:183], v3 offset:6144
ds_read_b64_tr_b16 v[184:185], v3 offset:8192
v_mfma_f32_16x16x32_bf16 v[124:127], v[152:155], a[184:187], v[124:127]
buffer_load_dwordx4 v7, s[60:63], s29 offen offset:1024  lds
v_mfma_f32_16x16x32_bf16 v[124:127], v[156:159], a[188:191], v[124:127]
ds_read_b64_tr_b16 v[186:187], v3 offset:10240
s_waitcnt lgkmcnt(6)
v_mfma_f32_16x16x32_bf16 v[96:99], v[160:163], a[64:67], v[96:99]
ds_read_b64_tr_b16 v[188:189], v3 offset:12288
ds_read_b64_tr_b16 v[190:191], v3 offset:14336
v_mfma_f32_16x16x32_bf16 v[96:99], v[164:167], a[68:71], v[96:99]
buffer_load_dwordx4 v8, s[60:63], s29 offen offset:2048  lds
v_mfma_f32_16x16x32_bf16 v[96:99], v[168:171], a[72:75], v[96:99]
ds_read_b64_tr_b16 v[144:145], v4 offset:0
ds_read_b64_tr_b16 v[146:147], v4 offset:2048
v_mfma_f32_16x16x32_bf16 v[96:99], v[172:175], a[76:79], v[96:99]
ds_read_b64_tr_b16 v[148:149], v4 offset:4096
ds_read_b64_tr_b16 v[150:151], v4 offset:6144
v_mfma_f32_16x16x32_bf16 v[112:115], v[160:163], a[192:195], v[112:115]
ds_read_b64_tr_b16 v[152:153], v4 offset:8192
ds_read_b64_tr_b16 v[154:155], v4 offset:10240
v_mfma_f32_16x16x32_bf16 v[112:115], v[164:167], a[196:199], v[112:115]
ds_read_b64_tr_b16 v[156:157], v4 offset:12288
v_mfma_f32_16x16x32_bf16 v[112:115], v[168:171], a[200:203], v[112:115]
buffer_store_dwordx4 v[40:43], v20, s[12:15], s57 offen offset:2048 sc1
v_mfma_f32_16x16x32_bf16 v[112:115], v[172:175], a[204:207], v[112:115]
ds_read_b64_tr_b16 v[158:159], v4 offset:14336
s_waitcnt lgkmcnt(8)
v_mfma_f32_16x16x32_bf16 v[100:103], v[176:179], a[64:67], v[100:103]
buffer_load_dwordx4 v18, s[60:63], s29 offen offset:3072  lds
v_mfma_f32_16x16x32_bf16 v[100:103], v[180:183], a[68:71], v[100:103]
ds_read_b64_tr_b16 v[160:161], v5 offset:0
ds_read_b64_tr_b16 v[162:163], v5 offset:2048
v_mfma_f32_16x16x32_bf16 v[100:103], v[184:187], a[72:75], v[100:103]
ds_read_b64_tr_b16 v[164:165], v5 offset:4096
ds_read_b64_tr_b16 v[166:167], v5 offset:6144
v_mfma_f32_16x16x32_bf16 v[100:103], v[188:191], a[76:79], v[100:103]
ds_read_b64_tr_b16 v[168:169], v5 offset:8192
v_mfma_f32_16x16x32_bf16 v[116:119], v[176:179], a[192:195], v[116:119]
ds_read_b64_tr_b16 v[170:171], v5 offset:10240
v_mfma_f32_16x16x32_bf16 v[116:119], v[180:183], a[196:199], v[116:119]
ds_read_b64_tr_b16 v[172:173], v5 offset:12288
v_mfma_f32_16x16x32_bf16 v[116:119], v[184:187], a[200:203], v[116:119]
ds_read_b64_tr_b16 v[174:175], v5 offset:14336
v_mfma_f32_16x16x32_bf16 v[116:119], v[188:191], a[204:207], v[116:119]
s_waitcnt lgkmcnt(8)
s_barrier
v_mfma_f32_16x16x32_bf16 v[104:107], v[144:147], a[64:67], v[104:107]
buffer_store_dwordx4 v[44:47], v20, s[12:15], s57 offen offset:3072 sc1
v_mfma_f32_16x16x32_bf16 v[104:107], v[148:151], a[68:71], v[104:107]
s_add_u32 m0, s32, 131072
s_add_u32 s29, s33, 1179648
v_mfma_f32_16x16x32_bf16 v[104:107], v[152:155], a[72:75], v[104:107]
ds_read_b64_tr_b16 v[176:177], v2 offset:16384
ds_read_b64_tr_b16 v[178:179], v2 offset:18432
v_mfma_f32_16x16x32_bf16 v[104:107], v[156:159], a[76:79], v[104:107]
buffer_load_dwordx4 v6, s[60:63], s29 offen offset:0  lds
v_mfma_f32_16x16x32_bf16 v[120:123], v[144:147], a[192:195], v[120:123]
ds_read_b64_tr_b16 v[180:181], v2 offset:20480
ds_read_b64_tr_b16 v[182:183], v2 offset:22528
v_mfma_f32_16x16x32_bf16 v[120:123], v[148:151], a[196:199], v[120:123]
ds_read_b64_tr_b16 v[184:185], v2 offset:24576
ds_read_b64_tr_b16 v[186:187], v2 offset:26624
v_mfma_f32_16x16x32_bf16 v[120:123], v[152:155], a[200:203], v[120:123]
ds_read_b64_tr_b16 v[188:189], v2 offset:28672
ds_read_b64_tr_b16 v[190:191], v2 offset:30720
v_mfma_f32_16x16x32_bf16 v[120:123], v[156:159], a[204:207], v[120:123]
s_waitcnt lgkmcnt(8)
v_mfma_f32_16x16x32_bf16 v[108:111], v[160:163], a[64:67], v[108:111]
buffer_load_dwordx4 v7, s[60:63], s29 offen offset:1024  lds
v_mfma_f32_16x16x32_bf16 v[108:111], v[164:167], a[68:71], v[108:111]
ds_read_b64_tr_b16 v[144:145], v3 offset:16384
ds_read_b64_tr_b16 v[146:147], v3 offset:18432
v_mfma_f32_16x16x32_bf16 v[108:111], v[168:171], a[72:75], v[108:111]
buffer_store_dwordx4 v[64:67], v255, s[12:15], s57 offen offset:0 sc1
v_mfma_f32_16x16x32_bf16 v[108:111], v[172:175], a[76:79], v[108:111]
ds_read_b64_tr_b16 v[148:149], v3 offset:20480
ds_read_b64_tr_b16 v[150:151], v3 offset:22528
v_mfma_f32_16x16x32_bf16 v[124:127], v[160:163], a[192:195], v[124:127]
ds_read_b64_tr_b16 v[152:153], v3 offset:24576
ds_read_b64_tr_b16 v[154:155], v3 offset:26624
v_mfma_f32_16x16x32_bf16 v[124:127], v[164:167], a[196:199], v[124:127]
ds_read_b64_tr_b16 v[156:157], v3 offset:28672
v_mfma_f32_16x16x32_bf16 v[124:127], v[168:171], a[200:203], v[124:127]
ds_read_b64_tr_b16 v[158:159], v3 offset:30720
v_mfma_f32_16x16x32_bf16 v[124:127], v[172:175], a[204:207], v[124:127]
s_waitcnt lgkmcnt(8)
v_mfma_f32_16x16x32_bf16 v[96:99], v[176:179], a[80:83], v[96:99]
buffer_load_dwordx4 v8, s[60:63], s29 offen offset:2048  lds
v_mfma_f32_16x16x32_bf16 v[96:99], v[180:183], a[84:87], v[96:99]
ds_read_b64_tr_b16 v[160:161], v4 offset:16384
ds_read_b64_tr_b16 v[162:163], v4 offset:18432
v_mfma_f32_16x16x32_bf16 v[96:99], v[184:187], a[88:91], v[96:99]
ds_read_b64_tr_b16 v[164:165], v4 offset:20480
ds_read_b64_tr_b16 v[166:167], v4 offset:22528
v_mfma_f32_16x16x32_bf16 v[96:99], v[188:191], a[92:95], v[96:99]
ds_read_b64_tr_b16 v[168:169], v4 offset:24576
v_mfma_f32_16x16x32_bf16 v[112:115], v[176:179], a[208:211], v[112:115]
buffer_store_dwordx4 v[68:71], v255, s[12:15], s57 offen offset:1024 sc1
v_mfma_f32_16x16x32_bf16 v[112:115], v[180:183], a[212:215], v[112:115]
ds_read_b64_tr_b16 v[170:171], v4 offset:26624
ds_read_b64_tr_b16 v[172:173], v4 offset:28672
v_mfma_f32_16x16x32_bf16 v[112:115], v[184:187], a[216:219], v[112:115]
ds_read_b64_tr_b16 v[174:175], v4 offset:30720
v_mfma_f32_16x16x32_bf16 v[112:115], v[188:191], a[220:223], v[112:115]
s_waitcnt lgkmcnt(8)
v_mfma_f32_16x16x32_bf16 v[100:103], v[144:147], a[80:83], v[100:103]
buffer_load_dwordx4 v18, s[60:63], s29 offen offset:3072  lds
v_mfma_f32_16x16x32_bf16 v[100:103], v[148:151], a[84:87], v[100:103]
ds_read_b64_tr_b16 v[176:177], v5 offset:16384
ds_read_b64_tr_b16 v[178:179], v5 offset:18432
v_mfma_f32_16x16x32_bf16 v[100:103], v[152:155], a[88:91], v[100:103]
ds_read_b64_tr_b16 v[180:181], v5 offset:20480
ds_read_b64_tr_b16 v[182:183], v5 offset:22528
v_mfma_f32_16x16x32_bf16 v[100:103], v[156:159], a[92:95], v[100:103]
ds_read_b64_tr_b16 v[184:185], v5 offset:24576
v_mfma_f32_16x16x32_bf16 v[116:119], v[144:147], a[208:211], v[116:119]
ds_read_b64_tr_b16 v[186:187], v5 offset:26624
v_mfma_f32_16x16x32_bf16 v[116:119], v[148:151], a[212:215], v[116:119]
ds_read_b64_tr_b16 v[188:189], v5 offset:28672
v_mfma_f32_16x16x32_bf16 v[116:119], v[152:155], a[216:219], v[116:119]
buffer_store_dwordx4 v[72:75], v255, s[12:15], s57 offen offset:2048 sc1
v_mfma_f32_16x16x32_bf16 v[116:119], v[156:159], a[220:223], v[116:119]
s_waitcnt lgkmcnt(7)
s_waitcnt vmcnt(35)
s_barrier
v_mfma_f32_16x16x32_bf16 v[104:107], v[160:163], a[80:83], v[104:107]
s_add_u32 m0, s32, 147456
s_add_u32 s29, s33, 393216
v_mfma_f32_16x16x32_bf16 v[104:107], v[164:167], a[84:87], v[104:107]
ds_read_b64_tr_b16 v[190:191], v5 offset:30720
s_add_u32 s29, s29, s31
v_mfma_f32_16x16x32_bf16 v[104:107], v[168:171], a[88:91], v[104:107]
ds_read_b64_tr_b16 v[144:145], v2 offset:32768
ds_read_b64_tr_b16 v[146:147], v2 offset:34816
v_mfma_f32_16x16x32_bf16 v[104:107], v[172:175], a[92:95], v[104:107]
buffer_load_dwordx4 v6, s[60:63], s29 offen offset:0  lds
v_mfma_f32_16x16x32_bf16 v[120:123], v[160:163], a[208:211], v[120:123]
ds_read_b64_tr_b16 v[148:149], v2 offset:36864
ds_read_b64_tr_b16 v[150:151], v2 offset:38912
v_mfma_f32_16x16x32_bf16 v[120:123], v[164:167], a[212:215], v[120:123]
ds_read_b64_tr_b16 v[152:153], v2 offset:40960
ds_read_b64_tr_b16 v[154:155], v2 offset:43008
v_mfma_f32_16x16x32_bf16 v[120:123], v[168:171], a[216:219], v[120:123]
ds_read_b64_tr_b16 v[156:157], v2 offset:45056
ds_read_b64_tr_b16 v[158:159], v2 offset:47104
v_mfma_f32_16x16x32_bf16 v[120:123], v[172:175], a[220:223], v[120:123]
s_waitcnt lgkmcnt(8)
v_mfma_f32_16x16x32_bf16 v[108:111], v[176:179], a[80:83], v[108:111]
buffer_store_dwordx4 v[76:79], v255, s[12:15], s57 offen offset:3072 sc1
v_mfma_f32_16x16x32_bf16 v[108:111], v[180:183], a[84:87], v[108:111]
buffer_load_dwordx4 v7, s[60:63], s29 offen offset:1024  lds
v_mfma_f32_16x16x32_bf16 v[108:111], v[184:187], a[88:91], v[108:111]
ds_read_b64_tr_b16 v[160:161], v3 offset:32768
ds_read_b64_tr_b16 v[162:163], v3 offset:34816
v_mfma_f32_16x16x32_bf16 v[108:111], v[188:191], a[92:95], v[108:111]
ds_read_b64_tr_b16 v[164:165], v3 offset:36864
ds_read_b64_tr_b16 v[166:167], v3 offset:38912
v_mfma_f32_16x16x32_bf16 v[124:127], v[176:179], a[208:211], v[124:127]
ds_read_b64_tr_b16 v[168:169], v3 offset:40960
ds_read_b64_tr_b16 v[170:171], v3 offset:43008
v_mfma_f32_16x16x32_bf16 v[124:127], v[180:183], a[212:215], v[124:127]
ds_read_b64_tr_b16 v[172:173], v3 offset:45056
v_mfma_f32_16x16x32_bf16 v[124:127], v[184:187], a[216:219], v[124:127]
ds_read_b64_tr_b16 v[174:175], v3 offset:47104
v_mfma_f32_16x16x32_bf16 v[124:127], v[188:191], a[220:223], v[124:127]
s_waitcnt lgkmcnt(8)
v_mfma_f32_16x16x32_bf16 v[96:99], v[144:147], a[96:99], v[96:99]
buffer_load_dwordx4 v8, s[60:63], s29 offen offset:2048  lds
v_mfma_f32_16x16x32_bf16 v[96:99], v[148:151], a[100:103], v[96:99]
ds_read_b64_tr_b16 v[176:177], v4 offset:32768
ds_read_b64_tr_b16 v[178:179], v4 offset:34816
v_mfma_f32_16x16x32_bf16 v[96:99], v[152:155], a[104:107], v[96:99]
ds_read_b64_tr_b16 v[180:181], v4 offset:36864
ds_read_b64_tr_b16 v[182:183], v4 offset:38912
v_mfma_f32_16x16x32_bf16 v[96:99], v[156:159], a[108:111], v[96:99]
ds_read_b64_tr_b16 v[184:185], v4 offset:40960
v_mfma_f32_16x16x32_bf16 v[112:115], v[144:147], a[224:227], v[112:115]
ds_read_b64_tr_b16 v[186:187], v4 offset:43008
v_mfma_f32_16x16x32_bf16 v[112:115], v[148:151], a[228:231], v[112:115]
ds_read_b64_tr_b16 v[188:189], v4 offset:45056
v_mfma_f32_16x16x32_bf16 v[112:115], v[152:155], a[232:235], v[112:115]
ds_read_b64_tr_b16 v[190:191], v4 offset:47104
v_mfma_f32_16x16x32_bf16 v[112:115], v[156:159], a[236:239], v[112:115]
s_waitcnt lgkmcnt(8)
v_mfma_f32_16x16x32_bf16 v[100:103], v[160:163], a[96:99], v[100:103]
buffer_load_dwordx4 v18, s[60:63], s29 offen offset:3072  lds
v_mfma_f32_16x16x32_bf16 v[100:103], v[164:167], a[100:103], v[100:103]
ds_read_b64_tr_b16 v[144:145], v5 offset:32768
ds_read_b64_tr_b16 v[146:147], v5 offset:34816
v_mfma_f32_16x16x32_bf16 v[100:103], v[168:171], a[104:107], v[100:103]
ds_read_b64_tr_b16 v[148:149], v5 offset:36864
ds_read_b64_tr_b16 v[150:151], v5 offset:38912
v_mfma_f32_16x16x32_bf16 v[100:103], v[172:175], a[108:111], v[100:103]
ds_read_b64_tr_b16 v[152:153], v5 offset:40960
v_mfma_f32_16x16x32_bf16 v[116:119], v[160:163], a[224:227], v[116:119]
ds_read_b64_tr_b16 v[154:155], v5 offset:43008
v_mfma_f32_16x16x32_bf16 v[116:119], v[164:167], a[228:231], v[116:119]
ds_read_b64_tr_b16 v[156:157], v5 offset:45056
v_mfma_f32_16x16x32_bf16 v[116:119], v[168:171], a[232:235], v[116:119]
ds_read_b64_tr_b16 v[158:159], v5 offset:47104
v_mfma_f32_16x16x32_bf16 v[116:119], v[172:175], a[236:239], v[116:119]
s_waitcnt lgkmcnt(8)
s_waitcnt vmcnt(36)
s_barrier
v_mfma_f32_16x16x32_bf16 v[104:107], v[176:179], a[96:99], v[104:107]
ds_read_b64_tr_b16 v[160:161], v2 offset:49152
ds_read_b64_tr_b16 v[162:163], v2 offset:51200
v_mfma_f32_16x16x32_bf16 v[104:107], v[180:183], a[100:103], v[104:107]
ds_read_b64_tr_b16 v[164:165], v2 offset:53248
v_mfma_f32_16x16x32_bf16 v[104:107], v[184:187], a[104:107], v[104:107]
ds_read_b64_tr_b16 v[166:167], v2 offset:55296
v_mfma_f32_16x16x32_bf16 v[104:107], v[188:191], a[108:111], v[104:107]
ds_read_b64_tr_b16 v[168:169], v2 offset:57344
v_mfma_f32_16x16x32_bf16 v[120:123], v[176:179], a[224:227], v[120:123]
ds_read_b64_tr_b16 v[170:171], v2 offset:59392
v_mfma_f32_16x16x32_bf16 v[120:123], v[180:183], a[228:231], v[120:123]
ds_read_b64_tr_b16 v[172:173], v2 offset:61440
v_mfma_f32_16x16x32_bf16 v[120:123], v[184:187], a[232:235], v[120:123]
ds_read_b64_tr_b16 v[174:175], v2 offset:63488
v_mfma_f32_16x16x32_bf16 v[120:123], v[188:191], a[236:239], v[120:123]
s_waitcnt lgkmcnt(8)
v_mfma_f32_16x16x32_bf16 v[108:111], v[144:147], a[96:99], v[108:111]
ds_read_b64_tr_b16 v[176:177], v3 offset:49152
ds_read_b64_tr_b16 v[178:179], v3 offset:51200
v_mfma_f32_16x16x32_bf16 v[108:111], v[148:151], a[100:103], v[108:111]
ds_read_b64_tr_b16 v[180:181], v3 offset:53248
v_mfma_f32_16x16x32_bf16 v[108:111], v[152:155], a[104:107], v[108:111]
ds_read_b64_tr_b16 v[182:183], v3 offset:55296
v_mfma_f32_16x16x32_bf16 v[108:111], v[156:159], a[108:111], v[108:111]
ds_read_b64_tr_b16 v[184:185], v3 offset:57344
v_mfma_f32_16x16x32_bf16 v[124:127], v[144:147], a[224:227], v[124:127]
ds_read_b64_tr_b16 v[186:187], v3 offset:59392
v_mfma_f32_16x16x32_bf16 v[124:127], v[148:151], a[228:231], v[124:127]
ds_read_b64_tr_b16 v[188:189], v3 offset:61440
v_mfma_f32_16x16x32_bf16 v[124:127], v[152:155], a[232:235], v[124:127]
ds_read_b64_tr_b16 v[190:191], v3 offset:63488
v_mfma_f32_16x16x32_bf16 v[124:127], v[156:159], a[236:239], v[124:127]
s_waitcnt lgkmcnt(8)
v_mfma_f32_16x16x32_bf16 v[32:35], v[160:163], a[0:3], 0
ds_read_b64_tr_b16 v[144:145], v4 offset:49152
ds_read_b64_tr_b16 v[146:147], v4 offset:51200
v_mfma_f32_16x16x32_bf16 v[32:35], v[164:167], a[4:7], v[32:35]
ds_read_b64_tr_b16 v[148:149], v4 offset:53248
v_mfma_f32_16x16x32_bf16 v[32:35], v[168:171], a[8:11], v[32:35]
ds_read_b64_tr_b16 v[150:151], v4 offset:55296
v_mfma_f32_16x16x32_bf16 v[32:35], v[172:175], a[12:15], v[32:35]
ds_read_b64_tr_b16 v[152:153], v4 offset:57344
v_mfma_f32_16x16x32_bf16 v[48:51], v[160:163], a[128:131], 0
v_cvt_pk_bf16_f32 v96, v96, v97
v_cvt_pk_bf16_f32 v97, v98, v99
v_mfma_f32_16x16x32_bf16 v[48:51], v[164:167], a[132:135], v[48:51]
s_waitcnt vmcnt(3)
buffer_store_dword v31, v30, s[12:15], s59 offen offset:20 sc1
v_mfma_f32_16x16x32_bf16 v[48:51], v[168:171], a[136:139], v[48:51]
v_cvt_pk_bf16_f32 v98, v100, v101
v_cvt_pk_bf16_f32 v99, v102, v103
v_mfma_f32_16x16x32_bf16 v[48:51], v[172:175], a[140:143], v[48:51]
ds_read_b64_tr_b16 v[154:155], v4 offset:59392
v_cvt_pk_bf16_f32 v100, v104, v105
s_waitcnt lgkmcnt(6)
v_mfma_f32_16x16x32_bf16 v[36:39], v[176:179], a[0:3], 0
ds_read_b64_tr_b16 v[156:157], v4 offset:61440
v_cvt_pk_bf16_f32 v101, v106, v107
v_mfma_f32_16x16x32_bf16 v[36:39], v[180:183], a[4:7], v[36:39]
buffer_store_dwordx4 v[96:99], v232, s[12:15], s57 offen offset:0 sc1
ds_read_b64_tr_b16 v[158:159], v4 offset:63488
v_cvt_pk_bf16_f32 v102, v108, v109
v_mfma_f32_16x16x32_bf16 v[36:39], v[184:187], a[8:11], v[36:39]
ds_read_b64_tr_b16 v[160:161], v5 offset:49152
v_cvt_pk_bf16_f32 v103, v110, v111
v_cvt_pk_bf16_f32 v104, v112, v113
v_mfma_f32_16x16x32_bf16 v[36:39], v[188:191], a[12:15], v[36:39]
ds_read_b64_tr_b16 v[162:163], v5 offset:51200
v_cvt_pk_bf16_f32 v105, v114, v115
v_mfma_f32_16x16x32_bf16 v[52:55], v[176:179], a[128:131], 0
buffer_store_dwordx4 v[100:103], v232, s[12:15], s57 offen offset:1024 sc1
ds_read_b64_tr_b16 v[164:165], v5 offset:53248
v_cvt_pk_bf16_f32 v106, v116, v117
v_mfma_f32_16x16x32_bf16 v[52:55], v[180:183], a[132:135], v[52:55]
ds_read_b64_tr_b16 v[166:167], v5 offset:55296
v_cvt_pk_bf16_f32 v107, v118, v119
v_cvt_pk_bf16_f32 v108, v120, v121
v_mfma_f32_16x16x32_bf16 v[52:55], v[184:187], a[136:139], v[52:55]
ds_read_b64_tr_b16 v[168:169], v5 offset:57344
v_cvt_pk_bf16_f32 v109, v122, v123
v_mfma_f32_16x16x32_bf16 v[52:55], v[188:191], a[140:143], v[52:55]
buffer_store_dwordx4 v[104:107], v232, s[12:15], s57 offen offset:2048 sc1
ds_read_b64_tr_b16 v[170:171], v5 offset:59392
v_cvt_pk_bf16_f32 v110, v124, v125
s_waitcnt lgkmcnt(6)
s_barrier
v_mfma_f32_16x16x32_bf16 v[40:43], v[144:147], a[0:3], 0
ds_read_b64_tr_b16 v[172:173], v5 offset:61440
v_cvt_pk_bf16_f32 v111, v126, v127
v_mfma_f32_16x16x32_bf16 v[40:43], v[148:151], a[4:7], v[40:43]
ds_read_b64_tr_b16 v[174:175], v5 offset:63488
ds_read_b64_tr_b16 v[176:177], v10 offset:0
v_mfma_f32_16x16x32_bf16 v[40:43], v[152:155], a[8:11], v[40:43]
buffer_store_dwordx4 v[108:111], v232, s[12:15], s57 offen offset:3072 sc1
v_mfma_f32_16x16x32_bf16 v[40:43], v[156:159], a[12:15], v[40:43]
ds_read_b64_tr_b16 v[178:179], v10 offset:2048
ds_read_b64_tr_b16 v[180:181], v10 offset:4096
v_mfma_f32_16x16x32_bf16 v[56:59], v[144:147], a[128:131], 0
ds_read_b64_tr_b16 v[182:183], v10 offset:6144
ds_read_b64_tr_b16 v[184:185], v10 offset:8192
v_mfma_f32_16x16x32_bf16 v[56:59], v[148:151], a[132:135], v[56:59]
ds_read_b64_tr_b16 v[186:187], v10 offset:10240
ds_read_b64_tr_b16 v[188:189], v10 offset:12288
v_mfma_f32_16x16x32_bf16 v[56:59], v[152:155], a[136:139], v[56:59]
v_lshlrev_b32 v96, 16, v216
v_mfma_f32_16x16x32_bf16 v[56:59], v[156:159], a[140:143], v[56:59]
v_and_b32 v97, 0xffff0000, v216
s_waitcnt lgkmcnt(7)
v_mfma_f32_16x16x32_bf16 v[44:47], v[160:163], a[0:3], 0
v_lshlrev_b32 v98, 16, v217
v_and_b32 v99, 0xffff0000, v217
v_mfma_f32_16x16x32_bf16 v[44:47], v[164:167], a[4:7], v[44:47]
ds_read_b64_tr_b16 v[190:191], v10 offset:14336
v_lshlrev_b32 v100, 16, v218
v_mfma_f32_16x16x32_bf16 v[44:47], v[168:171], a[8:11], v[44:47]
ds_read_b64_tr_b16 v[144:145], v11 offset:0
v_and_b32 v101, 0xffff0000, v218
v_mfma_f32_16x16x32_bf16 v[44:47], v[172:175], a[12:15], v[44:47]
ds_read_b64_tr_b16 v[146:147], v11 offset:2048
v_lshlrev_b32 v102, 16, v219
v_mfma_f32_16x16x32_bf16 v[60:63], v[160:163], a[128:131], 0
ds_read_b64_tr_b16 v[148:149], v11 offset:4096
v_and_b32 v103, 0xffff0000, v219
v_mfma_f32_16x16x32_bf16 v[60:63], v[164:167], a[132:135], v[60:63]
ds_read_b64_tr_b16 v[150:151], v11 offset:6144
v_lshlrev_b32 v104, 16, v220
v_mfma_f32_16x16x32_bf16 v[60:63], v[168:171], a[136:139], v[60:63]
ds_read_b64_tr_b16 v[152:153], v11 offset:8192
v_and_b32 v105, 0xffff0000, v220
v_mfma_f32_16x16x32_bf16 v[60:63], v[172:175], a[140:143], v[60:63]
ds_read_b64_tr_b16 v[154:155], v11 offset:10240
s_waitcnt lgkmcnt(6)
v_mfma_f32_16x16x32_bf16 v[32:35], v[176:179], a[16:19], v[32:35]
ds_read_b64_tr_b16 v[156:157], v11 offset:12288
v_lshlrev_b32 v106, 16, v221
v_mfma_f32_16x16x32_bf16 v[32:35], v[180:183], a[20:23], v[32:35]
ds_read_b64_tr_b16 v[158:159], v11 offset:14336
v_and_b32 v107, 0xffff0000, v221
v_mfma_f32_16x16x32_bf16 v[32:35], v[184:187], a[24:27], v[32:35]
ds_read_b64_tr_b16 v[160:161], v12 offset:0
v_lshlrev_b32 v108, 16, v222
v_mfma_f32_16x16x32_bf16 v[32:35], v[188:191], a[28:31], v[32:35]
ds_read_b64_tr_b16 v[162:163], v12 offset:2048
v_and_b32 v109, 0xffff0000, v222
v_mfma_f32_16x16x32_bf16 v[48:51], v[176:179], a[144:147], v[48:51]
ds_read_b64_tr_b16 v[164:165], v12 offset:4096
v_lshlrev_b32 v110, 16, v223
v_mfma_f32_16x16x32_bf16 v[48:51], v[180:183], a[148:151], v[48:51]
ds_read_b64_tr_b16 v[166:167], v12 offset:6144
v_and_b32 v111, 0xffff0000, v223
v_mfma_f32_16x16x32_bf16 v[48:51], v[184:187], a[152:155], v[48:51]
ds_read_b64_tr_b16 v[168:169], v12 offset:8192
v_lshlrev_b32 v112, 16, v224
v_mfma_f32_16x16x32_bf16 v[48:51], v[188:191], a[156:159], v[48:51]
ds_read_b64_tr_b16 v[170:171], v12 offset:10240
s_waitcnt lgkmcnt(6)
v_mfma_f32_16x16x32_bf16 v[36:39], v[144:147], a[16:19], v[36:39]
ds_read_b64_tr_b16 v[172:173], v12 offset:12288
v_and_b32 v113, 0xffff0000, v224
v_mfma_f32_16x16x32_bf16 v[36:39], v[148:151], a[20:23], v[36:39]
ds_read_b64_tr_b16 v[174:175], v12 offset:14336
v_lshlrev_b32 v114, 16, v225
v_mfma_f32_16x16x32_bf16 v[36:39], v[152:155], a[24:27], v[36:39]
ds_read_b64_tr_b16 v[176:177], v13 offset:0
v_and_b32 v115, 0xffff0000, v225
v_mfma_f32_16x16x32_bf16 v[36:39], v[156:159], a[28:31], v[36:39]
ds_read_b64_tr_b16 v[178:179], v13 offset:2048
v_lshlrev_b32 v116, 16, v226
v_mfma_f32_16x16x32_bf16 v[52:55], v[144:147], a[144:147], v[52:55]
ds_read_b64_tr_b16 v[180:181], v13 offset:4096
v_and_b32 v117, 0xffff0000, v226
v_mfma_f32_16x16x32_bf16 v[52:55], v[148:151], a[148:151], v[52:55]
ds_read_b64_tr_b16 v[182:183], v13 offset:6144
v_lshlrev_b32 v118, 16, v227
v_mfma_f32_16x16x32_bf16 v[52:55], v[152:155], a[152:155], v[52:55]
ds_read_b64_tr_b16 v[184:185], v13 offset:8192
v_and_b32 v119, 0xffff0000, v227
v_mfma_f32_16x16x32_bf16 v[52:55], v[156:159], a[156:159], v[52:55]
ds_read_b64_tr_b16 v[186:187], v13 offset:10240
s_waitcnt lgkmcnt(6)
s_barrier
v_mfma_f32_16x16x32_bf16 v[40:43], v[160:163], a[16:19], v[40:43]
ds_read_b64_tr_b16 v[188:189], v13 offset:12288
v_lshlrev_b32 v120, 16, v228
v_mfma_f32_16x16x32_bf16 v[40:43], v[164:167], a[20:23], v[40:43]
ds_read_b64_tr_b16 v[190:191], v13 offset:14336
v_and_b32 v121, 0xffff0000, v228
v_mfma_f32_16x16x32_bf16 v[40:43], v[168:171], a[24:27], v[40:43]
ds_read_b64_tr_b16 v[144:145], v10 offset:16384
v_lshlrev_b32 v122, 16, v229
v_mfma_f32_16x16x32_bf16 v[40:43], v[172:175], a[28:31], v[40:43]
ds_read_b64_tr_b16 v[146:147], v10 offset:18432
v_and_b32 v123, 0xffff0000, v229
v_mfma_f32_16x16x32_bf16 v[56:59], v[160:163], a[144:147], v[56:59]
ds_read_b64_tr_b16 v[148:149], v10 offset:20480
v_lshlrev_b32 v124, 16, v230
v_mfma_f32_16x16x32_bf16 v[56:59], v[164:167], a[148:151], v[56:59]
ds_read_b64_tr_b16 v[150:151], v10 offset:22528
v_and_b32 v125, 0xffff0000, v230
v_mfma_f32_16x16x32_bf16 v[56:59], v[168:171], a[152:155], v[56:59]
ds_read_b64_tr_b16 v[152:153], v10 offset:24576
v_lshlrev_b32 v126, 16, v231
v_mfma_f32_16x16x32_bf16 v[56:59], v[172:175], a[156:159], v[56:59]
s_waitcnt vmcnt(0)
buffer_store_dword v31, v30, s[12:15], s59 offen offset:24 sc1
ds_read_b64_tr_b16 v[154:155], v10 offset:26624
s_waitcnt lgkmcnt(6)
v_mfma_f32_16x16x32_bf16 v[44:47], v[176:179], a[16:19], v[44:47]
ds_read_b64_tr_b16 v[156:157], v10 offset:28672
v_and_b32 v127, 0xffff0000, v231
v_mfma_f32_16x16x32_bf16 v[44:47], v[180:183], a[20:23], v[44:47]
ds_read_b64_tr_b16 v[158:159], v10 offset:30720
ds_read_b64_tr_b16 v[160:161], v11 offset:16384
v_mfma_f32_16x16x32_bf16 v[44:47], v[184:187], a[24:27], v[44:47]
ds_read_b64_tr_b16 v[162:163], v11 offset:18432
ds_read_b64_tr_b16 v[164:165], v11 offset:20480
v_mfma_f32_16x16x32_bf16 v[44:47], v[188:191], a[28:31], v[44:47]
ds_read_b64_tr_b16 v[166:167], v11 offset:22528
ds_read_b64_tr_b16 v[168:169], v11 offset:24576
v_mfma_f32_16x16x32_bf16 v[60:63], v[176:179], a[144:147], v[60:63]
ds_read_b64_tr_b16 v[170:171], v11 offset:26624
v_mfma_f32_16x16x32_bf16 v[60:63], v[180:183], a[148:151], v[60:63]
ds_read_b64_tr_b16 v[172:173], v11 offset:28672
v_mfma_f32_16x16x32_bf16 v[60:63], v[184:187], a[152:155], v[60:63]
ds_read_b64_tr_b16 v[174:175], v11 offset:30720
v_mfma_f32_16x16x32_bf16 v[60:63], v[188:191], a[156:159], v[60:63]
s_waitcnt lgkmcnt(8)
v_mfma_f32_16x16x32_bf16 v[32:35], v[144:147], a[32:35], v[32:35]
ds_read_b64_tr_b16 v[176:177], v12 offset:16384
ds_read_b64_tr_b16 v[178:179], v12 offset:18432
v_mfma_f32_16x16x32_bf16 v[32:35], v[148:151], a[36:39], v[32:35]
s_buffer_load_dword s45, s[12:15], s41 offset:262164 glc
s_buffer_load_dword s46, s[12:15], s42 offset:262164 glc
v_mfma_f32_16x16x32_bf16 v[32:35], v[152:155], a[40:43], v[32:35]
ds_read_b64_tr_b16 v[180:181], v12 offset:20480
ds_read_b64_tr_b16 v[182:183], v12 offset:22528
v_mfma_f32_16x16x32_bf16 v[32:35], v[156:159], a[44:47], v[32:35]
ds_read_b64_tr_b16 v[184:185], v12 offset:24576
v_mfma_f32_16x16x32_bf16 v[48:51], v[144:147], a[160:163], v[48:51]
ds_read_b64_tr_b16 v[186:187], v12 offset:26624
v_mfma_f32_16x16x32_bf16 v[48:51], v[148:151], a[164:167], v[48:51]
ds_read_b64_tr_b16 v[188:189], v12 offset:28672
v_mfma_f32_16x16x32_bf16 v[48:51], v[152:155], a[168:171], v[48:51]
ds_read_b64_tr_b16 v[190:191], v12 offset:30720
v_mfma_f32_16x16x32_bf16 v[48:51], v[156:159], a[172:175], v[48:51]
s_waitcnt lgkmcnt(8)
v_mfma_f32_16x16x32_bf16 v[36:39], v[160:163], a[32:35], v[36:39]
ds_read_b64_tr_b16 v[144:145], v13 offset:16384
ds_read_b64_tr_b16 v[146:147], v13 offset:18432
v_mfma_f32_16x16x32_bf16 v[36:39], v[164:167], a[36:39], v[36:39]
ds_read_b64_tr_b16 v[148:149], v13 offset:20480
v_mfma_f32_16x16x32_bf16 v[36:39], v[168:171], a[40:43], v[36:39]
ds_read_b64_tr_b16 v[150:151], v13 offset:22528
v_mfma_f32_16x16x32_bf16 v[36:39], v[172:175], a[44:47], v[36:39]
ds_read_b64_tr_b16 v[152:153], v13 offset:24576
v_mfma_f32_16x16x32_bf16 v[52:55], v[160:163], a[160:163], v[52:55]
ds_read_b64_tr_b16 v[154:155], v13 offset:26624
v_mfma_f32_16x16x32_bf16 v[52:55], v[164:167], a[164:167], v[52:55]
ds_read_b64_tr_b16 v[156:157], v13 offset:28672
v_mfma_f32_16x16x32_bf16 v[52:55], v[168:171], a[168:171], v[52:55]
ds_read_b64_tr_b16 v[158:159], v13 offset:30720
v_mfma_f32_16x16x32_bf16 v[52:55], v[172:175], a[172:175], v[52:55]
s_waitcnt lgkmcnt(8)
s_barrier
v_mfma_f32_16x16x32_bf16 v[40:43], v[176:179], a[32:35], v[40:43]
ds_read_b64_tr_b16 v[160:161], v10 offset:32768
ds_read_b64_tr_b16 v[162:163], v10 offset:34816
v_mfma_f32_16x16x32_bf16 v[40:43], v[180:183], a[36:39], v[40:43]
ds_read_b64_tr_b16 v[164:165], v10 offset:36864
v_mfma_f32_16x16x32_bf16 v[40:43], v[184:187], a[40:43], v[40:43]
ds_read_b64_tr_b16 v[166:167], v10 offset:38912
v_mfma_f32_16x16x32_bf16 v[40:43], v[188:191], a[44:47], v[40:43]
ds_read_b64_tr_b16 v[168:169], v10 offset:40960
v_mfma_f32_16x16x32_bf16 v[56:59], v[176:179], a[160:163], v[56:59]
ds_read_b64_tr_b16 v[170:171], v10 offset:43008
v_mfma_f32_16x16x32_bf16 v[56:59], v[180:183], a[164:167], v[56:59]
ds_read_b64_tr_b16 v[172:173], v10 offset:45056
v_mfma_f32_16x16x32_bf16 v[56:59], v[184:187], a[168:171], v[56:59]
ds_read_b64_tr_b16 v[174:175], v10 offset:47104
v_mfma_f32_16x16x32_bf16 v[56:59], v[188:191], a[172:175], v[56:59]
s_waitcnt lgkmcnt(8)
v_mfma_f32_16x16x32_bf16 v[44:47], v[144:147], a[32:35], v[44:47]
ds_read_b64_tr_b16 v[176:177], v11 offset:32768
ds_read_b64_tr_b16 v[178:179], v11 offset:34816
v_mfma_f32_16x16x32_bf16 v[44:47], v[148:151], a[36:39], v[44:47]
ds_read_b64_tr_b16 v[180:181], v11 offset:36864
v_mfma_f32_16x16x32_bf16 v[44:47], v[152:155], a[40:43], v[44:47]
ds_read_b64_tr_b16 v[182:183], v11 offset:38912
v_mfma_f32_16x16x32_bf16 v[44:47], v[156:159], a[44:47], v[44:47]
ds_read_b64_tr_b16 v[184:185], v11 offset:40960
v_mfma_f32_16x16x32_bf16 v[60:63], v[144:147], a[160:163], v[60:63]
ds_read_b64_tr_b16 v[186:187], v11 offset:43008
v_mfma_f32_16x16x32_bf16 v[60:63], v[148:151], a[164:167], v[60:63]
ds_read_b64_tr_b16 v[188:189], v11 offset:45056
v_mfma_f32_16x16x32_bf16 v[60:63], v[152:155], a[168:171], v[60:63]
ds_read_b64_tr_b16 v[190:191], v11 offset:47104
v_mfma_f32_16x16x32_bf16 v[60:63], v[156:159], a[172:175], v[60:63]
s_waitcnt lgkmcnt(8)
v_mfma_f32_16x16x32_bf16 v[32:35], v[160:163], a[48:51], v[32:35]
ds_read_b64_tr_b16 v[144:145], v12 offset:32768
ds_read_b64_tr_b16 v[146:147], v12 offset:34816
v_mfma_f32_16x16x32_bf16 v[32:35], v[164:167], a[52:55], v[32:35]
ds_read_b64_tr_b16 v[148:149], v12 offset:36864
v_mfma_f32_16x16x32_bf16 v[32:35], v[168:171], a[56:59], v[32:35]
ds_read_b64_tr_b16 v[150:151], v12 offset:38912
v_mfma_f32_16x16x32_bf16 v[32:35], v[172:175], a[60:63], v[32:35]
ds_read_b64_tr_b16 v[152:153], v12 offset:40960
v_mfma_f32_16x16x32_bf16 v[48:51], v[160:163], a[176:179], v[48:51]
ds_read_b64_tr_b16 v[154:155], v12 offset:43008
v_mfma_f32_16x16x32_bf16 v[48:51], v[164:167], a[180:183], v[48:51]
ds_read_b64_tr_b16 v[156:157], v12 offset:45056
v_mfma_f32_16x16x32_bf16 v[48:51], v[168:171], a[184:187], v[48:51]
ds_read_b64_tr_b16 v[158:159], v12 offset:47104
v_mfma_f32_16x16x32_bf16 v[48:51], v[172:175], a[188:191], v[48:51]
s_waitcnt lgkmcnt(8)
v_mfma_f32_16x16x32_bf16 v[36:39], v[176:179], a[48:51], v[36:39]
ds_read_b64_tr_b16 v[160:161], v13 offset:32768
ds_read_b64_tr_b16 v[162:163], v13 offset:34816
v_mfma_f32_16x16x32_bf16 v[36:39], v[180:183], a[52:55], v[36:39]
s_waitcnt lgkmcnt(0)
s_and_b32 s45, s45, s46
s_cbranch_scc1 mlp_kernel_q9_ok
s_mov_b32 s27, 0x40000
mlp_kernel_q9:
s_sleep 4
s_buffer_load_dword s45, s[12:15], s41 offset:262164 glc
s_buffer_load_dword s46, s[12:15], s42 offset:262164 glc
s_waitcnt lgkmcnt(0)
s_sub_u32 s27, s27, 1
s_cbranch_scc1 mlp_kernel_q9_ok
s_and_b32 s45, s45, s46
s_cbranch_scc0 mlp_kernel_q9
mlp_kernel_q9_ok:
ds_read_b64_tr_b16 v[164:165], v13 offset:36864
v_mfma_f32_16x16x32_bf16 v[36:39], v[184:187], a[56:59], v[36:39]
buffer_load_dwordx4 v[64:67], v20, s[12:15], s58 offen offset:0 sc1
v_mfma_f32_16x16x32_bf16 v[36:39], v[188:191], a[60:63], v[36:39]
buffer_load_dwordx4 v[68:71], v20, s[12:15], s58 offen offset:1024 sc1
v_mfma_f32_16x16x32_bf16 v[52:55], v[176:179], a[176:179], v[52:55]
buffer_load_dwordx4 v[72:75], v20, s[12:15], s58 offen offset:2048 sc1
v_mfma_f32_16x16x32_bf16 v[52:55], v[180:183], a[180:183], v[52:55]
ds_read_b64_tr_b16 v[166:167], v13 offset:38912
ds_read_b64_tr_b16 v[168:169], v13 offset:40960
v_mfma_f32_16x16x32_bf16 v[52:55], v[184:187], a[184:187], v[52:55]
buffer_load_dwordx4 v[76:79], v20, s[12:15], s58 offen offset:3072 sc1
v_mfma_f32_16x16x32_bf16 v[52:55], v[188:191], a[188:191], v[52:55]
buffer_load_dwordx4 v[80:83], v20, s[12:15], s56 offen offset:0 sc1
ds_read_b64_tr_b16 v[170:171], v13 offset:43008
s_barrier
v_mfma_f32_16x16x32_bf16 v[40:43], v[144:147], a[48:51], v[40:43]
buffer_load_dwordx4 v[84:87], v20, s[12:15], s56 offen offset:1024 sc1
ds_read_b64_tr_b16 v[172:173], v13 offset:45056
v_mfma_f32_16x16x32_bf16 v[40:43], v[148:151], a[52:55], v[40:43]
buffer_load_dwordx4 v[88:91], v20, s[12:15], s56 offen offset:2048 sc1
ds_read_b64_tr_b16 v[174:175], v13 offset:47104
v_mfma_f32_16x16x32_bf16 v[40:43], v[152:155], a[56:59], v[40:43]
buffer_load_dwordx4 v[92:95], v20, s[12:15], s56 offen offset:3072 sc1
ds_read_b64_tr_b16 v[176:177], v10 offset:49152
v_mfma_f32_16x16x32_bf16 v[40:43], v[156:159], a[60:63], v[40:43]
ds_read_b64_tr_b16 v[178:179], v10 offset:51200
ds_read_b64_tr_b16 v[180:181], v10 offset:53248
v_mfma_f32_16x16x32_bf16 v[56:59], v[144:147], a[176:179], v[56:59]
ds_read_b64_tr_b16 v[182:183], v10 offset:55296
ds_read_b64_tr_b16 v[184:185], v10 offset:57344
v_mfma_f32_16x16x32_bf16 v[56:59], v[148:151], a[180:183], v[56:59]
ds_read_b64_tr_b16 v[186:187], v10 offset:59392
ds_read_b64_tr_b16 v[188:189], v10 offset:61440
v_mfma_f32_16x16x32_bf16 v[56:59], v[152:155], a[184:187], v[56:59]
ds_read_b64_tr_b16 v[190:191], v10 offset:63488
v_mfma_f32_16x16x32_bf16 v[56:59], v[156:159], a[188:191], v[56:59]
s_waitcnt lgkmcnt(8)
v_mfma_f32_16x16x32_bf16 v[44:47], v[160:163], a[48:51], v[44:47]
ds_read_b64_tr_b16 v[144:145], v11 offset:49152
ds_read_b64_tr_b16 v[146:147], v11 offset:51200
v_mfma_f32_16x16x32_bf16 v[44:47], v[164:167], a[52:55], v[44:47]
ds_read_b64_tr_b16 v[148:149], v11 offset:53248
v_mfma_f32_16x16x32_bf16 v[44:47], v[168:171], a[56:59], v[44:47]
ds_read_b64_tr_b16 v[150:151], v11 offset:55296
v_mfma_f32_16x16x32_bf16 v[44:47], v[172:175], a[60:63], v[44:47]
ds_read_b64_tr_b16 v[152:153], v11 offset:57344
v_mfma_f32_16x16x32_bf16 v[60:63], v[160:163], a[176:179], v[60:63]
ds_read_b64_tr_b16 v[154:155], v11 offset:59392
v_mfma_f32_16x16x32_bf16 v[60:63], v[164:167], a[180:183], v[60:63]
ds_read_b64_tr_b16 v[156:157], v11 offset:61440
v_mfma_f32_16x16x32_bf16 v[60:63], v[168:171], a[184:187], v[60:63]
ds_read_b64_tr_b16 v[158:159], v11 offset:63488
v_mfma_f32_16x16x32_bf16 v[60:63], v[172:175], a[188:191], v[60:63]
s_waitcnt lgkmcnt(8)
v_mfma_f32_16x16x32_bf16 v[32:35], v[176:179], a[64:67], v[32:35]
ds_read_b64_tr_b16 v[160:161], v12 offset:49152
ds_read_b64_tr_b16 v[162:163], v12 offset:51200
v_mfma_f32_16x16x32_bf16 v[32:35], v[180:183], a[68:71], v[32:35]
ds_read_b64_tr_b16 v[164:165], v12 offset:53248
v_mfma_f32_16x16x32_bf16 v[32:35], v[184:187], a[72:75], v[32:35]
ds_read_b64_tr_b16 v[166:167], v12 offset:55296
v_mfma_f32_16x16x32_bf16 v[32:35], v[188:191], a[76:79], v[32:35]
ds_read_b64_tr_b16 v[168:169], v12 offset:57344
v_mfma_f32_16x16x32_bf16 v[48:51], v[176:179], a[192:195], v[48:51]
ds_read_b64_tr_b16 v[170:171], v12 offset:59392
v_mfma_f32_16x16x32_bf16 v[48:51], v[180:183], a[196:199], v[48:51]
ds_read_b64_tr_b16 v[172:173], v12 offset:61440
v_mfma_f32_16x16x32_bf16 v[48:51], v[184:187], a[200:203], v[48:51]
ds_read_b64_tr_b16 v[174:175], v12 offset:63488
v_mfma_f32_16x16x32_bf16 v[48:51], v[188:191], a[204:207], v[48:51]
s_waitcnt lgkmcnt(8)
v_mfma_f32_16x16x32_bf16 v[36:39], v[144:147], a[64:67], v[36:39]
ds_read_b64_tr_b16 v[176:177], v13 offset:49152
ds_read_b64_tr_b16 v[178:179], v13 offset:51200
v_mfma_f32_16x16x32_bf16 v[36:39], v[148:151], a[68:71], v[36:39]
ds_read_b64_tr_b16 v[180:181], v13 offset:53248
v_mfma_f32_16x16x32_bf16 v[36:39], v[152:155], a[72:75], v[36:39]
ds_read_b64_tr_b16 v[182:183], v13 offset:55296
v_mfma_f32_16x16x32_bf16 v[36:39], v[156:159], a[76:79], v[36:39]
ds_read_b64_tr_b16 v[184:185], v13 offset:57344
v_mfma_f32_16x16x32_bf16 v[52:55], v[144:147], a[192:195], v[52:55]
ds_read_b64_tr_b16 v[186:187], v13 offset:59392
v_mfma_f32_16x16x32_bf16 v[52:55], v[148:151], a[196:199], v[52:55]
ds_read_b64_tr_b16 v[188:189], v13 offset:61440
v_mfma_f32_16x16x32_bf16 v[52:55], v[152:155], a[200:203], v[52:55]
ds_read_b64_tr_b16 v[190:191], v13 offset:63488
v_mfma_f32_16x16x32_bf16 v[52:55], v[156:159], a[204:207], v[52:55]
s_waitcnt lgkmcnt(8)
s_barrier
v_mfma_f32_16x16x32_bf16 v[40:43], v[160:163], a[64:67], v[40:43]
s_buffer_load_dword s44, s[12:15], s43 offset:262168 glc
ds_read_b64_tr_b16 v[144:145], v14 offset:0
v_mfma_f32_16x16x32_bf16 v[40:43], v[164:167], a[68:71], v[40:43]
ds_read_b64_tr_b16 v[146:147], v14 offset:2048
ds_read_b64_tr_b16 v[148:149], v14 offset:4096
v_mfma_f32_16x16x32_bf16 v[40:43], v[168:171], a[72:75], v[40:43]
ds_read_b64_tr_b16 v[150:151], v14 offset:6144
v_mfma_f32_16x16x32_bf16 v[40:43], v[172:175], a[76:79], v[40:43]
ds_read_b64_tr_b16 v[152:153], v14 offset:8192
v_mfma_f32_16x16x32_bf16 v[56:59], v[160:163], a[192:195], v[56:59]
ds_read_b64_tr_b16 v[154:155], v14 offset:10240
v_mfma_f32_16x16x32_bf16 v[56:59], v[164:167], a[196:199], v[56:59]
ds_read_b64_tr_b16 v[156:157], v14 offset:12288
v_mfma_f32_16x16x32_bf16 v[56:59], v[168:171], a[200:203], v[56:59]
ds_read_b64_tr_b16 v[158:159], v14 offset:14336
v_mfma_f32_16x16x32_bf16 v[56:59], v[172:175], a[204:207], v[56:59]
s_waitcnt lgkmcnt(8)
v_mfma_f32_16x16x32_bf16 v[44:47], v[176:179], a[64:67], v[44:47]
ds_read_b64_tr_b16 v[160:161], v15 offset:0
ds_read_b64_tr_b16 v[162:163], v15 offset:2048
v_mfma_f32_16x16x32_bf16 v[44:47], v[180:183], a[68:71], v[44:47]
ds_read_b64_tr_b16 v[164:165], v15 offset:4096
v_mfma_f32_16x16x32_bf16 v[44:47], v[184:187], a[72:75], v[44:47]
ds_read_b64_tr_b16 v[166:167], v15 offset:6144
v_mfma_f32_16x16x32_bf16 v[44:47], v[188:191], a[76:79], v[44:47]
ds_read_b64_tr_b16 v[168:169], v15 offset:8192
v_mfma_f32_16x16x32_bf16 v[60:63], v[176:179], a[192:195], v[60:63]
ds_read_b64_tr_b16 v[170:171], v15 offset:10240
v_mfma_f32_16x16x32_bf16 v[60:63], v[180:183], a[196:199], v[60:63]
ds_read_b64_tr_b16 v[172:173], v15 offset:12288
v_mfma_f32_16x16x32_bf16 v[60:63], v[184:187], a[200:203], v[60:63]
ds_read_b64_tr_b16 v[174:175], v15 offset:14336
v_mfma_f32_16x16x32_bf16 v[60:63], v[188:191], a[204:207], v[60:63]
s_waitcnt lgkmcnt(8)
v_mfma_f32_16x16x32_bf16 v[32:35], v[144:147], a[80:83], v[32:35]
ds_read_b64_tr_b16 v[176:177], v16 offset:0
ds_read_b64_tr_b16 v[178:179], v16 offset:2048
v_mfma_f32_16x16x32_bf16 v[32:35], v[148:151], a[84:87], v[32:35]
ds_read_b64_tr_b16 v[180:181], v16 offset:4096
v_mfma_f32_16x16x32_bf16 v[32:35], v[152:155], a[88:91], v[32:35]
ds_read_b64_tr_b16 v[182:183], v16 offset:6144
v_mfma_f32_16x16x32_bf16 v[32:35], v[156:159], a[92:95], v[32:35]
ds_read_b64_tr_b16 v[184:185], v16 offset:8192
v_mfma_f32_16x16x32_bf16 v[48:51], v[144:147], a[208:211], v[48:51]
ds_read_b64_tr_b16 v[186:187], v16 offset:10240
v_mfma_f32_16x16x32_bf16 v[48:51], v[148:151], a[212:215], v[48:51]
ds_read_b64_tr_b16 v[188:189], v16 offset:12288
v_mfma_f32_16x16x32_bf16 v[48:51], v[152:155], a[216:219], v[48:51]
ds_read_b64_tr_b16 v[190:191], v16 offset:14336
v_mfma_f32_16x16x32_bf16 v[48:51], v[156:159], a[220:223], v[48:51]
s_waitcnt lgkmcnt(8)
v_mfma_f32_16x16x32_bf16 v[36:39], v[160:163], a[80:83], v[36:39]
s_waitcnt lgkmcnt(0)
s_and_b32 s44, s44, 1
s_cbranch_scc1 mlp_kernel_q10_ok
s_mov_b32 s27, 0x40000
mlp_kernel_q10:
s_sleep 4
s_buffer_load_dword s44, s[12:15], s43 offset:262168 glc
s_waitcnt lgkmcnt(0)
s_sub_u32 s27, s27, 1
s_cbranch_scc1 mlp_kernel_q10_ok
s_and_b32 s44, s44, 1
s_cbranch_scc0 mlp_kernel_q10
mlp_kernel_q10_ok:
ds_read_b64_tr_b16 v[144:145], v17 offset:0
v_mfma_f32_16x16x32_bf16 v[36:39], v[164:167], a[84:87], v[36:39]
buffer_load_dwordx4 v[128:131], v20, s[12:15], s23 offen offset:0 sc1
v_mfma_f32_16x16x32_bf16 v[36:39], v[168:171], a[88:91], v[36:39]
buffer_load_dwordx4 v[132:135], v20, s[12:15], s23 offen offset:1024 sc1
v_mfma_f32_16x16x32_bf16 v[36:39], v[172:175], a[92:95], v[36:39]
ds_read_b64_tr_b16 v[146:147], v17 offset:2048
ds_read_b64_tr_b16 v[148:149], v17 offset:4096
v_mfma_f32_16x16x32_bf16 v[52:55], v[160:163], a[208:211], v[52:55]
buffer_load_dwordx4 v[136:139], v20, s[12:15], s23 offen offset:2048 sc1
v_mfma_f32_16x16x32_bf16 v[52:55], v[164:167], a[212:215], v[52:55]
buffer_load_dwordx4 v[140:143], v20, s[12:15], s23 offen offset:3072 sc1
ds_read_b64_tr_b16 v[150:151], v17 offset:6144
v_mfma_f32_16x16x32_bf16 v[52:55], v[168:171], a[216:219], v[52:55]
ds_read_b64_tr_b16 v[152:153], v17 offset:8192
ds_read_b64_tr_b16 v[154:155], v17 offset:10240
v_mfma_f32_16x16x32_bf16 v[52:55], v[172:175], a[220:223], v[52:55]
s_waitcnt vmcnt(4)
v_lshlrev_b32 v192, 16, v64
s_barrier
v_mfma_f32_16x16x32_bf16 v[40:43], v[176:179], a[80:83], v[40:43]
ds_read_b64_tr_b16 v[156:157], v17 offset:12288
v_and_b32 v193, 0xffff0000, v64
v_lshlrev_b32 v194, 16, v65
v_and_b32 v195, 0xffff0000, v65
v_mfma_f32_16x16x32_bf16 v[40:43], v[180:183], a[84:87], v[40:43]
ds_read_b64_tr_b16 v[158:159], v17 offset:14336
v_fmac_f32 v96, v236, v192
v_fmac_f32 v97, v237, v193
v_fmac_f32 v98, v238, v194
v_mfma_f32_16x16x32_bf16 v[40:43], v[184:187], a[88:91], v[40:43]
ds_read_b64_tr_b16 v[160:161], v14 offset:16384
v_fmac_f32 v99, v239, v195
v_lshlrev_b32 v196, 16, v66
v_mfma_f32_16x16x32_bf16 v[40:43], v[188:191], a[92:95], v[40:43]
ds_read_b64_tr_b16 v[162:163], v14 offset:18432
v_and_b32 v197, 0xffff0000, v66
v_lshlrev_b32 v198, 16, v67
v_and_b32 v199, 0xffff0000, v67
v_mfma_f32_16x16x32_bf16 v[56:59], v[176:179], a[208:211], v[56:59]
ds_read_b64_tr_b16 v[164:165], v14 offset:20480
v_fmac_f32 v100, v240, v196
v_fmac_f32 v101, v241, v197
v_fmac_f32 v102, v242, v198
v_mfma_f32_16x16x32_bf16 v[56:59], v[180:183], a[212:215], v[56:59]
ds_read_b64_tr_b16 v[166:167], v14 offset:22528
v_fmac_f32 v103, v243, v199
v_lshlrev_b32 v200, 16, v68
v_mfma_f32_16x16x32_bf16 v[56:59], v[184:187], a[216:219], v[56:59]
ds_read_b64_tr_b16 v[168:169], v14 offset:24576
v_and_b32 v201, 0xffff0000, v68
v_lshlrev_b32 v202, 16, v69
v_and_b32 v203, 0xffff0000, v69
v_mfma_f32_16x16x32_bf16 v[56:59], v[188:191], a[220:223], v[56:59]
ds_read_b64_tr_b16 v[170:171], v14 offset:26624
v_fmac_f32 v104, v244, v200
v_fmac_f32 v105, v245, v201
v_fmac_f32 v106, v246, v202
s_waitcnt lgkmcnt(6)
v_mfma_f32_16x16x32_bf16 v[44:47], v[144:147], a[80:83], v[44:47]
ds_read_b64_tr_b16 v[172:173], v14 offset:28672
v_fmac_f32 v107, v247, v203
v_lshlrev_b32 v204, 16, v70
v_mfma_f32_16x16x32_bf16 v[44:47], v[148:151], a[84:87], v[44:47]
ds_read_b64_tr_b16 v[174:175], v14 offset:30720
v_and_b32 v205, 0xffff0000, v70
v_lshlrev_b32 v206, 16, v71
v_and_b32 v207, 0xffff0000, v71
v_mfma_f32_16x16x32_bf16 v[44:47], v[152:155], a[88:91], v[44:47]
ds_read_b64_tr_b16 v[176:177], v15 offset:16384
v_fmac_f32 v108, v248, v204
v_fmac_f32 v109, v249, v205
v_fmac_f32 v110, v250, v206
v_mfma_f32_16x16x32_bf16 v[44:47], v[156:159], a[92:95], v[44:47]
ds_read_b64_tr_b16 v[178:179], v15 offset:18432
v_fmac_f32 v111, v251, v207
v_lshlrev_b32 v192, 16, v72
v_mfma_f32_16x16x32_bf16 v[60:63], v[144:147], a[208:211], v[60:63]
ds_read_b64_tr_b16 v[180:181], v15 offset:20480
v_and_b32 v193, 0xffff0000, v72
v_lshlrev_b32 v194, 16, v73
v_and_b32 v195, 0xffff0000, v73
v_mfma_f32_16x16x32_bf16 v[60:63], v[148:151], a[212:215], v[60:63]
ds_read_b64_tr_b16 v[182:183], v15 offset:22528
v_fmac_f32 v112, v236, v192
v_fmac_f32 v113, v237, v193
v_fmac_f32 v114, v238, v194
v_mfma_f32_16x16x32_bf16 v[60:63], v[152:155], a[216:219], v[60:63]
ds_read_b64_tr_b16 v[184:185], v15 offset:24576
v_fmac_f32 v115, v239, v195
v_lshlrev_b32 v196, 16, v74
v_mfma_f32_16x16x32_bf16 v[60:63], v[156:159], a[220:223], v[60:63]
ds_read_b64_tr_b16 v[186:187], v15 offset:26624
v_and_b32 v197, 0xffff0000, v74
v_lshlrev_b32 v198, 16, v75
v_and_b32 v199, 0xffff0000, v75
s_waitcnt lgkmcnt(6)
v_mfma_f32_16x16x32_bf16 v[32:35], v[160:163], a[96:99], v[32:35]
ds_read_b64_tr_b16 v[188:189], v15 offset:28672
v_fmac_f32 v116, v240, v196
v_fmac_f32 v117, v241, v197
v_fmac_f32 v118, v242, v198
v_mfma_f32_16x16x32_bf16 v[32:35], v[164:167], a[100:103], v[32:35]
ds_read_b64_tr_b16 v[190:191], v15 offset:30720
v_fmac_f32 v119, v243, v199
v_lshlrev_b32 v200, 16, v76
v_and_b32 v201, 0xffff0000, v76
v_mfma_f32_16x16x32_bf16 v[32:35], v[168:171], a[104:107], v[32:35]
ds_read_b64_tr_b16 v[144:145], v16 offset:16384
v_lshlrev_b32 v202, 16, v77
v_and_b32 v203, 0xffff0000, v77
v_mfma_f32_16x16x32_bf16 v[32:35], v[172:175], a[108:111], v[32:35]
ds_read_b64_tr_b16 v[146:147], v16 offset:18432
v_fmac_f32 v120, v244, v200
v_fmac_f32 v121, v245, v201
v_fmac_f32 v122, v246, v202
v_mfma_f32_16x16x32_bf16 v[48:51], v[160:163], a[224:227], v[48:51]
ds_read_b64_tr_b16 v[148:149], v16 offset:20480
v_fmac_f32 v123, v247, v203
v_lshlrev_b32 v204, 16, v78
v_and_b32 v205, 0xffff0000, v78
v_mfma_f32_16x16x32_bf16 v[48:51], v[164:167], a[228:231], v[48:51]
ds_read_b64_tr_b16 v[150:151], v16 offset:22528
v_lshlrev_b32 v206, 16, v79
v_and_b32 v207, 0xffff0000, v79
v_mfma_f32_16x16x32_bf16 v[48:51], v[168:171], a[232:235], v[48:51]
ds_read_b64_tr_b16 v[152:153], v16 offset:24576
v_fmac_f32 v124, v248, v204
v_fmac_f32 v125, v249, v205
v_fmac_f32 v126, v250, v206
v_mfma_f32_16x16x32_bf16 v[48:51], v[172:175], a[236:239], v[48:51]
ds_read_b64_tr_b16 v[154:155], v16 offset:26624
v_fmac_f32 v127, v251, v207
v_lshlrev_b32 v192, 16, v80
v_and_b32 v193, 0xffff0000, v80
s_waitcnt lgkmcnt(6)
v_mfma_f32_16x16x32_bf16 v[36:39], v[176:179], a[96:99], v[36:39]
ds_read_b64_tr_b16 v[156:157], v16 offset:28672
v_lshlrev_b32 v194, 16, v81
v_and_b32 v195, 0xffff0000, v81
v_mfma_f32_16x16x32_bf16 v[36:39], v[180:183], a[100:103], v[36:39]
ds_read_b64_tr_b16 v[158:159], v16 offset:30720
v_fmac_f32 v96, v236, v192
v_fmac_f32 v97, v237, v193
v_fmac_f32 v98, v238, v194
v_mfma_f32_16x16x32_bf16 v[36:39], v[184:187], a[104:107], v[36:39]
ds_read_b64_tr_b16 v[160:161], v17 offset:16384
v_fmac_f32 v99, v239, v195
v_lshlrev_b32 v196, 16, v82
v_and_b32 v197, 0xffff0000, v82
v_mfma_f32_16x16x32_bf16 v[36:39], v[188:191], a[108:111], v[36:39]
ds_read_b64_tr_b16 v[162:163], v17 offset:18432
v_lshlrev_b32 v198, 16, v83
v_and_b32 v199, 0xffff0000, v83
v_mfma_f32_16x16x32_bf16 v[52:55], v[176:179], a[224:227], v[52:55]
ds_read_b64_tr_b16 v[164:165], v17 offset:20480
v_fmac_f32 v100, v240, v196
v_fmac_f32 v101, v241, v197
v_fmac_f32 v102, v242, v198
v_mfma_f32_16x16x32_bf16 v[52:55], v[180:183], a[228:231], v[52:55]
ds_read_b64_tr_b16 v[166:167], v17 offset:22528
v_fmac_f32 v103, v243, v199
v_lshlrev_b32 v200, 16, v84
v_and_b32 v201, 0xffff0000, v84
v_mfma_f32_16x16x32_bf16 v[52:55], v[184:187], a[232:235], v[52:55]
ds_read_b64_tr_b16 v[168:169], v17 offset:24576
v_lshlrev_b32 v202, 16, v85
v_and_b32 v203, 0xffff0000, v85
v_mfma_f32_16x16x32_bf16 v[52:55], v[188:191], a[236:239], v[52:55]
ds_read_b64_tr_b16 v[170:171], v17 offset:26624
v_fmac_f32 v104, v244, v200
v_fmac_f32 v105, v245, v201
v_fmac_f32 v106, v246, v202
s_waitcnt lgkmcnt(6)
v_mfma_f32_16x16x32_bf16 v[40:43], v[144:147], a[96:99], v[40:43]
ds_read_b64_tr_b16 v[172:173], v17 offset:28672
v_fmac_f32 v107, v247, v203
v_lshlrev_b32 v204, 16, v86
v_and_b32 v205, 0xffff0000, v86
v_mfma_f32_16x16x32_bf16 v[40:43], v[148:151], a[100:103], v[40:43]
ds_read_b64_tr_b16 v[174:175], v17 offset:30720
v_lshlrev_b32 v206, 16, v87
v_and_b32 v207, 0xffff0000, v87
v_fmac_f32 v108, v248, v204
v_mfma_f32_16x16x32_bf16 v[40:43], v[152:155], a[104:107], v[40:43]
v_fmac_f32 v109, v249, v205
v_fmac_f32 v110, v250, v206
v_mfma_f32_16x16x32_bf16 v[40:43], v[156:159], a[108:111], v[40:43]
v_fmac_f32 v111, v251, v207
v_lshlrev_b32 v192, 16, v88
v_and_b32 v193, 0xffff0000, v88
v_mfma_f32_16x16x32_bf16 v[56:59], v[144:147], a[224:227], v[56:59]
v_lshlrev_b32 v194, 16, v89
v_and_b32 v195, 0xffff0000, v89
v_fmac_f32 v112, v236, v192
v_mfma_f32_16x16x32_bf16 v[56:59], v[148:151], a[228:231], v[56:59]
v_fmac_f32 v113, v237, v193
v_fmac_f32 v114, v238, v194
v_mfma_f32_16x16x32_bf16 v[56:59], v[152:155], a[232:235], v[56:59]
v_fmac_f32 v115, v239, v195
v_lshlrev_b32 v196, 16, v90
v_and_b32 v197, 0xffff0000, v90
v_mfma_f32_16x16x32_bf16 v[56:59], v[156:159], a[236:239], v[56:59]
v_lshlrev_b32 v198, 16, v91
v_and_b32 v199, 0xffff0000, v91
v_fmac_f32 v116, v240, v196
s_waitcnt lgkmcnt(0)
v_mfma_f32_16x16x32_bf16 v[44:47], v[160:163], a[96:99], v[44:47]
v_fmac_f32 v117, v241, v197
v_fmac_f32 v118, v242, v198
v_mfma_f32_16x16x32_bf16 v[44:47], v[164:167], a[100:103], v[44:47]
v_fmac_f32 v119, v243, v199
v_lshlrev_b32 v200, 16, v92
v_and_b32 v201, 0xffff0000, v92
v_mfma_f32_16x16x32_bf16 v[44:47], v[168:171], a[104:107], v[44:47]
v_lshlrev_b32 v202, 16, v93
v_and_b32 v203, 0xffff0000, v93
v_fmac_f32 v120, v244, v200
v_mfma_f32_16x16x32_bf16 v[44:47], v[172:175], a[108:111], v[44:47]
v_fmac_f32 v121, v245, v201
v_fmac_f32 v122, v246, v202
v_mfma_f32_16x16x32_bf16 v[60:63], v[160:163], a[224:227], v[60:63]
v_fmac_f32 v123, v247, v203
v_lshlrev_b32 v204, 16, v94
v_and_b32 v205, 0xffff0000, v94
v_mfma_f32_16x16x32_bf16 v[60:63], v[164:167], a[228:231], v[60:63]
v_lshlrev_b32 v206, 16, v95
v_and_b32 v207, 0xffff0000, v95
v_fmac_f32 v124, v248, v204
v_mfma_f32_16x16x32_bf16 v[60:63], v[168:171], a[232:235], v[60:63]
v_fmac_f32 v125, v249, v205
v_fmac_f32 v126, v250, v206
v_mfma_f32_16x16x32_bf16 v[60:63], v[172:175], a[236:239], v[60:63]
v_fmac_f32 v127, v251, v207
s_nop 7
v_pk_fma_f32 v[96:97], v[236:237], v[32:33], v[96:97]
v_pk_fma_f32 v[98:99], v[238:239], v[34:35], v[98:99]
v_pk_fma_f32 v[100:101], v[240:241], v[36:37], v[100:101]
v_pk_fma_f32 v[102:103], v[242:243], v[38:39], v[102:103]
v_pk_fma_f32 v[104:105], v[244:245], v[40:41], v[104:105]
v_pk_fma_f32 v[106:107], v[246:247], v[42:43], v[106:107]
v_pk_fma_f32 v[108:109], v[248:249], v[44:45], v[108:109]
v_pk_fma_f32 v[110:111], v[250:251], v[46:47], v[110:111]
v_pk_fma_f32 v[112:113], v[236:237], v[48:49], v[112:113]
v_pk_fma_f32 v[114:115], v[238:239], v[50:51], v[114:115]
v_pk_fma_f32 v[116:117], v[240:241], v[52:53], v[116:117]
v_pk_fma_f32 v[118:119], v[242:243], v[54:55], v[118:119]
v_pk_fma_f32 v[120:121], v[244:245], v[56:57], v[120:121]
v_pk_fma_f32 v[122:123], v[246:247], v[58:59], v[122:123]
v_pk_fma_f32 v[124:125], v[248:249], v[60:61], v[124:125]
v_pk_fma_f32 v[126:127], v[250:251], v[62:63], v[126:127]
s_waitcnt vmcnt(0)
v_lshlrev_b32 v192, 16, v128
v_and_b32 v193, 0xffff0000, v128
v_lshlrev_b32 v194, 16, v129
v_and_b32 v195, 0xffff0000, v129
v_pk_fma_f32 v[96:97], v[236:237], v[192:193], v[96:97]
v_pk_fma_f32 v[98:99], v[238:239], v[194:195], v[98:99]
v_cvt_pk_bf16_f32 v216, v96, v97
v_cvt_pk_bf16_f32 v217, v98, v99
v_lshlrev_b32 v196, 16, v130
v_and_b32 v197, 0xffff0000, v130
v_lshlrev_b32 v198, 16, v131
v_and_b32 v199, 0xffff0000, v131
v_pk_fma_f32 v[100:101], v[240:241], v[196:197], v[100:101]
v_pk_fma_f32 v[102:103], v[242:243], v[198:199], v[102:103]
v_cvt_pk_bf16_f32 v218, v100, v101
v_cvt_pk_bf16_f32 v219, v102, v103
s_nop 1
v_permlane16_swap_b32 v216, v218
v_permlane16_swap_b32 v217, v219
buffer_store_dwordx4 v[216:219], v208, s[16:19], s24 offen offset:0
v_lshlrev_b32 v200, 16, v132
v_and_b32 v201, 0xffff0000, v132
v_lshlrev_b32 v202, 16, v133
v_and_b32 v203, 0xffff0000, v133
v_pk_fma_f32 v[104:105], v[244:245], v[200:201], v[104:105]
v_pk_fma_f32 v[106:107], v[246:247], v[202:203], v[106:107]
v_cvt_pk_bf16_f32 v220, v104, v105
v_cvt_pk_bf16_f32 v221, v106, v107
v_lshlrev_b32 v204, 16, v134
v_and_b32 v205, 0xffff0000, v134
v_lshlrev_b32 v206, 16, v135
v_and_b32 v207, 0xffff0000, v135
v_pk_fma_f32 v[108:109], v[248:249], v[204:205], v[108:109]
v_pk_fma_f32 v[110:111], v[250:251], v[206:207], v[110:111]
v_cvt_pk_bf16_f32 v222, v108, v109
v_cvt_pk_bf16_f32 v223, v110, v111
s_nop 1
v_permlane16_swap_b32 v220, v222
v_permlane16_swap_b32 v221, v223
buffer_store_dwordx4 v[220:223], v208, s[16:19], s24 offen offset:64
v_lshlrev_b32 v192, 16, v136
v_and_b32 v193, 0xffff0000, v136
v_lshlrev_b32 v194, 16, v137
v_and_b32 v195, 0xffff0000, v137
v_pk_fma_f32 v[112:113], v[236:237], v[192:193], v[112:113]
v_pk_fma_f32 v[114:115], v[238:239], v[194:195], v[114:115]
v_cvt_pk_bf16_f32 v224, v112, v113
v_cvt_pk_bf16_f32 v225, v114, v115
v_lshlrev_b32 v196, 16, v138
v_and_b32 v197, 0xffff0000, v138
v_lshlrev_b32 v198, 16, v139
v_and_b32 v199, 0xffff0000, v139
v_pk_fma_f32 v[116:117], v[240:241], v[196:197], v[116:117]
v_pk_fma_f32 v[118:119], v[242:243], v[198:199], v[118:119]
v_cvt_pk_bf16_f32 v226, v116, v117
v_cvt_pk_bf16_f32 v227, v118, v119
s_nop 1
v_permlane16_swap_b32 v224, v226
v_permlane16_swap_b32 v225, v227
buffer_store_dwordx4 v[224:227], v209, s[16:19], s24 offen offset:0
v_lshlrev_b32 v200, 16, v140
v_and_b32 v201, 0xffff0000, v140
v_lshlrev_b32 v202, 16, v141
v_and_b32 v203, 0xffff0000, v141
v_pk_fma_f32 v[120:121], v[244:245], v[200:201], v[120:121]
v_pk_fma_f32 v[122:123], v[246:247], v[202:203], v[122:123]
v_cvt_pk_bf16_f32 v228, v120, v121
v_cvt_pk_bf16_f32 v229, v122, v123
v_lshlrev_b32 v204, 16, v142
v_and_b32 v205, 0xffff0000, v142
v_lshlrev_b32 v206, 16, v143
v_and_b32 v207, 0xffff0000, v143
v_pk_fma_f32 v[124:125], v[248:249], v[204:205], v[124:125]
v_pk_fma_f32 v[126:127], v[250:251], v[206:207], v[126:127]
v_cvt_pk_bf16_f32 v230, v124, v125
v_cvt_pk_bf16_f32 v231, v126, v127
s_nop 1
v_permlane16_swap_b32 v228, v230
v_permlane16_swap_b32 v229, v231
buffer_store_dwordx4 v[228:231], v209, s[16:19], s24 offen offset:64
mlp_kernel_end:
s_endpgm

.section .rodata,"a"
.p2align 6
.amdhsa_kernel conv_kernel
  .amdhsa_next_free_vgpr 512
  .amdhsa_next_free_sgpr 102
  .amdhsa_accum_offset 256
  .amdhsa_group_segment_fixed_size 0
  .amdhsa_kernarg_size 112
  .amdhsa_user_sgpr_count 2
  .amdhsa_user_sgpr_kernarg_segment_ptr 1
  .amdhsa_system_sgpr_workgroup_id_x 1
.end_amdhsa_kernel

.section .rodata,"a"
.p2align 6
.amdhsa_kernel mlp_kernel
  .amdhsa_next_free_vgpr 512
  .amdhsa_next_free_sgpr 102
  .amdhsa_accum_offset 256
  .amdhsa_group_segment_fixed_size 0
  .amdhsa_kernarg_size 112
  .amdhsa_user_sgpr_count 2
  .amdhsa_user_sgpr_kernarg_segment_ptr 1
  .amdhsa_system_sgpr_workgroup_id_x 1
.end_amdhsa_kernel
```
